```python
import torch

def _softmax(x, axis=-1):
    return torch.softmax(x, dim=axis)
def _gelu(x):
    return torch.nn.functional.gelu(x, approximate="tanh")
def _silu(x):
    return torch.nn.functional.silu(x)
def _sigmoid(x):
    return torch.sigmoid(x)
def _layernorm(x, axis=-1, eps=1e-5):
    m = x.mean(dim=axis, keepdim=True)
    v = x.var(dim=axis, keepdim=True, unbiased=False)
    return (x - m) / torch.sqrt(v + eps)
def _scatter_add(tgt, idx, src, axis=0):
    return tgt.clone().index_add_(axis, idx, src)
def _segment_sum(src, seg, n):
    out = torch.zeros((n,) + src.shape[1:], dtype=src.dtype)
    return out.index_add_(0, seg, src)
def _pad(x, pw):
    flat = tuple(v for pair in reversed(pw) for v in pair)
    return torch.nn.functional.pad(x, flat)

kernel_name = 'parallel_sum__softmax_full_mha__dense_activation_relu__prompt'

def setup_inputs():

    _w = (lambda a: (lambda t: t.to(torch.bfloat16) if t.is_floating_point() else t)(torch.as_tensor(a)))
    def _A_setup():
        B, S, D = 1, 2048, 1024
        return {
            "x": _w((lambda *s: torch.randn(*s, dtype=torch.bfloat16) * 0.05)(B, S, D)),
            "wqkv": _w((lambda *s: torch.randn(*s, dtype=torch.bfloat16) * 0.05)(D, 3 * D)),
            "wo": _w((lambda *s: torch.randn(*s, dtype=torch.bfloat16) * 0.05)(D, D)),
        }
    _A_in = _A_setup()

    def _B_setup():
        B, S, D, Dff = 1, 2048, 1024, 3584
        return {
            "x": _w((lambda *s: torch.randn(*s, dtype=torch.bfloat16) * 0.05)(B, S, D)),
            "w1": _w((lambda *s: torch.randn(*s, dtype=torch.bfloat16) * 0.05)(D, Dff)),
            "w2": _w((lambda *s: torch.randn(*s, dtype=torch.bfloat16) * 0.05)(Dff, D)),
        }
    _B_in = _B_setup()

    return {
        "A_x": _A_in["x"],
        "A_wqkv": _A_in["wqkv"],
        "A_wo": _A_in["wo"],
        "B_x": _B_in["x"],
        "B_w1": _B_in["w1"],
        "B_w2": _B_in["w2"],
    }

def reference(A_x, A_wqkv, A_wo, B_x, B_w1, B_w2):
    def _A_ref(x, wqkv, wo):
        B, S, D = x.shape
        H = 32; Dh = D // H
        qkv = (lambda x, *d: x.permute(*d))((x @ wqkv).reshape(B, S, 3, H, Dh), 2, 0, 3, 1, 4)
        q, k, v = qkv[0], qkv[1], qkv[2]
        scale = Dh ** -0.5
        scores = torch.einsum("bhqd,bhkd->bhqk", q, k) * scale
        p = _softmax(scores, axis=-1)
        o = torch.einsum("bhqk,bhkd->bhqd", p, v)
        return (lambda x, *d: x.permute(*d))(o, 0, 2, 1, 3).reshape(B, S, D) @ wo

    def _B_ref(x, w1, w2):
        h = torch.einsum("bsd,df->bsf", x, w1)
        zero = torch.zeros_like(h)
        h = torch.maximum(h, zero)
        return torch.einsum("bsf,fd->bsd", h, w2)

    x = A_x
    xn = _layernorm(x, axis=-1)
    return x + _A_ref(xn, A_wqkv, A_wo) + _B_ref(xn, B_w1, B_w2)
```

```asm
; @launch grid=(256,1,1) block=(256,1,1) lds=163840
.amdgcn_target "amdgcn-amd-amdhsa--gfx950"
.text
.globl parallel_sum__softmax_full_mha__dense_activation_relu__prompt_kernel
.p2align 8
.type parallel_sum__softmax_full_mha__dense_activation_relu__prompt_kernel,@function
parallel_sum__softmax_full_mha__dense_activation_relu__prompt_kernel:
    s_cmp_ge_u32 s2, 256
    s_cbranch_scc1 K_end
    s_load_dwordx16 s[16:31], s[0:1], 0
    s_load_dwordx2 s[32:33], s[0:1], 64
    s_getpc_b64 s[48:49]
K_pc:
    s_sub_u32 s48, s48, K_pc-parallel_sum__softmax_full_mha__dense_activation_relu__prompt_kernel
    s_subb_u32 s49, s49, 0
    s_mov_b32 s50, K_code_end-parallel_sum__softmax_full_mha__dense_activation_relu__prompt_kernel
    s_mov_b32 s51, 0x00020000
    v_lshlrev_b32 v2, 7, v0
    buffer_load_dword v6, v2, s[48:51], 0 offen
    s_mov_b32 s3, 0x8000
    buffer_load_dword v7, v2, s[48:51], s3 offen
    v_and_b32 v255, 63, v0
    v_lshrrev_b32 v1, 6, v0
    v_lshlrev_b32 v254, 4, v255
    v_readfirstlane_b32 s4, v1
    s_and_b32 s5, s2, 7
    s_lshr_b32 s6, s2, 3
    s_and_b32 s7, s6, 7
    s_lshr_b32 s8, s6, 3
    s_and_b32 s9, s8, 1
    s_lshl_b32 s3, s5, 1
    s_add_u32 s9, s9, s3
    s_lshr_b32 s10, s4, 1
    s_and_b32 s11, s4, 1
    s_lshl_b32 s35, s5, 2
    s_add_u32 s35, s35, s8
    v_lshrrev_b32 v250, 4, v255
    v_and_b32 v251, 15, v255
    v_lshrrev_b32 v239, 3, v255
    v_and_b32 v240, 7, v255
    v_xor_b32 v240, v240, v250
    v_lshlrev_b32_e64 v240, 4, v240
    v_lshl_add_u32 v231, v239, 11, v240
    v_xor_b32_e64 v232, 64, v231
    v_add_u32 v233, 30720, v231
    v_add_u32 v232, 15360, v232
    v_add_u32 v234, 30720, v232
    s_lshl_b32 s64, s7, 19
    s_lshl_b32 s3, s4, 17
    s_add_u32 s64, s64, s3
    s_add_u32 s65, s64, 0x10000
    s_add_u32 s78, s7, 1
    s_cmp_eq_u32 s7, 7
    s_cselect_b32 s78, 1, s78
    s_mov_b32 s66, 0
    s_lshl_b32 s68, s4, 13
    s_add_u32 s69, s68, 4096
    s_mov_b32 s72, 0
    s_mov_b32 s73, 0
    s_lshl_b32 s76, s7, 8
    s_lshl_b32 s3, s35, 3
    s_add_u32 s76, s76, s3
    s_lshl_b32 s3, s4, 1
    s_add_u32 s76, s76, s3
    s_lshl_b32 s79, s76, 11
    v_lshrrev_b32 v1, 5, v255
    v_and_b32 v2, 31, v255
    v_lshlrev_b32_e64 v3, 4, v2
    v_lshl_add_u32 v3, v1, 11, v3
    s_waitcnt lgkmcnt(0)
    s_mov_b32 s40, s16
    s_mov_b32 s41, s17
    s_mov_b32 s42, 0x400000
    s_mov_b32 s43, 0x00020000
    s_cmp_ge_u32 s8, 2
    s_cbranch_scc1 G1_ffn
    s_mul_i32 s70, s4, 3072
    s_add_u32 m0, s68, s72
    s_add_u32 s80, s64, s66
    s_nop 0
    buffer_load_dwordx4 v231, s[40:43], s80 offen lds
    s_add_u32 s70, s70, 98304
    s_mov_b32 s67, 4294770688
    s_mul_i32 s77, s9, 128
    s_mul_i32 s3, s4, 192
    s_mov_b32 s81, 2731
    s_mov_b32 s82, 6144
    v_add_u32_e64 v239, s3, v255
    buffer_load_dwordx4 v232, s[40:43], s80 offen offset:1024 lds
    v_mul_lo_u32 v240, v239, s81
    v_lshrrev_b32 v240, 16, v240
    v_mul_u32_u24 v241, 24, v240
    v_sub_u32 v239, v239, v241
    v_and_b32 v241, 2, v240
    v_bfe_u32 v242, v240, 3, 1
    v_lshl_or_b32 v241, v242, 2, v241
    buffer_load_dwordx4 v233, s[40:43], s80 offen offset:2048 lds
    v_xor_b32 v239, v239, v241
    v_lshrrev_b32 v241, 3, v239
    v_and_b32 v239, 7, v239
    v_lshlrev_b32 v239, 4, v239
    v_lshl_add_u32 v239, v241, 11, v239
    v_mul_lo_u32 v241, v240, s82
    v_add3_u32 v235, v241, v239, s77
    buffer_load_dwordx4 v234, s[40:43], s80 offen offset:3072 lds
    v_add_u32 v239, s3, v255
    v_add_u32 v239, 64, v239
    v_mul_lo_u32 v240, v239, s81
    v_lshrrev_b32 v240, 16, v240
    v_mul_u32_u24 v241, 24, v240
    v_sub_u32 v239, v239, v241
    v_and_b32 v241, 2, v240
    s_add_u32 m0, s69, s72
    s_add_u32 s80, s65, s66
    buffer_load_dwordx4 v231, s[40:43], s80 offen lds
    v_bfe_u32 v242, v240, 3, 1
    v_lshl_or_b32 v241, v242, 2, v241
    v_xor_b32 v239, v239, v241
    v_lshrrev_b32 v241, 3, v239
    v_and_b32 v239, 7, v239
    v_lshlrev_b32 v239, 4, v239
    v_lshl_add_u32 v239, v241, 11, v239
    buffer_load_dwordx4 v232, s[40:43], s80 offen offset:1024 lds
    v_mul_lo_u32 v241, v240, s82
    v_add3_u32 v236, v241, v239, s77
    v_subrev_u32 v236, 1024, v236
    v_add_u32_e64 v239, s3, v255
    v_add_u32 v239, 128, v239
    v_mul_lo_u32 v240, v239, s81
    v_lshrrev_b32_e64 v240, 16, v240
    buffer_load_dwordx4 v233, s[40:43], s80 offen offset:2048 lds
    s_add_u32 s72, s72, 0x8000
    s_cmp_eq_u32 s72, 0x18000
    s_cselect_b32 s72, 0, s72
    v_mul_u32_u24 v241, 24, v240
    v_sub_u32 v239, v239, v241
    v_and_b32 v241, 2, v240
    v_bfe_u32 v242, v240, 3, 1
    v_lshl_or_b32 v241, v242, 2, v241
    v_xor_b32 v239, v239, v241
    v_lshrrev_b32 v241, 3, v239
    buffer_load_dwordx4 v234, s[40:43], s80 offen offset:3072 lds
    s_add_u32 s66, s66, 128
    s_cmp_eq_u32 s66, 2048
    s_cselect_b32 s66, 256, s66
    v_and_b32 v239, 7, v239
    v_lshlrev_b32 v239, 4, v239
    v_lshl_add_u32 v239, v241, 11, v239
    v_mul_lo_u32 v241, v240, s82
    v_add3_u32 v237, v241, v239, s77
    v_subrev_u32 v237, 2048, v237
    s_mov_b32 s44, s18
    s_mov_b32 s45, s19
    s_mov_b32 s46, 0x600000
    s_mov_b32 s47, 0x00020000
    s_add_u32 m0, s70, 0
    s_nop 0
    s_add_u32 s67, s67, 196608
    s_cmp_eq_u32 s67, 6291456
    s_cselect_b32 s67, 786432, s67
    buffer_load_dwordx4 v235, s[44:47], s67 offen lds
    buffer_load_dwordx4 v236, s[44:47], s67 offen offset:1024 lds
    buffer_load_dwordx4 v237, s[44:47], s67 offen offset:2048 lds
    s_mov_b32 s36, s32
    s_mov_b32 s37, s33
    s_mov_b32 s38, 0x2c00000
    s_mov_b32 s39, 0x00020000
    s_lshl_b32 s13, s2, 2
    s_add_u32 s13, s13, s4
    s_lshl_b32 s13, s13, 9
    s_add_u32 s13, s13, 0x2a00000
    s_mov_b32 s52, s30
    s_mov_b32 s53, s31
    s_mov_b32 s54, 0x100
    s_mov_b32 s55, 0x00020000
    s_or_b32 s3, s2, s4
    s_cmp_lg_u32 s3, 0
    s_cbranch_scc1 G1_nonon
    s_memrealtime s[98:99]
    v_cmp_eq_u32 vcc, 0, v255
    v_mov_b32 v239, 0x80000000
    s_waitcnt lgkmcnt(0)
    s_lshr_b64 s[98:99], s[98:99], 8
    s_or_b32 s98, s98, 0x80000000
    v_cndmask_b32 v239, v239, 0, vcc
    v_mov_b32 v252, s98
    v_mov_b32_e64 v253, 0
    buffer_atomic_cmpswap v[252:253], v239, s[52:55], 0 offen sc1
G1_nonon:
    s_lshr_b32 s60, s5, 2
    s_add_u32 m0, s70, 16384
    s_add_u32 s67, s67, 196608
    buffer_load_dwordx4 v235, s[44:47], s67 offen lds
    s_lshl_b32 s3, s60, 4
    s_xor_b32 s6, s6, s3
    s_bfe_u32 s61, s5, 0x10001
    s_lshl_b32 s61, s61, 3
    s_and_b32 s3, s6, 7
    s_add_u32 s61, s61, s3
    s_and_b32 s62, s5, 1
    buffer_load_dwordx4 v236, s[44:47], s67 offen offset:1024 lds
    s_lshl_b32 s62, s62, 2
    s_lshr_b32 s3, s6, 3
    s_add_u32 s62, s62, s3
    s_mov_b32 s12, 0x40000
    s_lshl_b32 s63, s61, 3
    s_add_u32 s63, s63, s62
    s_lshl_b32 s34, s63, 2
    s_add_u32 s34, s34, s4
    buffer_load_dwordx4 v237, s[44:47], s67 offen offset:2048 lds
    s_lshl_b32 s34, s34, 7
    s_add_u32 s34, s34, 0x2910000
    s_lshl_b32 s15, s7, 12
    s_lshl_b32 s3, s35, 7
    s_add_u32 s15, s15, s3
    s_add_u32 s15, s15, 0x2908000
    s_lshr_b32 s22, s35, 1
    s_lshl_b32 s22, s22, 10
    s_add_u32 m0, s68, s72
    s_add_u32 s80, s64, s66
    buffer_load_dwordx4 v231, s[40:43], s80 offen lds
    s_add_u32 s22, s22, 0x2900000
    s_lshr_b32 s23, s61, 1
    s_lshl_b32 s83, s23, 12
    s_add_u32 s83, s83, 0x2908000
    s_lshl_b32 s23, s23, 11
    s_add_u32 s23, s23, 0x2904000
    s_mov_b32 s84, 1
    s_mov_b32 s95, 0
    buffer_load_dwordx4 v232, s[40:43], s80 offen offset:1024 lds
    s_mov_b32 s56, s26
    s_mov_b32 s57, s27
    s_mov_b32 s58, 0x700000
    s_mov_b32 s59, 0x00020000
    v_lshrrev_b32 v239, 1, v251
    v_xor_b32 v239, v239, v250
    v_lshlrev_b32 v239, 4, v239
    v_lshl_add_u32 v239, v251, 7, v239
    buffer_load_dwordx4 v233, s[40:43], s80 offen offset:2048 lds
    s_lshl_b32 s3, s10, 14
    v_add_u32 v224, s3, v239
    v_xor_b32 v225, 64, v224
    v_mov_b32 v226, v224
    v_mov_b32 v227, v225
    v_lshrrev_b32 v239, 2, v251
    v_lshl_add_u32 v240, v250, 3, v239
    v_mul_u32_u24 v240, 384, v240
    buffer_load_dwordx4 v234, s[40:43], s80 offen offset:3072 lds
    v_and_b32_e64 v241, 3, v255
    v_lshl_add_u32 v240, v241, 3, v240
    v_add_u32 v240, 98304, v240
    v_and_b32 v241, 1, v250
    v_lshrrev_b32 v239, 1, v239
    v_lshl_or_b32 v239, v241, 1, v239
    s_lshl_b32 s3, s11, 1
    v_xor_b32 v242, s3, v239
    s_add_u32 m0, s70, 32768
    s_add_u32 s67, s67, 196608
    buffer_load_dwordx4 v235, s[44:47], s67 offen lds
    v_lshl_add_u32 v228, v242, 5, v240
    v_xor_b32_e64 v242, 1, v242
    v_lshl_add_u32 v229, v242, 5, v240
    s_lshl_b32 s14, s9, 10
    s_lshl_b32 s3, s7, 7
    s_add_u32 s14, s14, s3
    s_add_u32 s14, s14, 0x2900000
    v_lshrrev_b32 v239, 1, v251
    buffer_load_dwordx4 v236, s[44:47], s67 offen offset:1024 lds
    v_and_b32_e64 v240, 1, v251
    v_lshl_add_u32 v239, v239, 2, v240
    s_lshl_b32 s3, s11, 1
    v_add_u32 v239, s3, v239
    v_lshlrev_b32_e64 v243, 4, v250
    v_lshl_add_u32 v243, v239, 6, v243
    v_lshl_or_b32 v239, s10, 4, v251
    v_cmp_gt_u32 vcc, 6, v239
    buffer_load_dwordx4 v237, s[44:47], s67 offen offset:2048 lds
    v_mov_b32 v240, 0x80000000
    v_mov_b32 v241, 0x3f803f80
    v_cndmask_b32 v243, v240, v243, vcc
    v_cmp_eq_u32 vcc, 0, v251
    s_nop 1
    v_cndmask_b32 v242, 0, v241, vcc
    v_accvgpr_write_b32 a128, v242
    v_accvgpr_write_b32 a129, v242
    s_add_u32 m0, s69, s72
    s_add_u32 s80, s65, s66
    buffer_load_dwordx4 v231, s[40:43], s80 offen lds
    v_cmp_eq_u32 vcc, 1, v251
    v_accvgpr_write_b32 a130, v242
    v_accvgpr_write_b32 a131, v242
    v_cndmask_b32 v239, 0, v241, vcc
    v_accvgpr_write_b32 a132, v239
    v_accvgpr_write_b32 a133, v239
    v_cmp_eq_u32 vcc, 2, v251
    v_accvgpr_write_b32 a134, v239
    buffer_load_dwordx4 v232, s[40:43], s80 offen offset:1024 lds
    v_accvgpr_write_b32 a135, v239
    v_cndmask_b32 v242, 0, v241, vcc
    v_accvgpr_write_b32 a136, v242
    v_accvgpr_write_b32 a137, v242
    v_cmp_eq_u32 vcc, 3, v251
    v_accvgpr_write_b32 a138, v242
    v_accvgpr_write_b32 a139, v242
    v_cndmask_b32 v239, 0, v241, vcc
    buffer_load_dwordx4 v233, s[40:43], s80 offen offset:2048 lds
    s_add_u32 s72, s72, 0x8000
    s_cmp_eq_u32 s72, 0x18000
    s_cselect_b32 s72, 0, s72
    v_accvgpr_write_b32 a140, v239
    v_accvgpr_write_b32 a141, v239
    v_cmp_eq_u32 vcc, 4, v251
    v_accvgpr_write_b32 a142, v239
    v_accvgpr_write_b32 a143, v239
    v_cndmask_b32 v242, 0, v241, vcc
    v_accvgpr_write_b32 a144, v242
    v_accvgpr_write_b32 a145, v242
    buffer_load_dwordx4 v234, s[40:43], s80 offen offset:3072 lds
    s_add_u32 s66, s66, 128
    s_cmp_eq_u32 s66, 2048
    s_cselect_b32 s66, 256, s66
    v_cmp_eq_u32 vcc, 5, v251
    v_accvgpr_write_b32 a146, v242
    v_accvgpr_write_b32 a147, v242
    v_cndmask_b32 v239, 0, v241, vcc
    v_accvgpr_write_b32 a148, v239
    v_accvgpr_write_b32 a149, v239
    v_accvgpr_write_b32 a150, v239
    v_accvgpr_write_b32 a151, v239
    v_cmp_eq_u32 vcc, 0, v2
    v_lshlrev_b32 v4, 3, v1
    s_lshl_b32 s82, s76, 3
    v_cndmask_b32 v248, v240, v4, vcc
    s_add_u32 s82, s82, 0x2800000
    buffer_load_dwordx4 a[160:163], v3, s[40:43], s79 offen offset:0
    buffer_load_dwordx4 a[164:167], v3, s[40:43], s79 offen offset:512
    buffer_load_dwordx4 a[168:171], v3, s[40:43], s79 offen offset:1024
    buffer_load_dwordx4 a[172:175], v3, s[40:43], s79 offen offset:1536
    s_lshl_b32 s66, s78, 8
    s_waitcnt vmcnt(18)
    s_barrier
    s_nop 0
    ds_read_b64_tr_b16 a[32:33], v228 offset:0
    ds_read_b64_tr_b16 a[34:35], v228 offset:1536
    ds_read_b128 a[0:3], v226 offset:0
    ds_read_b64_tr_b16 a[36:37], v229 offset:0
    ds_read_b64_tr_b16 a[38:39], v229 offset:1536
    ds_read_b128 a[4:7], v226 offset:2048
    ds_read_b64_tr_b16 a[40:41], v228 offset:128
    ds_read_b64_tr_b16 a[42:43], v228 offset:1664
    ds_read_b128 a[8:11], v226 offset:4096
    ds_read_b64_tr_b16 a[44:45], v229 offset:128
    ds_read_b64_tr_b16 a[46:47], v229 offset:1664
    ds_read_b128 a[12:15], v226 offset:6144
    ds_read_b64_tr_b16 a[48:49], v228 offset:256
    ds_read_b64_tr_b16 a[50:51], v228 offset:1792
    ds_read_b128 a[16:19], v226 offset:8192
    ds_read_b64_tr_b16 a[52:53], v229 offset:256
    ds_read_b64_tr_b16 a[54:55], v229 offset:1792
    ds_read_b128 a[20:23], v226 offset:10240
    ds_read_b128 a[24:27], v226 offset:12288
    ds_read_b128 a[28:31], v226 offset:14336
    s_waitcnt vmcnt(15) lgkmcnt(0)
    s_barrier
    v_mfma_f32_16x16x32_bf16 v[0:3], a[32:35], a[0:3], 0
    ds_read_b64_tr_b16 a[96:97], v228 offset:16384
    ds_read_b64_tr_b16 a[98:99], v228 offset:17920
    v_mfma_f32_16x16x32_bf16 v[16:19], a[32:35], a[4:7], 0
    s_add_u32 m0, s70, 49152
    v_mfma_f32_16x16x32_bf16 v[32:35], a[32:35], a[8:11], 0
    s_add_u32 s67, s67, 196608
    v_mfma_f32_16x16x32_bf16 v[48:51], a[32:35], a[12:15], 0
    buffer_load_dwordx4 v235, s[44:47], s67 offen lds
    v_mfma_f32_16x16x32_bf16 v[64:67], a[32:35], a[16:19], 0
    ds_read_b128 a[64:67], v227 offset:0
    v_mfma_f32_16x16x32_bf16 v[80:83], a[32:35], a[20:23], 0
    ds_read_b64_tr_b16 a[100:101], v229 offset:16384
    v_mfma_f32_16x16x32_bf16 v[96:99], a[32:35], a[24:27], 0
    buffer_load_dwordx4 v236, s[44:47], s67 offen offset:1024 lds
    v_mfma_f32_16x16x32_bf16 v[112:115], a[32:35], a[28:31], 0
    ds_read_b64_tr_b16 a[102:103], v229 offset:17920
    v_mfma_f32_16x16x32_bf16 a[60:63], a[32:35], a[128:131], 0
    ds_read_b128 a[68:71], v227 offset:2048
    v_mfma_f32_16x16x32_bf16 v[116:119], a[36:39], a[28:31], 0
    buffer_load_dwordx4 v237, s[44:47], s67 offen offset:2048 lds
    v_mfma_f32_16x16x32_bf16 v[100:103], a[36:39], a[24:27], 0
    ds_read_b64_tr_b16 a[104:105], v228 offset:16512
    v_mfma_f32_16x16x32_bf16 v[84:87], a[36:39], a[20:23], 0
    ds_read_b64_tr_b16 a[106:107], v228 offset:18048
    v_mfma_f32_16x16x32_bf16 v[68:71], a[36:39], a[16:19], 0
    s_mul_i32 s67, s78, 786432
    v_mfma_f32_16x16x32_bf16 v[52:55], a[36:39], a[12:15], 0
    s_sub_u32 s67, s67, 196608
    v_mfma_f32_16x16x32_bf16 v[36:39], a[36:39], a[8:11], 0
    ds_read_b128 a[72:75], v227 offset:4096
    v_mfma_f32_16x16x32_bf16 v[20:23], a[36:39], a[4:7], 0
    ds_read_b64_tr_b16 a[108:109], v229 offset:16512
    v_mfma_f32_16x16x32_bf16 v[4:7], a[36:39], a[0:3], 0
    s_add_u32 m0, s68, s72
    v_mfma_f32_16x16x32_bf16 a[60:63], a[36:39], a[132:135], a[60:63]
    s_add_u32 s80, s64, s66
    v_mfma_f32_16x16x32_bf16 v[8:11], a[40:43], a[0:3], 0
    buffer_load_dwordx4 v231, s[40:43], s80 offen lds
    ds_read_b64_tr_b16 a[110:111], v229 offset:18048
    v_mfma_f32_16x16x32_bf16 v[24:27], a[40:43], a[4:7], 0
    ds_read_b128 a[76:79], v227 offset:6144
    v_mfma_f32_16x16x32_bf16 v[40:43], a[40:43], a[8:11], 0
    buffer_load_dwordx4 v232, s[40:43], s80 offen offset:1024 lds
    v_mfma_f32_16x16x32_bf16 v[56:59], a[40:43], a[12:15], 0
    ds_read_b64_tr_b16 a[112:113], v228 offset:16640
    v_mfma_f32_16x16x32_bf16 v[72:75], a[40:43], a[16:19], 0
    ds_read_b64_tr_b16 a[114:115], v228 offset:18176
    v_mfma_f32_16x16x32_bf16 v[88:91], a[40:43], a[20:23], 0
    buffer_load_dwordx4 v233, s[40:43], s80 offen offset:2048 lds
    v_mfma_f32_16x16x32_bf16 v[104:107], a[40:43], a[24:27], 0
    ds_read_b128 a[80:83], v227 offset:8192
    v_mfma_f32_16x16x32_bf16 v[120:123], a[40:43], a[28:31], 0
    ds_read_b64_tr_b16 a[116:117], v229 offset:16640
    v_mfma_f32_16x16x32_bf16 a[60:63], a[40:43], a[136:139], a[60:63]
    buffer_load_dwordx4 v234, s[40:43], s80 offen offset:3072 lds
    v_mfma_f32_16x16x32_bf16 v[124:127], a[44:47], a[28:31], 0
    ds_read_b64_tr_b16 a[118:119], v229 offset:18176
    v_mfma_f32_16x16x32_bf16 v[108:111], a[44:47], a[24:27], 0
    ds_read_b128 a[84:87], v227 offset:10240
    v_mfma_f32_16x16x32_bf16 v[92:95], a[44:47], a[20:23], 0
    s_add_u32 m0, s70, 0
    v_mfma_f32_16x16x32_bf16 v[76:79], a[44:47], a[16:19], 0
    s_add_u32 s67, s67, 196608
    v_mfma_f32_16x16x32_bf16 v[60:63], a[44:47], a[12:15], 0
    s_cmp_eq_u32 s67, 6291456
    v_mfma_f32_16x16x32_bf16 v[44:47], a[44:47], a[8:11], 0
    s_cselect_b32 s67, 786432, s67
    v_mfma_f32_16x16x32_bf16 v[28:31], a[44:47], a[4:7], 0
    buffer_load_dwordx4 v235, s[44:47], s67 offen lds
    v_mfma_f32_16x16x32_bf16 v[12:15], a[44:47], a[0:3], 0
    ds_read_b128 a[88:91], v227 offset:12288
    v_mfma_f32_16x16x32_bf16 a[60:63], a[44:47], a[140:143], a[60:63]
    ds_read_b128 a[92:95], v227 offset:14336
    v_mfma_f32_16x16x32_bf16 v[128:131], a[0:3], a[48:51], 0
    buffer_load_dwordx4 v236, s[44:47], s67 offen offset:1024 lds
    buffer_load_dwordx4 v237, s[44:47], s67 offen offset:2048 lds
    v_mfma_f32_16x16x32_bf16 v[132:135], a[4:7], a[48:51], 0
    s_add_u32 m0, s69, s72
    v_mfma_f32_16x16x32_bf16 v[144:147], a[8:11], a[48:51], 0
    s_add_u32 s80, s65, s66
    v_mfma_f32_16x16x32_bf16 v[148:151], a[12:15], a[48:51], 0
    buffer_load_dwordx4 v231, s[40:43], s80 offen lds
    v_mfma_f32_16x16x32_bf16 v[160:163], a[16:19], a[48:51], 0
    buffer_load_dwordx4 v232, s[40:43], s80 offen offset:1024 lds
    v_mfma_f32_16x16x32_bf16 v[164:167], a[20:23], a[48:51], 0
    buffer_load_dwordx4 v233, s[40:43], s80 offen offset:2048 lds
    v_mfma_f32_16x16x32_bf16 v[176:179], a[24:27], a[48:51], 0
    s_add_u32 s72, s72, 0x8000
    v_mfma_f32_16x16x32_bf16 v[180:183], a[28:31], a[48:51], 0
    s_cmp_eq_u32 s72, 0x18000
    v_mfma_f32_16x16x32_bf16 a[60:63], a[48:51], a[144:147], a[60:63]
    s_cselect_b32 s72, 0, s72
    v_mfma_f32_16x16x32_bf16 v[188:191], a[28:31], a[52:55], 0
    buffer_load_dwordx4 v234, s[40:43], s80 offen offset:3072 lds
    v_mfma_f32_16x16x32_bf16 v[184:187], a[24:27], a[52:55], 0
    s_add_u32 s66, s66, 128
    v_mfma_f32_16x16x32_bf16 v[172:175], a[20:23], a[52:55], 0
    s_cmp_eq_u32 s66, 2048
    v_mfma_f32_16x16x32_bf16 v[168:171], a[16:19], a[52:55], 0
    s_cselect_b32 s66, 256, s66
    v_mfma_f32_16x16x32_bf16 v[156:159], a[12:15], a[52:55], 0
    s_add_u32 s73, s73, 0x8000
    v_mfma_f32_16x16x32_bf16 v[152:155], a[8:11], a[52:55], 0
    s_cmp_eq_u32 s73, 0x18000
    v_mfma_f32_16x16x32_bf16 v[140:143], a[4:7], a[52:55], 0
    s_cselect_b32 s73, 0, s73
    v_mfma_f32_16x16x32_bf16 v[136:139], a[0:3], a[52:55], 0
    v_add_u32 v226, s73, v224
    v_mfma_f32_16x16x32_bf16 a[60:63], a[52:55], a[148:151], a[60:63]
    v_add_u32 v227, s73, v225
    s_waitcnt vmcnt(18) lgkmcnt(0)
    s_barrier
    v_mfma_f32_16x16x32_bf16 v[0:3], a[96:99], a[64:67], v[0:3]
    ds_read_b64_tr_b16 a[32:33], v228 offset:32768
    v_mfma_f32_16x16x32_bf16 v[16:19], a[96:99], a[68:71], v[16:19]
    ds_read_b64_tr_b16 a[34:35], v228 offset:34304
    v_mfma_f32_16x16x32_bf16 v[32:35], a[96:99], a[72:75], v[32:35]
    ds_read_b128 a[0:3], v226 offset:0
    v_mfma_f32_16x16x32_bf16 v[48:51], a[96:99], a[76:79], v[48:51]
    ds_read_b64_tr_b16 a[36:37], v229 offset:32768
    v_mfma_f32_16x16x32_bf16 v[64:67], a[96:99], a[80:83], v[64:67]
    s_add_u32 m0, s70, 16384
    v_mfma_f32_16x16x32_bf16 v[80:83], a[96:99], a[84:87], v[80:83]
    s_add_u32 s67, s67, 196608
    v_mfma_f32_16x16x32_bf16 v[96:99], a[96:99], a[88:91], v[96:99]
    buffer_load_dwordx4 v235, s[44:47], s67 offen lds
    v_mfma_f32_16x16x32_bf16 v[112:115], a[96:99], a[92:95], v[112:115]
    ds_read_b64_tr_b16 a[38:39], v229 offset:34304
    v_mfma_f32_16x16x32_bf16 a[60:63], a[96:99], a[128:131], a[60:63]
    ds_read_b128 a[4:7], v226 offset:2048
    v_mfma_f32_16x16x32_bf16 v[116:119], a[100:103], a[92:95], v[116:119]
    ds_read_b64_tr_b16 a[40:41], v228 offset:32896
    v_mfma_f32_16x16x32_bf16 v[100:103], a[100:103], a[88:91], v[100:103]
    v_mfma_f32_16x16x32_bf16 v[84:87], a[100:103], a[84:87], v[84:87]
    ds_read_b64_tr_b16 a[42:43], v228 offset:34432
    v_mfma_f32_16x16x32_bf16 v[68:71], a[100:103], a[80:83], v[68:71]
    buffer_load_dwordx4 v236, s[44:47], s67 offen offset:1024 lds
    v_mfma_f32_16x16x32_bf16 v[52:55], a[100:103], a[76:79], v[52:55]
    ds_read_b128 a[8:11], v226 offset:4096
    v_mfma_f32_16x16x32_bf16 v[36:39], a[100:103], a[72:75], v[36:39]
    ds_read_b64_tr_b16 a[44:45], v229 offset:32896
    v_mfma_f32_16x16x32_bf16 v[20:23], a[100:103], a[68:71], v[20:23]
    ds_read_b64_tr_b16 a[46:47], v229 offset:34432
    v_mfma_f32_16x16x32_bf16 v[4:7], a[100:103], a[64:67], v[4:7]
    ds_read_b128 a[12:15], v226 offset:6144
    v_mfma_f32_16x16x32_bf16 a[60:63], a[100:103], a[132:135], a[60:63]
    buffer_load_dwordx4 v237, s[44:47], s67 offen offset:2048 lds
    v_mfma_f32_16x16x32_bf16 v[8:11], a[104:107], a[64:67], v[8:11]
    ds_read_b64_tr_b16 a[48:49], v228 offset:33024
    v_mfma_f32_16x16x32_bf16 v[24:27], a[104:107], a[68:71], v[24:27]
    ds_read_b64_tr_b16 a[50:51], v228 offset:34560
    v_mfma_f32_16x16x32_bf16 v[40:43], a[104:107], a[72:75], v[40:43]
    ds_read_b128 a[16:19], v226 offset:8192
    v_mfma_f32_16x16x32_bf16 v[56:59], a[104:107], a[76:79], v[56:59]
    v_mfma_f32_16x16x32_bf16 v[72:75], a[104:107], a[80:83], v[72:75]
    ds_read_b64_tr_b16 a[52:53], v229 offset:33024
    v_mfma_f32_16x16x32_bf16 v[88:91], a[104:107], a[84:87], v[88:91]
    s_add_u32 m0, s68, s72
    v_mfma_f32_16x16x32_bf16 v[104:107], a[104:107], a[88:91], v[104:107]
    s_add_u32 s80, s64, s66
    v_mfma_f32_16x16x32_bf16 v[120:123], a[104:107], a[92:95], v[120:123]
    buffer_load_dwordx4 v231, s[40:43], s80 offen lds
    v_mfma_f32_16x16x32_bf16 a[60:63], a[104:107], a[136:139], a[60:63]
    ds_read_b64_tr_b16 a[54:55], v229 offset:34560
    v_mfma_f32_16x16x32_bf16 v[124:127], a[108:111], a[92:95], v[124:127]
    ds_read_b128 a[20:23], v226 offset:10240
    v_mfma_f32_16x16x32_bf16 v[108:111], a[108:111], a[88:91], v[108:111]
    ds_read_b128 a[24:27], v226 offset:12288
    v_mfma_f32_16x16x32_bf16 v[92:95], a[108:111], a[84:87], v[92:95]
    ds_read_b128 a[28:31], v226 offset:14336
    v_mfma_f32_16x16x32_bf16 v[76:79], a[108:111], a[80:83], v[76:79]
    buffer_load_dwordx4 v232, s[40:43], s80 offen offset:1024 lds
    v_mfma_f32_16x16x32_bf16 v[60:63], a[108:111], a[76:79], v[60:63]
    buffer_load_dwordx4 v233, s[40:43], s80 offen offset:2048 lds
    v_mfma_f32_16x16x32_bf16 v[44:47], a[108:111], a[72:75], v[44:47]
    v_mfma_f32_16x16x32_bf16 v[28:31], a[108:111], a[68:71], v[28:31]
    buffer_load_dwordx4 v234, s[40:43], s80 offen offset:3072 lds
    v_mfma_f32_16x16x32_bf16 v[12:15], a[108:111], a[64:67], v[12:15]
    s_lshl_b32 s76, s9, 3
    v_mfma_f32_16x16x32_bf16 a[60:63], a[108:111], a[140:143], a[60:63]
    s_add_u32 s81, s7, s76
    v_mfma_f32_16x16x32_bf16 v[128:131], a[64:67], a[112:115], v[128:131]
    s_lshl_b32 s81, s81, 10
    v_mfma_f32_16x16x32_bf16 v[132:135], a[68:71], a[112:115], v[132:135]
    s_add_u32 s81, s81, 0x2810000
    v_mfma_f32_16x16x32_bf16 v[144:147], a[72:75], a[112:115], v[144:147]
    s_cmp_eq_u32 s7, 7
    v_mfma_f32_16x16x32_bf16 v[148:151], a[76:79], a[112:115], v[148:151]
    s_cselect_b32 s76, s81, 0x40000000
    v_mfma_f32_16x16x32_bf16 v[160:163], a[80:83], a[112:115], v[160:163]
    s_cselect_b32 s81, 0x40000000, s81
    v_mfma_f32_16x16x32_bf16 v[164:167], a[84:87], a[112:115], v[164:167]
    s_lshl_b32 s3, s7, 5
    v_mfma_f32_16x16x32_bf16 v[176:179], a[88:91], a[112:115], v[176:179]
    v_add_u32_e64 v249, s3, v255
    v_mfma_f32_16x16x32_bf16 v[180:183], a[92:95], a[112:115], v[180:183]
    v_mfma_f32_16x16x32_bf16 a[60:63], a[112:115], a[144:147], a[60:63]
    v_and_b32_e64 v245, 7, v255
    v_mfma_f32_16x16x32_bf16 v[188:191], a[92:95], a[116:119], v[188:191]
    v_cmp_gt_u32 vcc, 32, v255
    v_mfma_f32_16x16x32_bf16 v[184:187], a[88:91], a[116:119], v[184:187]
    v_lshl_add_u32 v245, v245, 5, s35
    v_mfma_f32_16x16x32_bf16 v[172:175], a[84:87], a[116:119], v[172:175]
    s_mov_b32 s75, 0x2920000
    v_mfma_f32_16x16x32_bf16 v[168:171], a[80:83], a[116:119], v[168:171]
    v_cndmask_b32 v249, v245, v249, vcc
    v_mfma_f32_16x16x32_bf16 v[156:159], a[76:79], a[116:119], v[156:159]
    v_lshlrev_b32_e64 v249, 7, v249
    v_mfma_f32_16x16x32_bf16 v[152:155], a[72:75], a[116:119], v[152:155]
    v_lshlrev_b32_e64 v245, 7, v255
    v_mfma_f32_16x16x32_bf16 v[140:143], a[68:71], a[116:119], v[140:143]
    s_lshl_b32 s74, s4, 13
    v_mfma_f32_16x16x32_bf16 v[136:139], a[64:67], a[116:119], v[136:139]
    s_add_u32 s74, s74, G1_qkv_post-parallel_sum__softmax_full_mha__dense_activation_relu__prompt_kernel
    v_mfma_f32_16x16x32_bf16 a[60:63], a[116:119], a[148:151], a[60:63]
    s_waitcnt vmcnt(14) lgkmcnt(0)
    s_barrier
    v_mfma_f32_16x16x32_bf16 v[0:3], a[32:35], a[0:3], v[0:3]
    ds_read_b64_tr_b16 a[96:97], v228 offset:49152
    ds_read_b64_tr_b16 a[98:99], v228 offset:50688
    v_mfma_f32_16x16x32_bf16 v[16:19], a[32:35], a[4:7], v[16:19]
    ds_read_b128 a[64:67], v227 offset:0
    v_mfma_f32_16x16x32_bf16 v[32:35], a[32:35], a[8:11], v[32:35]
    ds_read_b64_tr_b16 a[100:101], v229 offset:49152
    v_mfma_f32_16x16x32_bf16 v[48:51], a[32:35], a[12:15], v[48:51]
    s_add_u32 m0, s70, 32768
    v_mfma_f32_16x16x32_bf16 v[64:67], a[32:35], a[16:19], v[64:67]
    s_add_u32 s67, s67, 196608
    v_mfma_f32_16x16x32_bf16 v[80:83], a[32:35], a[20:23], v[80:83]
    buffer_load_dwordx4 v235, s[44:47], s67 offen lds
    v_mfma_f32_16x16x32_bf16 v[96:99], a[32:35], a[24:27], v[96:99]
    ds_read_b64_tr_b16 a[102:103], v229 offset:50688
    v_mfma_f32_16x16x32_bf16 v[112:115], a[32:35], a[28:31], v[112:115]
    ds_read_b128 a[68:71], v227 offset:2048
    v_mfma_f32_16x16x32_bf16 a[60:63], a[32:35], a[128:131], a[60:63]
    ds_read_b64_tr_b16 a[104:105], v228 offset:49280
    v_mfma_f32_16x16x32_bf16 v[116:119], a[36:39], a[28:31], v[116:119]
    ds_read_b64_tr_b16 a[106:107], v228 offset:50816
    v_mfma_f32_16x16x32_bf16 v[100:103], a[36:39], a[24:27], v[100:103]
    buffer_load_dwordx4 v236, s[44:47], s67 offen offset:1024 lds
    v_mfma_f32_16x16x32_bf16 v[84:87], a[36:39], a[20:23], v[84:87]
    ds_read_b128 a[72:75], v227 offset:4096
    v_mfma_f32_16x16x32_bf16 v[68:71], a[36:39], a[16:19], v[68:71]
    ds_read_b64_tr_b16 a[108:109], v229 offset:49280
    v_mfma_f32_16x16x32_bf16 v[52:55], a[36:39], a[12:15], v[52:55]
    ds_read_b64_tr_b16 a[110:111], v229 offset:50816
    v_mfma_f32_16x16x32_bf16 v[36:39], a[36:39], a[8:11], v[36:39]
    ds_read_b128 a[76:79], v227 offset:6144
    v_mfma_f32_16x16x32_bf16 v[20:23], a[36:39], a[4:7], v[20:23]
    buffer_load_dwordx4 v237, s[44:47], s67 offen offset:2048 lds
    v_mfma_f32_16x16x32_bf16 v[4:7], a[36:39], a[0:3], v[4:7]
    ds_read_b64_tr_b16 a[112:113], v228 offset:49408
    v_mfma_f32_16x16x32_bf16 a[60:63], a[36:39], a[132:135], a[60:63]
    ds_read_b64_tr_b16 a[114:115], v228 offset:50944
    v_mfma_f32_16x16x32_bf16 v[8:11], a[40:43], a[0:3], v[8:11]
    ds_read_b128 a[80:83], v227 offset:8192
    v_mfma_f32_16x16x32_bf16 v[24:27], a[40:43], a[4:7], v[24:27]
    ds_read_b64_tr_b16 a[116:117], v229 offset:49408
    v_mfma_f32_16x16x32_bf16 v[40:43], a[40:43], a[8:11], v[40:43]
    s_add_u32 m0, s69, s72
    v_mfma_f32_16x16x32_bf16 v[56:59], a[40:43], a[12:15], v[56:59]
    s_add_u32 s80, s65, s66
    v_mfma_f32_16x16x32_bf16 v[72:75], a[40:43], a[16:19], v[72:75]
    buffer_load_dwordx4 v231, s[40:43], s80 offen lds
    v_mfma_f32_16x16x32_bf16 v[88:91], a[40:43], a[20:23], v[88:91]
    ds_read_b64_tr_b16 a[118:119], v229 offset:50944
    v_mfma_f32_16x16x32_bf16 v[104:107], a[40:43], a[24:27], v[104:107]
    ds_read_b128 a[84:87], v227 offset:10240
    v_mfma_f32_16x16x32_bf16 v[120:123], a[40:43], a[28:31], v[120:123]
    ds_read_b128 a[88:91], v227 offset:12288
    v_mfma_f32_16x16x32_bf16 a[60:63], a[40:43], a[136:139], a[60:63]
    ds_read_b128 a[92:95], v227 offset:14336
    v_mfma_f32_16x16x32_bf16 v[124:127], a[44:47], a[28:31], v[124:127]
    buffer_load_dwordx4 v232, s[40:43], s80 offen offset:1024 lds
    buffer_load_dwordx4 v233, s[40:43], s80 offen offset:2048 lds
    v_mfma_f32_16x16x32_bf16 v[108:111], a[44:47], a[24:27], v[108:111]
    s_add_u32 s72, s72, 0x8000
    v_mfma_f32_16x16x32_bf16 v[92:95], a[44:47], a[20:23], v[92:95]
    s_cmp_eq_u32 s72, 0x18000
    v_mfma_f32_16x16x32_bf16 v[76:79], a[44:47], a[16:19], v[76:79]
    s_cselect_b32 s72, 0, s72
    v_mfma_f32_16x16x32_bf16 v[60:63], a[44:47], a[12:15], v[60:63]
    buffer_load_dwordx4 v234, s[40:43], s80 offen offset:3072 lds
    v_mfma_f32_16x16x32_bf16 v[44:47], a[44:47], a[8:11], v[44:47]
    s_add_u32 s66, s66, 128
    v_mfma_f32_16x16x32_bf16 v[28:31], a[44:47], a[4:7], v[28:31]
    s_cmp_eq_u32 s66, 2048
    v_mfma_f32_16x16x32_bf16 v[12:15], a[44:47], a[0:3], v[12:15]
    s_cselect_b32 s66, 256, s66
    v_mfma_f32_16x16x32_bf16 a[60:63], a[44:47], a[140:143], a[60:63]
    s_add_u32 s73, s73, 0x8000
    v_mfma_f32_16x16x32_bf16 v[128:131], a[0:3], a[48:51], v[128:131]
    s_cmp_eq_u32 s73, 0x18000
    v_mfma_f32_16x16x32_bf16 v[132:135], a[4:7], a[48:51], v[132:135]
    s_cselect_b32 s73, 0, s73
    v_mfma_f32_16x16x32_bf16 v[144:147], a[8:11], a[48:51], v[144:147]
    v_add_u32 v226, s73, v224
    v_mfma_f32_16x16x32_bf16 v[148:151], a[12:15], a[48:51], v[148:151]
    v_add_u32_e64 v227, s73, v225
    v_mfma_f32_16x16x32_bf16 v[160:163], a[16:19], a[48:51], v[160:163]
    v_accvgpr_read_b32 v239, a160
    v_mfma_f32_16x16x32_bf16 v[164:167], a[20:23], a[48:51], v[164:167]
    v_accvgpr_read_b32 v240, a161
    v_mfma_f32_16x16x32_bf16 v[176:179], a[24:27], a[48:51], v[176:179]
    v_dot2_f32_bf16 v246, v239, v241, 0
    v_mfma_f32_16x16x32_bf16 v[180:183], a[28:31], a[48:51], v[180:183]
    v_dot2_f32_bf16 v247, v239, v239, 0
    v_mfma_f32_16x16x32_bf16 a[60:63], a[48:51], a[144:147], a[60:63]
    v_accvgpr_read_b32 v239, a162
    v_mfma_f32_16x16x32_bf16 v[188:191], a[28:31], a[52:55], v[188:191]
    v_dot2_f32_bf16 v246, v240, v241, v246
    v_mfma_f32_16x16x32_bf16 v[184:187], a[24:27], a[52:55], v[184:187]
    v_dot2_f32_bf16 v247, v240, v240, v247
    v_mfma_f32_16x16x32_bf16 v[172:175], a[20:23], a[52:55], v[172:175]
    v_accvgpr_read_b32 v240, a163
    v_mfma_f32_16x16x32_bf16 v[168:171], a[16:19], a[52:55], v[168:171]
    v_dot2_f32_bf16 v246, v239, v241, v246
    v_mfma_f32_16x16x32_bf16 v[156:159], a[12:15], a[52:55], v[156:159]
    v_dot2_f32_bf16 v247, v239, v239, v247
    v_mfma_f32_16x16x32_bf16 v[152:155], a[8:11], a[52:55], v[152:155]
    v_accvgpr_read_b32 v239, a164
    v_mfma_f32_16x16x32_bf16 v[140:143], a[4:7], a[52:55], v[140:143]
    v_dot2_f32_bf16 v246, v240, v241, v246
    v_mfma_f32_16x16x32_bf16 v[136:139], a[0:3], a[52:55], v[136:139]
    v_dot2_f32_bf16 v247, v240, v240, v247
    v_mfma_f32_16x16x32_bf16 a[60:63], a[52:55], a[148:151], a[60:63]
    v_accvgpr_read_b32 v240, a165
    s_waitcnt vmcnt(14) lgkmcnt(0)
    s_barrier
    v_mfma_f32_16x16x32_bf16 v[0:3], a[96:99], a[64:67], v[0:3]
    ds_read_b64_tr_b16 a[32:33], v228 offset:0
    v_mfma_f32_16x16x32_bf16 v[16:19], a[96:99], a[68:71], v[16:19]
    ds_read_b64_tr_b16 a[34:35], v228 offset:1536
    v_mfma_f32_16x16x32_bf16 v[32:35], a[96:99], a[72:75], v[32:35]
    ds_read_b128 a[0:3], v226 offset:0
    v_mfma_f32_16x16x32_bf16 v[48:51], a[96:99], a[76:79], v[48:51]
    ds_read_b64_tr_b16 a[36:37], v229 offset:0
    v_mfma_f32_16x16x32_bf16 v[64:67], a[96:99], a[80:83], v[64:67]
    s_add_u32 m0, s70, 49152
    v_mfma_f32_16x16x32_bf16 v[80:83], a[96:99], a[84:87], v[80:83]
    v_mfma_f32_16x16x32_bf16 v[96:99], a[96:99], a[88:91], v[96:99]
    s_add_u32 s67, s67, 196608
    v_mfma_f32_16x16x32_bf16 v[112:115], a[96:99], a[92:95], v[112:115]
    buffer_load_dwordx4 v235, s[44:47], s67 offen lds
    v_mfma_f32_16x16x32_bf16 a[60:63], a[96:99], a[128:131], a[60:63]
    ds_read_b64_tr_b16 a[38:39], v229 offset:1536
    v_mfma_f32_16x16x32_bf16 v[116:119], a[100:103], a[92:95], v[116:119]
    ds_read_b128 a[4:7], v226 offset:2048
    v_mfma_f32_16x16x32_bf16 v[100:103], a[100:103], a[88:91], v[100:103]
    ds_read_b64_tr_b16 a[40:41], v228 offset:128
    v_mfma_f32_16x16x32_bf16 v[84:87], a[100:103], a[84:87], v[84:87]
    v_mfma_f32_16x16x32_bf16 v[68:71], a[100:103], a[80:83], v[68:71]
    ds_read_b64_tr_b16 a[42:43], v228 offset:1664
    v_mfma_f32_16x16x32_bf16 v[52:55], a[100:103], a[76:79], v[52:55]
    buffer_load_dwordx4 v236, s[44:47], s67 offen offset:1024 lds
    v_mfma_f32_16x16x32_bf16 v[36:39], a[100:103], a[72:75], v[36:39]
    ds_read_b128 a[8:11], v226 offset:4096
    v_mfma_f32_16x16x32_bf16 v[20:23], a[100:103], a[68:71], v[20:23]
    ds_read_b64_tr_b16 a[44:45], v229 offset:128
    v_mfma_f32_16x16x32_bf16 v[4:7], a[100:103], a[64:67], v[4:7]
    ds_read_b64_tr_b16 a[46:47], v229 offset:1664
    v_mfma_f32_16x16x32_bf16 a[60:63], a[100:103], a[132:135], a[60:63]
    v_mfma_f32_16x16x32_bf16 v[8:11], a[104:107], a[64:67], v[8:11]
    ds_read_b128 a[12:15], v226 offset:6144
    v_mfma_f32_16x16x32_bf16 v[24:27], a[104:107], a[68:71], v[24:27]
    buffer_load_dwordx4 v237, s[44:47], s67 offen offset:2048 lds
    v_mfma_f32_16x16x32_bf16 v[40:43], a[104:107], a[72:75], v[40:43]
    ds_read_b64_tr_b16 a[48:49], v228 offset:256
    v_mfma_f32_16x16x32_bf16 v[56:59], a[104:107], a[76:79], v[56:59]
    ds_read_b64_tr_b16 a[50:51], v228 offset:1792
    v_mfma_f32_16x16x32_bf16 v[72:75], a[104:107], a[80:83], v[72:75]
    ds_read_b128 a[16:19], v226 offset:8192
    v_mfma_f32_16x16x32_bf16 v[88:91], a[104:107], a[84:87], v[88:91]
    v_mfma_f32_16x16x32_bf16 v[104:107], a[104:107], a[88:91], v[104:107]
    ds_read_b64_tr_b16 a[52:53], v229 offset:256
    v_mfma_f32_16x16x32_bf16 v[120:123], a[104:107], a[92:95], v[120:123]
    s_add_u32 m0, s68, s72
    v_mfma_f32_16x16x32_bf16 a[60:63], a[104:107], a[136:139], a[60:63]
    s_add_u32 s80, s64, s66
    v_mfma_f32_16x16x32_bf16 v[124:127], a[108:111], a[92:95], v[124:127]
    buffer_load_dwordx4 v231, s[40:43], s80 offen lds
    v_mfma_f32_16x16x32_bf16 v[108:111], a[108:111], a[88:91], v[108:111]
    ds_read_b64_tr_b16 a[54:55], v229 offset:1792
    v_mfma_f32_16x16x32_bf16 v[92:95], a[108:111], a[84:87], v[92:95]
    v_mfma_f32_16x16x32_bf16 v[76:79], a[108:111], a[80:83], v[76:79]
    ds_read_b128 a[20:23], v226 offset:10240
    v_mfma_f32_16x16x32_bf16 v[60:63], a[108:111], a[76:79], v[60:63]
    ds_read_b128 a[24:27], v226 offset:12288
    v_mfma_f32_16x16x32_bf16 v[44:47], a[108:111], a[72:75], v[44:47]
    ds_read_b128 a[28:31], v226 offset:14336
    v_mfma_f32_16x16x32_bf16 v[28:31], a[108:111], a[68:71], v[28:31]
    buffer_load_dwordx4 v232, s[40:43], s80 offen offset:1024 lds
    v_mfma_f32_16x16x32_bf16 v[12:15], a[108:111], a[64:67], v[12:15]
    buffer_load_dwordx4 v233, s[40:43], s80 offen offset:2048 lds
    v_mfma_f32_16x16x32_bf16 a[60:63], a[108:111], a[140:143], a[60:63]
    v_mfma_f32_16x16x32_bf16 v[128:131], a[64:67], a[112:115], v[128:131]
    buffer_load_dwordx4 v234, s[40:43], s80 offen offset:3072 lds
    v_mfma_f32_16x16x32_bf16 v[132:135], a[68:71], a[112:115], v[132:135]
    v_dot2_f32_bf16 v246, v239, v241, v246
    v_mfma_f32_16x16x32_bf16 v[144:147], a[72:75], a[112:115], v[144:147]
    v_dot2_f32_bf16 v247, v239, v239, v247
    v_mfma_f32_16x16x32_bf16 v[148:151], a[76:79], a[112:115], v[148:151]
    v_accvgpr_read_b32 v239, a166
    v_mfma_f32_16x16x32_bf16 v[160:163], a[80:83], a[112:115], v[160:163]
    v_dot2_f32_bf16 v246, v240, v241, v246
    v_mfma_f32_16x16x32_bf16 v[164:167], a[84:87], a[112:115], v[164:167]
    v_mfma_f32_16x16x32_bf16 v[176:179], a[88:91], a[112:115], v[176:179]
    v_dot2_f32_bf16 v247, v240, v240, v247
    v_mfma_f32_16x16x32_bf16 v[180:183], a[92:95], a[112:115], v[180:183]
    v_accvgpr_read_b32 v240, a167
    v_mfma_f32_16x16x32_bf16 a[60:63], a[112:115], a[144:147], a[60:63]
    v_dot2_f32_bf16 v246, v239, v241, v246
    v_mfma_f32_16x16x32_bf16 v[188:191], a[92:95], a[116:119], v[188:191]
    v_dot2_f32_bf16 v247, v239, v239, v247
    v_mfma_f32_16x16x32_bf16 v[184:187], a[88:91], a[116:119], v[184:187]
    v_accvgpr_read_b32 v239, a168
    v_mfma_f32_16x16x32_bf16 v[172:175], a[84:87], a[116:119], v[172:175]
    v_mfma_f32_16x16x32_bf16 v[168:171], a[80:83], a[116:119], v[168:171]
    v_dot2_f32_bf16 v246, v240, v241, v246
    v_mfma_f32_16x16x32_bf16 v[156:159], a[76:79], a[116:119], v[156:159]
    v_dot2_f32_bf16 v247, v240, v240, v247
    v_mfma_f32_16x16x32_bf16 v[152:155], a[72:75], a[116:119], v[152:155]
    v_accvgpr_read_b32 v240, a169
    v_mfma_f32_16x16x32_bf16 v[140:143], a[68:71], a[116:119], v[140:143]
    v_dot2_f32_bf16 v246, v239, v241, v246
    v_mfma_f32_16x16x32_bf16 v[136:139], a[64:67], a[116:119], v[136:139]
    v_dot2_f32_bf16 v247, v239, v239, v247
    v_mfma_f32_16x16x32_bf16 a[60:63], a[116:119], a[148:151], a[60:63]
    s_waitcnt vmcnt(14) lgkmcnt(0)
    s_barrier
    v_mfma_f32_16x16x32_bf16 v[0:3], a[32:35], a[0:3], v[0:3]
    ds_read_b64_tr_b16 a[96:97], v228 offset:16384
    ds_read_b64_tr_b16 a[98:99], v228 offset:17920
    v_mfma_f32_16x16x32_bf16 v[16:19], a[32:35], a[4:7], v[16:19]
    ds_read_b128 a[64:67], v227 offset:0
    v_mfma_f32_16x16x32_bf16 v[32:35], a[32:35], a[8:11], v[32:35]
    ds_read_b64_tr_b16 a[100:101], v229 offset:16384
    v_mfma_f32_16x16x32_bf16 v[48:51], a[32:35], a[12:15], v[48:51]
    s_add_u32 m0, s70, 0
    v_mfma_f32_16x16x32_bf16 v[64:67], a[32:35], a[16:19], v[64:67]
    s_add_u32 s67, s67, 196608
    v_mfma_f32_16x16x32_bf16 v[80:83], a[32:35], a[20:23], v[80:83]
    s_cmp_eq_u32 s67, 6291456
    v_mfma_f32_16x16x32_bf16 v[96:99], a[32:35], a[24:27], v[96:99]
    s_cselect_b32 s67, 786432, s67
    v_mfma_f32_16x16x32_bf16 v[112:115], a[32:35], a[28:31], v[112:115]
    buffer_load_dwordx4 v235, s[44:47], s67 offen lds
    v_mfma_f32_16x16x32_bf16 a[124:127], a[32:35], a[128:131], 0
    ds_read_b64_tr_b16 a[102:103], v229 offset:17920
    v_mfma_f32_16x16x32_bf16 v[116:119], a[36:39], a[28:31], v[116:119]
    ds_read_b128 a[68:71], v227 offset:2048
    v_mfma_f32_16x16x32_bf16 v[100:103], a[36:39], a[24:27], v[100:103]
    ds_read_b64_tr_b16 a[104:105], v228 offset:16512
    v_mfma_f32_16x16x32_bf16 v[84:87], a[36:39], a[20:23], v[84:87]
    ds_read_b64_tr_b16 a[106:107], v228 offset:18048
    v_mfma_f32_16x16x32_bf16 v[68:71], a[36:39], a[16:19], v[68:71]
    buffer_load_dwordx4 v236, s[44:47], s67 offen offset:1024 lds
    v_mfma_f32_16x16x32_bf16 v[52:55], a[36:39], a[12:15], v[52:55]
    ds_read_b128 a[72:75], v227 offset:4096
    ds_read_b64_tr_b16 a[108:109], v229 offset:16512
    v_mfma_f32_16x16x32_bf16 v[36:39], a[36:39], a[8:11], v[36:39]
    ds_read_b64_tr_b16 a[110:111], v229 offset:18048
    v_mfma_f32_16x16x32_bf16 v[20:23], a[36:39], a[4:7], v[20:23]
    ds_read_b128 a[76:79], v227 offset:6144
    v_mfma_f32_16x16x32_bf16 v[4:7], a[36:39], a[0:3], v[4:7]
    buffer_load_dwordx4 v237, s[44:47], s67 offen offset:2048 lds
    v_mfma_f32_16x16x32_bf16 a[124:127], a[36:39], a[132:135], a[124:127]
    ds_read_b64_tr_b16 a[112:113], v228 offset:16640
    v_mfma_f32_16x16x32_bf16 v[8:11], a[40:43], a[0:3], v[8:11]
    ds_read_b64_tr_b16 a[114:115], v228 offset:18176
    v_mfma_f32_16x16x32_bf16 v[24:27], a[40:43], a[4:7], v[24:27]
    ds_read_b128 a[80:83], v227 offset:8192
    v_mfma_f32_16x16x32_bf16 v[40:43], a[40:43], a[8:11], v[40:43]
    ds_read_b64_tr_b16 a[116:117], v229 offset:16640
    v_mfma_f32_16x16x32_bf16 v[56:59], a[40:43], a[12:15], v[56:59]
    s_add_u32 m0, s69, s72
    v_mfma_f32_16x16x32_bf16 v[72:75], a[40:43], a[16:19], v[72:75]
    s_add_u32 s80, s65, s66
    v_mfma_f32_16x16x32_bf16 v[88:91], a[40:43], a[20:23], v[88:91]
    buffer_load_dwordx4 v231, s[40:43], s80 offen lds
    v_mfma_f32_16x16x32_bf16 v[104:107], a[40:43], a[24:27], v[104:107]
    ds_read_b64_tr_b16 a[118:119], v229 offset:18176
    v_mfma_f32_16x16x32_bf16 v[120:123], a[40:43], a[28:31], v[120:123]
    ds_read_b128 a[84:87], v227 offset:10240
    v_mfma_f32_16x16x32_bf16 a[124:127], a[40:43], a[136:139], a[124:127]
    ds_read_b128 a[88:91], v227 offset:12288
    v_mfma_f32_16x16x32_bf16 v[124:127], a[44:47], a[28:31], v[124:127]
    ds_read_b128 a[92:95], v227 offset:14336
    buffer_load_dwordx4 v232, s[40:43], s80 offen offset:1024 lds
    v_mfma_f32_16x16x32_bf16 v[108:111], a[44:47], a[24:27], v[108:111]
    buffer_load_dwordx4 v233, s[40:43], s80 offen offset:2048 lds
    v_mfma_f32_16x16x32_bf16 v[92:95], a[44:47], a[20:23], v[92:95]
    s_add_u32 s72, s72, 0x8000
    v_mfma_f32_16x16x32_bf16 v[76:79], a[44:47], a[16:19], v[76:79]
    s_cmp_eq_u32 s72, 0x18000
    v_mfma_f32_16x16x32_bf16 v[60:63], a[44:47], a[12:15], v[60:63]
    s_cselect_b32 s72, 0, s72
    v_mfma_f32_16x16x32_bf16 v[44:47], a[44:47], a[8:11], v[44:47]
    buffer_load_dwordx4 v234, s[40:43], s80 offen offset:3072 lds
    v_mfma_f32_16x16x32_bf16 v[28:31], a[44:47], a[4:7], v[28:31]
    s_add_u32 s66, s66, 128
    v_mfma_f32_16x16x32_bf16 v[12:15], a[44:47], a[0:3], v[12:15]
    s_cmp_eq_u32 s66, 2048
    v_mfma_f32_16x16x32_bf16 a[124:127], a[44:47], a[140:143], a[124:127]
    s_cselect_b32 s66, 256, s66
    v_mfma_f32_16x16x32_bf16 v[128:131], a[0:3], a[48:51], v[128:131]
    s_add_u32 s73, s73, 0x8000
    v_mfma_f32_16x16x32_bf16 v[132:135], a[4:7], a[48:51], v[132:135]
    s_cmp_eq_u32 s73, 0x18000
    v_mfma_f32_16x16x32_bf16 v[144:147], a[8:11], a[48:51], v[144:147]
    s_cselect_b32 s73, 0, s73
    v_mfma_f32_16x16x32_bf16 v[148:151], a[12:15], a[48:51], v[148:151]
    v_add_u32 v226, s73, v224
    v_mfma_f32_16x16x32_bf16 v[160:163], a[16:19], a[48:51], v[160:163]
    v_add_u32_e64 v227, s73, v225
    v_accvgpr_read_b32 v239, a170
    v_mfma_f32_16x16x32_bf16 v[164:167], a[20:23], a[48:51], v[164:167]
    v_dot2_f32_bf16 v246, v240, v241, v246
    v_mfma_f32_16x16x32_bf16 v[176:179], a[24:27], a[48:51], v[176:179]
    v_dot2_f32_bf16 v247, v240, v240, v247
    v_mfma_f32_16x16x32_bf16 v[180:183], a[28:31], a[48:51], v[180:183]
    v_accvgpr_read_b32 v240, a171
    v_mfma_f32_16x16x32_bf16 a[124:127], a[48:51], a[144:147], a[124:127]
    v_dot2_f32_bf16 v246, v239, v241, v246
    v_mfma_f32_16x16x32_bf16 v[188:191], a[28:31], a[52:55], v[188:191]
    v_dot2_f32_bf16 v247, v239, v239, v247
    v_mfma_f32_16x16x32_bf16 v[184:187], a[24:27], a[52:55], v[184:187]
    v_accvgpr_read_b32 v239, a172
    v_mfma_f32_16x16x32_bf16 v[172:175], a[20:23], a[52:55], v[172:175]
    v_dot2_f32_bf16 v246, v240, v241, v246
    v_mfma_f32_16x16x32_bf16 v[168:171], a[16:19], a[52:55], v[168:171]
    v_dot2_f32_bf16 v247, v240, v240, v247
    v_mfma_f32_16x16x32_bf16 v[156:159], a[12:15], a[52:55], v[156:159]
    v_accvgpr_read_b32 v240, a173
    v_mfma_f32_16x16x32_bf16 v[152:155], a[8:11], a[52:55], v[152:155]
    v_dot2_f32_bf16 v246, v239, v241, v246
    v_mfma_f32_16x16x32_bf16 v[140:143], a[4:7], a[52:55], v[140:143]
    v_dot2_f32_bf16 v247, v239, v239, v247
    v_mfma_f32_16x16x32_bf16 v[136:139], a[0:3], a[52:55], v[136:139]
    v_accvgpr_read_b32 v239, a174
    v_mfma_f32_16x16x32_bf16 a[124:127], a[52:55], a[148:151], a[124:127]
    v_dot2_f32_bf16 v246, v240, v241, v246
    s_waitcnt vmcnt(14) lgkmcnt(0)
    s_barrier
    v_mfma_f32_16x16x32_bf16 v[0:3], a[96:99], a[64:67], v[0:3]
    ds_read_b64_tr_b16 a[32:33], v228 offset:32768
    v_mfma_f32_16x16x32_bf16 v[16:19], a[96:99], a[68:71], v[16:19]
    ds_read_b64_tr_b16 a[34:35], v228 offset:34304
    v_mfma_f32_16x16x32_bf16 v[32:35], a[96:99], a[72:75], v[32:35]
    ds_read_b128 a[0:3], v226 offset:0
    v_mfma_f32_16x16x32_bf16 v[48:51], a[96:99], a[76:79], v[48:51]
    ds_read_b64_tr_b16 a[36:37], v229 offset:32768
    v_mfma_f32_16x16x32_bf16 v[64:67], a[96:99], a[80:83], v[64:67]
    s_add_u32 m0, s70, 16384
    v_mfma_f32_16x16x32_bf16 v[80:83], a[96:99], a[84:87], v[80:83]
    s_add_u32 s67, s67, 196608
    v_mfma_f32_16x16x32_bf16 v[96:99], a[96:99], a[88:91], v[96:99]
    v_mfma_f32_16x16x32_bf16 v[112:115], a[96:99], a[92:95], v[112:115]
    buffer_load_dwordx4 v235, s[44:47], s67 offen lds
    v_mfma_f32_16x16x32_bf16 a[124:127], a[96:99], a[128:131], a[124:127]
    ds_read_b64_tr_b16 a[38:39], v229 offset:34304
    v_mfma_f32_16x16x32_bf16 v[116:119], a[100:103], a[92:95], v[116:119]
    ds_read_b128 a[4:7], v226 offset:2048
    v_mfma_f32_16x16x32_bf16 v[100:103], a[100:103], a[88:91], v[100:103]
    ds_read_b64_tr_b16 a[40:41], v228 offset:32896
    v_mfma_f32_16x16x32_bf16 v[84:87], a[100:103], a[84:87], v[84:87]
    ds_read_b64_tr_b16 a[42:43], v228 offset:34432
    v_mfma_f32_16x16x32_bf16 v[68:71], a[100:103], a[80:83], v[68:71]
    buffer_load_dwordx4 v236, s[44:47], s67 offen offset:1024 lds
    v_mfma_f32_16x16x32_bf16 v[52:55], a[100:103], a[76:79], v[52:55]
    v_mfma_f32_16x16x32_bf16 v[36:39], a[100:103], a[72:75], v[36:39]
    ds_read_b128 a[8:11], v226 offset:4096
    v_mfma_f32_16x16x32_bf16 v[20:23], a[100:103], a[68:71], v[20:23]
    ds_read_b64_tr_b16 a[44:45], v229 offset:32896
    v_mfma_f32_16x16x32_bf16 v[4:7], a[100:103], a[64:67], v[4:7]
    ds_read_b64_tr_b16 a[46:47], v229 offset:34432
    v_mfma_f32_16x16x32_bf16 a[124:127], a[100:103], a[132:135], a[124:127]
    ds_read_b128 a[12:15], v226 offset:6144
    v_mfma_f32_16x16x32_bf16 v[8:11], a[104:107], a[64:67], v[8:11]
    buffer_load_dwordx4 v237, s[44:47], s67 offen offset:2048 lds
    v_mfma_f32_16x16x32_bf16 v[24:27], a[104:107], a[68:71], v[24:27]
    ds_read_b64_tr_b16 a[48:49], v228 offset:33024
    v_mfma_f32_16x16x32_bf16 v[40:43], a[104:107], a[72:75], v[40:43]
    v_mfma_f32_16x16x32_bf16 v[56:59], a[104:107], a[76:79], v[56:59]
    ds_read_b64_tr_b16 a[50:51], v228 offset:34560
    v_mfma_f32_16x16x32_bf16 v[72:75], a[104:107], a[80:83], v[72:75]
    ds_read_b128 a[16:19], v226 offset:8192
    v_mfma_f32_16x16x32_bf16 v[88:91], a[104:107], a[84:87], v[88:91]
    ds_read_b64_tr_b16 a[52:53], v229 offset:33024
    v_mfma_f32_16x16x32_bf16 v[104:107], a[104:107], a[88:91], v[104:107]
    s_add_u32 m0, s68, s72
    v_mfma_f32_16x16x32_bf16 v[120:123], a[104:107], a[92:95], v[120:123]
    s_add_u32 s80, s64, s66
    v_mfma_f32_16x16x32_bf16 a[124:127], a[104:107], a[136:139], a[124:127]
    v_mfma_f32_16x16x32_bf16 v[124:127], a[108:111], a[92:95], v[124:127]
    buffer_load_dwordx4 v231, s[40:43], s80 offen lds
    v_mfma_f32_16x16x32_bf16 v[108:111], a[108:111], a[88:91], v[108:111]
    ds_read_b64_tr_b16 a[54:55], v229 offset:34560
    v_mfma_f32_16x16x32_bf16 v[92:95], a[108:111], a[84:87], v[92:95]
    ds_read_b128 a[20:23], v226 offset:10240
    v_mfma_f32_16x16x32_bf16 v[76:79], a[108:111], a[80:83], v[76:79]
    ds_read_b128 a[24:27], v226 offset:12288
    v_mfma_f32_16x16x32_bf16 v[60:63], a[108:111], a[76:79], v[60:63]
    ds_read_b128 a[28:31], v226 offset:14336
    v_mfma_f32_16x16x32_bf16 v[44:47], a[108:111], a[72:75], v[44:47]
    buffer_load_dwordx4 v232, s[40:43], s80 offen offset:1024 lds
    v_mfma_f32_16x16x32_bf16 v[28:31], a[108:111], a[68:71], v[28:31]
    v_mfma_f32_16x16x32_bf16 v[12:15], a[108:111], a[64:67], v[12:15]
    buffer_load_dwordx4 v233, s[40:43], s80 offen offset:2048 lds
    v_mfma_f32_16x16x32_bf16 a[124:127], a[108:111], a[140:143], a[124:127]
    buffer_load_dwordx4 v234, s[40:43], s80 offen offset:3072 lds
    v_mfma_f32_16x16x32_bf16 v[128:131], a[64:67], a[112:115], v[128:131]
    v_dot2_f32_bf16 v247, v240, v240, v247
    v_mfma_f32_16x16x32_bf16 v[132:135], a[68:71], a[112:115], v[132:135]
    v_accvgpr_read_b32 v240, a175
    v_mfma_f32_16x16x32_bf16 v[144:147], a[72:75], a[112:115], v[144:147]
    v_dot2_f32_bf16 v246, v239, v241, v246
    v_mfma_f32_16x16x32_bf16 v[148:151], a[76:79], a[112:115], v[148:151]
    v_dot2_f32_bf16 v247, v239, v239, v247
    v_mfma_f32_16x16x32_bf16 v[160:163], a[80:83], a[112:115], v[160:163]
    v_mfma_f32_16x16x32_bf16 v[164:167], a[84:87], a[112:115], v[164:167]
    v_dot2_f32_bf16 v246, v240, v241, v246
    v_mfma_f32_16x16x32_bf16 v[176:179], a[88:91], a[112:115], v[176:179]
    v_dot2_f32_bf16 v247, v240, v240, v247
    v_mfma_f32_16x16x32_bf16 v[180:183], a[92:95], a[112:115], v[180:183]
    s_nop 2
    v_mfma_f32_16x16x32_bf16 a[124:127], a[112:115], a[144:147], a[124:127]
    v_add_f32_dpp v246, v246, v246 quad_perm:[1,0,3,2] row_mask:0xf bank_mask:0xf
    v_mfma_f32_16x16x32_bf16 v[188:191], a[92:95], a[116:119], v[188:191]
    v_add_f32_dpp v247, v247, v247 quad_perm:[1,0,3,2] row_mask:0xf bank_mask:0xf
    v_mfma_f32_16x16x32_bf16 v[184:187], a[88:91], a[116:119], v[184:187]
    s_nop 0
    v_mfma_f32_16x16x32_bf16 v[172:175], a[84:87], a[116:119], v[172:175]
    v_mfma_f32_16x16x32_bf16 v[168:171], a[80:83], a[116:119], v[168:171]
    v_add_f32_dpp v246, v246, v246 quad_perm:[2,3,0,1] row_mask:0xf bank_mask:0xf
    v_mfma_f32_16x16x32_bf16 v[156:159], a[76:79], a[116:119], v[156:159]
    v_add_f32_dpp v247, v247, v247 quad_perm:[2,3,0,1] row_mask:0xf bank_mask:0xf
    v_mfma_f32_16x16x32_bf16 v[152:155], a[72:75], a[116:119], v[152:155]
    s_nop 0
    v_mfma_f32_16x16x32_bf16 v[140:143], a[68:71], a[116:119], v[140:143]
    v_add_f32_dpp v246, v246, v246 row_half_mirror row_mask:0xf bank_mask:0xf
    v_mfma_f32_16x16x32_bf16 v[136:139], a[64:67], a[116:119], v[136:139]
    buffer_store_dwordx4 a[60:63], v243, s[36:39], s76 offen sc1
    v_mfma_f32_16x16x32_bf16 a[124:127], a[116:119], a[148:151], a[124:127]
    s_waitcnt vmcnt(14) lgkmcnt(0)
    s_barrier
    v_mfma_f32_16x16x32_bf16 v[0:3], a[32:35], a[0:3], v[0:3]
    ds_read_b64_tr_b16 a[96:97], v228 offset:49152
    ds_read_b64_tr_b16 a[98:99], v228 offset:50688
    v_mfma_f32_16x16x32_bf16 v[16:19], a[32:35], a[4:7], v[16:19]
    ds_read_b128 a[64:67], v227 offset:0
    v_mfma_f32_16x16x32_bf16 v[32:35], a[32:35], a[8:11], v[32:35]
    ds_read_b64_tr_b16 a[100:101], v229 offset:49152
    v_mfma_f32_16x16x32_bf16 v[48:51], a[32:35], a[12:15], v[48:51]
    s_add_u32 m0, s70, 32768
    v_mfma_f32_16x16x32_bf16 v[64:67], a[32:35], a[16:19], v[64:67]
    s_add_u32 s67, s67, 196608
    v_mfma_f32_16x16x32_bf16 v[80:83], a[32:35], a[20:23], v[80:83]
    buffer_load_dwordx4 v235, s[44:47], s67 offen lds
    v_mfma_f32_16x16x32_bf16 v[96:99], a[32:35], a[24:27], v[96:99]
    ds_read_b64_tr_b16 a[102:103], v229 offset:50688
    v_mfma_f32_16x16x32_bf16 v[112:115], a[32:35], a[28:31], v[112:115]
    ds_read_b128 a[68:71], v227 offset:2048
    v_mfma_f32_16x16x32_bf16 a[124:127], a[32:35], a[128:131], a[124:127]
    ds_read_b64_tr_b16 a[104:105], v228 offset:49280
    v_mfma_f32_16x16x32_bf16 v[116:119], a[36:39], a[28:31], v[116:119]
    ds_read_b64_tr_b16 a[106:107], v228 offset:50816
    v_mfma_f32_16x16x32_bf16 v[100:103], a[36:39], a[24:27], v[100:103]
    buffer_load_dwordx4 v236, s[44:47], s67 offen offset:1024 lds
    v_mfma_f32_16x16x32_bf16 v[84:87], a[36:39], a[20:23], v[84:87]
    ds_read_b128 a[72:75], v227 offset:4096
    v_mfma_f32_16x16x32_bf16 v[68:71], a[36:39], a[16:19], v[68:71]
    ds_read_b64_tr_b16 a[108:109], v229 offset:49280
    v_mfma_f32_16x16x32_bf16 v[52:55], a[36:39], a[12:15], v[52:55]
    ds_read_b64_tr_b16 a[110:111], v229 offset:50816
    v_mfma_f32_16x16x32_bf16 v[36:39], a[36:39], a[8:11], v[36:39]
    ds_read_b128 a[76:79], v227 offset:6144
    v_mfma_f32_16x16x32_bf16 v[20:23], a[36:39], a[4:7], v[20:23]
    buffer_load_dwordx4 v237, s[44:47], s67 offen offset:2048 lds
    v_mfma_f32_16x16x32_bf16 v[4:7], a[36:39], a[0:3], v[4:7]
    ds_read_b64_tr_b16 a[112:113], v228 offset:49408
    v_mfma_f32_16x16x32_bf16 a[124:127], a[36:39], a[132:135], a[124:127]
    ds_read_b64_tr_b16 a[114:115], v228 offset:50944
    v_mfma_f32_16x16x32_bf16 v[8:11], a[40:43], a[0:3], v[8:11]
    ds_read_b128 a[80:83], v227 offset:8192
    v_mfma_f32_16x16x32_bf16 v[24:27], a[40:43], a[4:7], v[24:27]
    ds_read_b64_tr_b16 a[116:117], v229 offset:49408
    v_mfma_f32_16x16x32_bf16 v[40:43], a[40:43], a[8:11], v[40:43]
    s_add_u32 m0, s69, s72
    v_mfma_f32_16x16x32_bf16 v[56:59], a[40:43], a[12:15], v[56:59]
    s_add_u32 s80, s65, s66
    v_mfma_f32_16x16x32_bf16 v[72:75], a[40:43], a[16:19], v[72:75]
    buffer_load_dwordx4 v231, s[40:43], s80 offen lds
    v_mfma_f32_16x16x32_bf16 v[88:91], a[40:43], a[20:23], v[88:91]
    ds_read_b64_tr_b16 a[118:119], v229 offset:50944
    v_mfma_f32_16x16x32_bf16 v[104:107], a[40:43], a[24:27], v[104:107]
    ds_read_b128 a[84:87], v227 offset:10240
    v_mfma_f32_16x16x32_bf16 v[120:123], a[40:43], a[28:31], v[120:123]
    ds_read_b128 a[88:91], v227 offset:12288
    v_mfma_f32_16x16x32_bf16 a[124:127], a[40:43], a[136:139], a[124:127]
    ds_read_b128 a[92:95], v227 offset:14336
    v_mfma_f32_16x16x32_bf16 v[124:127], a[44:47], a[28:31], v[124:127]
    buffer_load_dwordx4 v232, s[40:43], s80 offen offset:1024 lds
    buffer_load_dwordx4 v233, s[40:43], s80 offen offset:2048 lds
    v_mfma_f32_16x16x32_bf16 v[108:111], a[44:47], a[24:27], v[108:111]
    s_add_u32 s72, s72, 0x8000
    v_mfma_f32_16x16x32_bf16 v[92:95], a[44:47], a[20:23], v[92:95]
    s_cmp_eq_u32 s72, 0x18000
    v_mfma_f32_16x16x32_bf16 v[76:79], a[44:47], a[16:19], v[76:79]
    s_cselect_b32 s72, 0, s72
    v_mfma_f32_16x16x32_bf16 v[60:63], a[44:47], a[12:15], v[60:63]
    buffer_load_dwordx4 v234, s[40:43], s80 offen offset:3072 lds
    v_mfma_f32_16x16x32_bf16 v[44:47], a[44:47], a[8:11], v[44:47]
    s_add_u32 s66, s66, 128
    v_mfma_f32_16x16x32_bf16 v[28:31], a[44:47], a[4:7], v[28:31]
    s_cmp_eq_u32 s66, 2048
    v_mfma_f32_16x16x32_bf16 v[12:15], a[44:47], a[0:3], v[12:15]
    s_cselect_b32 s66, 256, s66
    v_mfma_f32_16x16x32_bf16 a[124:127], a[44:47], a[140:143], a[124:127]
    s_add_u32 s73, s73, 0x8000
    v_mfma_f32_16x16x32_bf16 v[128:131], a[0:3], a[48:51], v[128:131]
    s_cmp_eq_u32 s73, 0x18000
    v_mfma_f32_16x16x32_bf16 v[132:135], a[4:7], a[48:51], v[132:135]
    s_cselect_b32 s73, 0, s73
    v_mfma_f32_16x16x32_bf16 v[144:147], a[8:11], a[48:51], v[144:147]
    v_add_u32 v226, s73, v224
    v_mfma_f32_16x16x32_bf16 v[148:151], a[12:15], a[48:51], v[148:151]
    v_add_u32_e64 v227, s73, v225
    v_mfma_f32_16x16x32_bf16 v[160:163], a[16:19], a[48:51], v[160:163]
    v_add_f32_dpp v247, v247, v247 row_half_mirror row_mask:0xf bank_mask:0xf
    v_mfma_f32_16x16x32_bf16 v[164:167], a[20:23], a[48:51], v[164:167]
    s_nop 0
    v_mfma_f32_16x16x32_bf16 v[176:179], a[24:27], a[48:51], v[176:179]
    v_add_f32_dpp v246, v246, v246 row_mirror row_mask:0xf bank_mask:0xf
    v_mfma_f32_16x16x32_bf16 v[180:183], a[28:31], a[48:51], v[180:183]
    v_add_f32_dpp v247, v247, v247 row_mirror row_mask:0xf bank_mask:0xf
    v_mfma_f32_16x16x32_bf16 a[124:127], a[48:51], a[144:147], a[124:127]
    s_nop 0
    v_mfma_f32_16x16x32_bf16 v[188:191], a[28:31], a[52:55], v[188:191]
    v_mov_b32_e64 v239, v246
    v_mfma_f32_16x16x32_bf16 v[184:187], a[24:27], a[52:55], v[184:187]
    v_mov_b32_e64 v240, v247
    v_mfma_f32_16x16x32_bf16 v[172:175], a[20:23], a[52:55], v[172:175]
    s_nop 0
    v_mfma_f32_16x16x32_bf16 v[168:171], a[16:19], a[52:55], v[168:171]
    v_permlane16_swap_b32 v239, v246
    v_mfma_f32_16x16x32_bf16 v[156:159], a[12:15], a[52:55], v[156:159]
    v_permlane16_swap_b32 v240, v247
    v_mfma_f32_16x16x32_bf16 v[152:155], a[8:11], a[52:55], v[152:155]
    v_add_f32 v246, v246, v239
    v_mfma_f32_16x16x32_bf16 v[140:143], a[4:7], a[52:55], v[140:143]
    v_add_f32_e64 v247, v247, v240
    v_mfma_f32_16x16x32_bf16 v[136:139], a[0:3], a[52:55], v[136:139]
    v_mul_f32 v246, 0x3a800000, v246
    v_mfma_f32_16x16x32_bf16 a[124:127], a[52:55], a[148:151], a[124:127]
    v_mul_f32 v247, 0x3a800000, v247
    s_waitcnt vmcnt(14) lgkmcnt(0)
    s_barrier
    v_mfma_f32_16x16x32_bf16 v[0:3], a[96:99], a[64:67], v[0:3]
    ds_read_b64_tr_b16 a[32:33], v228 offset:0
    v_mfma_f32_16x16x32_bf16 v[16:19], a[96:99], a[68:71], v[16:19]
    ds_read_b64_tr_b16 a[34:35], v228 offset:1536
    v_mfma_f32_16x16x32_bf16 v[32:35], a[96:99], a[72:75], v[32:35]
    ds_read_b128 a[0:3], v226 offset:0
    v_mfma_f32_16x16x32_bf16 v[48:51], a[96:99], a[76:79], v[48:51]
    ds_read_b64_tr_b16 a[36:37], v229 offset:0
    v_mfma_f32_16x16x32_bf16 v[64:67], a[96:99], a[80:83], v[64:67]
    s_add_u32 m0, s70, 49152
    v_mfma_f32_16x16x32_bf16 v[80:83], a[96:99], a[84:87], v[80:83]
    s_add_u32 s67, s67, 196608
    v_mfma_f32_16x16x32_bf16 v[96:99], a[96:99], a[88:91], v[96:99]
    buffer_load_dwordx4 v235, s[44:47], s67 offen lds
    v_mfma_f32_16x16x32_bf16 v[112:115], a[96:99], a[92:95], v[112:115]
    v_mfma_f32_16x16x32_bf16 a[124:127], a[96:99], a[128:131], a[124:127]
    ds_read_b64_tr_b16 a[38:39], v229 offset:1536
    v_mfma_f32_16x16x32_bf16 v[116:119], a[100:103], a[92:95], v[116:119]
    ds_read_b128 a[4:7], v226 offset:2048
    v_mfma_f32_16x16x32_bf16 v[100:103], a[100:103], a[88:91], v[100:103]
    ds_read_b64_tr_b16 a[40:41], v228 offset:128
    v_mfma_f32_16x16x32_bf16 v[84:87], a[100:103], a[84:87], v[84:87]
    ds_read_b64_tr_b16 a[42:43], v228 offset:1664
    v_mfma_f32_16x16x32_bf16 v[68:71], a[100:103], a[80:83], v[68:71]
    buffer_load_dwordx4 v236, s[44:47], s67 offen offset:1024 lds
    v_mfma_f32_16x16x32_bf16 v[52:55], a[100:103], a[76:79], v[52:55]
    ds_read_b128 a[8:11], v226 offset:4096
    v_mfma_f32_16x16x32_bf16 v[36:39], a[100:103], a[72:75], v[36:39]
    ds_read_b64_tr_b16 a[44:45], v229 offset:128
    v_mfma_f32_16x16x32_bf16 v[20:23], a[100:103], a[68:71], v[20:23]
    v_mfma_f32_16x16x32_bf16 v[4:7], a[100:103], a[64:67], v[4:7]
    ds_read_b64_tr_b16 a[46:47], v229 offset:1664
    v_mfma_f32_16x16x32_bf16 a[124:127], a[100:103], a[132:135], a[124:127]
    ds_read_b128 a[12:15], v226 offset:6144
    v_mfma_f32_16x16x32_bf16 v[8:11], a[104:107], a[64:67], v[8:11]
    buffer_load_dwordx4 v237, s[44:47], s67 offen offset:2048 lds
    v_mfma_f32_16x16x32_bf16 v[24:27], a[104:107], a[68:71], v[24:27]
    ds_read_b64_tr_b16 a[48:49], v228 offset:256
    v_mfma_f32_16x16x32_bf16 v[40:43], a[104:107], a[72:75], v[40:43]
    ds_read_b64_tr_b16 a[50:51], v228 offset:1792
    v_mfma_f32_16x16x32_bf16 v[56:59], a[104:107], a[76:79], v[56:59]
    ds_read_b128 a[16:19], v226 offset:8192
    v_mfma_f32_16x16x32_bf16 v[72:75], a[104:107], a[80:83], v[72:75]
    ds_read_b64_tr_b16 a[52:53], v229 offset:256
    v_mfma_f32_16x16x32_bf16 v[88:91], a[104:107], a[84:87], v[88:91]
    v_mfma_f32_16x16x32_bf16 v[104:107], a[104:107], a[88:91], v[104:107]
    s_add_u32 m0, s68, s72
    v_mfma_f32_16x16x32_bf16 v[120:123], a[104:107], a[92:95], v[120:123]
    s_add_u32 s80, s64, s66
    v_mfma_f32_16x16x32_bf16 a[124:127], a[104:107], a[136:139], a[124:127]
    buffer_load_dwordx4 v231, s[40:43], s80 offen lds
    v_mfma_f32_16x16x32_bf16 v[124:127], a[108:111], a[92:95], v[124:127]
    ds_read_b64_tr_b16 a[54:55], v229 offset:1792
    v_mfma_f32_16x16x32_bf16 v[108:111], a[108:111], a[88:91], v[108:111]
    ds_read_b128 a[20:23], v226 offset:10240
    v_mfma_f32_16x16x32_bf16 v[92:95], a[108:111], a[84:87], v[92:95]
    ds_read_b128 a[24:27], v226 offset:12288
    v_mfma_f32_16x16x32_bf16 v[76:79], a[108:111], a[80:83], v[76:79]
    v_mfma_f32_16x16x32_bf16 v[60:63], a[108:111], a[76:79], v[60:63]
    ds_read_b128 a[28:31], v226 offset:14336
    v_mfma_f32_16x16x32_bf16 v[44:47], a[108:111], a[72:75], v[44:47]
    buffer_load_dwordx4 v232, s[40:43], s80 offen offset:1024 lds
    v_mfma_f32_16x16x32_bf16 v[28:31], a[108:111], a[68:71], v[28:31]
    buffer_load_dwordx4 v233, s[40:43], s80 offen offset:2048 lds
    v_mfma_f32_16x16x32_bf16 v[12:15], a[108:111], a[64:67], v[12:15]
    buffer_load_dwordx4 v234, s[40:43], s80 offen offset:3072 lds
    v_mfma_f32_16x16x32_bf16 a[124:127], a[108:111], a[140:143], a[124:127]
    v_fma_f32 v247, -v246, v246, v247
    v_mfma_f32_16x16x32_bf16 v[128:131], a[64:67], a[112:115], v[128:131]
    v_max_f32_e64 v247, 0, v247
    v_mfma_f32_16x16x32_bf16 v[132:135], a[68:71], a[112:115], v[132:135]
    v_cvt_pk_bf16_f32 v246, v246, v246
    v_mfma_f32_16x16x32_bf16 v[144:147], a[72:75], a[112:115], v[144:147]
    v_mfma_f32_16x16x32_bf16 v[148:151], a[76:79], a[112:115], v[148:151]
    v_cvt_pk_bf16_f32 v247, v247, v247
    v_mfma_f32_16x16x32_bf16 v[160:163], a[80:83], a[112:115], v[160:163]
    v_lshlrev_b32_e64 v246, 16, v246
    v_mfma_f32_16x16x32_bf16 v[164:167], a[84:87], a[112:115], v[164:167]
    v_lshlrev_b32_e64 v247, 16, v247
    v_mfma_f32_16x16x32_bf16 v[176:179], a[88:91], a[112:115], v[176:179]
    v_add_f32 v247, 0x3727c5ac, v247
    v_mfma_f32_16x16x32_bf16 v[180:183], a[92:95], a[112:115], v[180:183]
    v_cvt_pk_bf16_f32 v247, v247, v247
    v_mfma_f32_16x16x32_bf16 a[124:127], a[112:115], a[144:147], a[124:127]
    v_lshlrev_b32_e64 v247, 16, v247
    v_mfma_f32_16x16x32_bf16 v[188:191], a[92:95], a[116:119], v[188:191]
    v_sqrt_f32_e64 v247, v247
    v_mfma_f32_16x16x32_bf16 v[184:187], a[88:91], a[116:119], v[184:187]
    v_mfma_f32_16x16x32_bf16 v[172:175], a[84:87], a[116:119], v[172:175]
    v_xor_b32 v246, 0x80000000, v246
    v_mfma_f32_16x16x32_bf16 v[168:171], a[80:83], a[116:119], v[168:171]
    v_cvt_pk_bf16_f32 v247, v247, v247
    v_mfma_f32_16x16x32_bf16 v[156:159], a[76:79], a[116:119], v[156:159]
    v_lshlrev_b32_e64 v247, 16, v247
    v_mfma_f32_16x16x32_bf16 v[152:155], a[72:75], a[116:119], v[152:155]
    v_rcp_f32_e64 v247, v247
    v_mfma_f32_16x16x32_bf16 v[140:143], a[68:71], a[116:119], v[140:143]
    s_mov_b32 s71, 2
    v_mfma_f32_16x16x32_bf16 v[136:139], a[64:67], a[116:119], v[136:139]
    buffer_load_dword v244, off, s[52:55], 0 sc1
    v_mfma_f32_16x16x32_bf16 a[124:127], a[116:119], a[148:151], a[124:127]
    s_waitcnt vmcnt(14) lgkmcnt(0)
    s_barrier
    buffer_store_dwordx2 v[246:247], v248, s[36:39], s82 offen sc1
    s_nop 4
    buffer_store_dwordx4 a[124:127], v243, s[36:39], s81 offen sc1
.p2align 6
G1_qkv_loop:
    v_mfma_f32_16x16x32_bf16 v[0:3], a[32:35], a[0:3], v[0:3]
    ds_read_b64_tr_b16 a[96:97], v228 offset:16384
    v_mfma_f32_16x16x32_bf16 v[16:19], a[32:35], a[4:7], v[16:19]
    ds_read_b64_tr_b16 a[98:99], v228 offset:17920
    v_mfma_f32_16x16x32_bf16 v[32:35], a[32:35], a[8:11], v[32:35]
    ds_read_b128 a[64:67], v227 offset:0
    v_mfma_f32_16x16x32_bf16 v[48:51], a[32:35], a[12:15], v[48:51]
    ds_read_b64_tr_b16 a[100:101], v229 offset:16384
    v_mfma_f32_16x16x32_bf16 v[64:67], a[32:35], a[16:19], v[64:67]
    s_add_u32 m0, s70, 0
    v_mfma_f32_16x16x32_bf16 v[80:83], a[32:35], a[20:23], v[80:83]
    s_add_u32 s67, s67, 196608
    v_mfma_f32_16x16x32_bf16 v[96:99], a[32:35], a[24:27], v[96:99]
    s_cmp_eq_u32 s67, 6291456
    v_mfma_f32_16x16x32_bf16 v[112:115], a[32:35], a[28:31], v[112:115]
    s_cselect_b32 s67, 786432, s67
    v_mfma_f32_16x16x32_bf16 v[116:119], a[36:39], a[28:31], v[116:119]
    buffer_load_dwordx4 v235, s[44:47], s67 offen lds
    v_mfma_f32_16x16x32_bf16 v[100:103], a[36:39], a[24:27], v[100:103]
    ds_read_b64_tr_b16 a[102:103], v229 offset:17920
    v_mfma_f32_16x16x32_bf16 v[84:87], a[36:39], a[20:23], v[84:87]
    ds_read_b128 a[68:71], v227 offset:2048
    v_mfma_f32_16x16x32_bf16 v[68:71], a[36:39], a[16:19], v[68:71]
    v_mfma_f32_16x16x32_bf16 v[52:55], a[36:39], a[12:15], v[52:55]
    ds_read_b64_tr_b16 a[104:105], v228 offset:16512
    v_mfma_f32_16x16x32_bf16 v[36:39], a[36:39], a[8:11], v[36:39]
    ds_read_b64_tr_b16 a[106:107], v228 offset:18048
    v_mfma_f32_16x16x32_bf16 v[20:23], a[36:39], a[4:7], v[20:23]
    buffer_load_dwordx4 v236, s[44:47], s67 offen offset:1024 lds
    v_mfma_f32_16x16x32_bf16 v[4:7], a[36:39], a[0:3], v[4:7]
    ds_read_b128 a[72:75], v227 offset:4096
    v_mfma_f32_16x16x32_bf16 v[8:11], a[40:43], a[0:3], v[8:11]
    ds_read_b64_tr_b16 a[108:109], v229 offset:16512
    v_mfma_f32_16x16x32_bf16 v[24:27], a[40:43], a[4:7], v[24:27]
    ds_read_b64_tr_b16 a[110:111], v229 offset:18048
    v_mfma_f32_16x16x32_bf16 v[40:43], a[40:43], a[8:11], v[40:43]
    ds_read_b128 a[76:79], v227 offset:6144
    v_mfma_f32_16x16x32_bf16 v[56:59], a[40:43], a[12:15], v[56:59]
    buffer_load_dwordx4 v237, s[44:47], s67 offen offset:2048 lds
    v_mfma_f32_16x16x32_bf16 v[72:75], a[40:43], a[16:19], v[72:75]
    ds_read_b64_tr_b16 a[112:113], v228 offset:16640
    v_mfma_f32_16x16x32_bf16 v[88:91], a[40:43], a[20:23], v[88:91]
    ds_read_b64_tr_b16 a[114:115], v228 offset:18176
    v_mfma_f32_16x16x32_bf16 v[104:107], a[40:43], a[24:27], v[104:107]
    ds_read_b128 a[80:83], v227 offset:8192
    v_mfma_f32_16x16x32_bf16 v[120:123], a[40:43], a[28:31], v[120:123]
    v_mfma_f32_16x16x32_bf16 v[124:127], a[44:47], a[28:31], v[124:127]
    ds_read_b64_tr_b16 a[116:117], v229 offset:16640
    v_mfma_f32_16x16x32_bf16 v[108:111], a[44:47], a[24:27], v[108:111]
    s_add_u32 m0, s69, s72
    v_mfma_f32_16x16x32_bf16 v[92:95], a[44:47], a[20:23], v[92:95]
    s_add_u32 s80, s65, s66
    v_mfma_f32_16x16x32_bf16 v[76:79], a[44:47], a[16:19], v[76:79]
    buffer_load_dwordx4 v231, s[40:43], s80 offen lds
    v_mfma_f32_16x16x32_bf16 v[60:63], a[44:47], a[12:15], v[60:63]
    ds_read_b64_tr_b16 a[118:119], v229 offset:18176
    v_mfma_f32_16x16x32_bf16 v[44:47], a[44:47], a[8:11], v[44:47]
    ds_read_b128 a[84:87], v227 offset:10240
    v_mfma_f32_16x16x32_bf16 v[28:31], a[44:47], a[4:7], v[28:31]
    ds_read_b128 a[88:91], v227 offset:12288
    v_mfma_f32_16x16x32_bf16 v[12:15], a[44:47], a[0:3], v[12:15]
    ds_read_b128 a[92:95], v227 offset:14336
    v_mfma_f32_16x16x32_bf16 v[128:131], a[0:3], a[48:51], v[128:131]
    buffer_load_dwordx4 v232, s[40:43], s80 offen offset:1024 lds
    v_mfma_f32_16x16x32_bf16 v[132:135], a[4:7], a[48:51], v[132:135]
    buffer_load_dwordx4 v233, s[40:43], s80 offen offset:2048 lds
    v_mfma_f32_16x16x32_bf16 v[144:147], a[8:11], a[48:51], v[144:147]
    s_add_u32 s72, s72, 0x8000
    v_mfma_f32_16x16x32_bf16 v[148:151], a[12:15], a[48:51], v[148:151]
    v_mfma_f32_16x16x32_bf16 v[160:163], a[16:19], a[48:51], v[160:163]
    s_cmp_eq_u32 s72, 0x18000
    v_mfma_f32_16x16x32_bf16 v[164:167], a[20:23], a[48:51], v[164:167]
    s_cselect_b32 s72, 0, s72
    v_mfma_f32_16x16x32_bf16 v[176:179], a[24:27], a[48:51], v[176:179]
    buffer_load_dwordx4 v234, s[40:43], s80 offen offset:3072 lds
    v_mfma_f32_16x16x32_bf16 v[180:183], a[28:31], a[48:51], v[180:183]
    s_add_u32 s66, s66, 128
    v_mfma_f32_16x16x32_bf16 v[188:191], a[28:31], a[52:55], v[188:191]
    s_cmp_eq_u32 s66, 2048
    v_mfma_f32_16x16x32_bf16 v[184:187], a[24:27], a[52:55], v[184:187]
    s_cselect_b32 s66, 256, s66
    v_mfma_f32_16x16x32_bf16 v[172:175], a[20:23], a[52:55], v[172:175]
    s_add_u32 s73, s73, 0x8000
    v_mfma_f32_16x16x32_bf16 v[168:171], a[16:19], a[52:55], v[168:171]
    s_cmp_eq_u32 s73, 0x18000
    v_mfma_f32_16x16x32_bf16 v[156:159], a[12:15], a[52:55], v[156:159]
    s_cselect_b32 s73, 0, s73
    v_mfma_f32_16x16x32_bf16 v[152:155], a[8:11], a[52:55], v[152:155]
    v_add_u32 v226, s73, v224
    v_mfma_f32_16x16x32_bf16 v[140:143], a[4:7], a[52:55], v[140:143]
    v_add_u32_e64 v227, s73, v225
    v_mfma_f32_16x16x32_bf16 v[136:139], a[0:3], a[52:55], v[136:139]
    s_waitcnt vmcnt(14) lgkmcnt(0)
    s_barrier
    v_mfma_f32_16x16x32_bf16 v[0:3], a[96:99], a[64:67], v[0:3]
    ds_read_b64_tr_b16 a[32:33], v228 offset:32768
    v_mfma_f32_16x16x32_bf16 v[16:19], a[96:99], a[68:71], v[16:19]
    ds_read_b64_tr_b16 a[34:35], v228 offset:34304
    v_mfma_f32_16x16x32_bf16 v[32:35], a[96:99], a[72:75], v[32:35]
    v_mfma_f32_16x16x32_bf16 v[48:51], a[96:99], a[76:79], v[48:51]
    ds_read_b128 a[0:3], v226 offset:0
    v_mfma_f32_16x16x32_bf16 v[64:67], a[96:99], a[80:83], v[64:67]
    ds_read_b64_tr_b16 a[36:37], v229 offset:32768
    v_mfma_f32_16x16x32_bf16 v[80:83], a[96:99], a[84:87], v[80:83]
    v_mfma_f32_16x16x32_bf16 v[96:99], a[96:99], a[88:91], v[96:99]
    s_add_u32 m0, s70, 16384
    v_mfma_f32_16x16x32_bf16 v[112:115], a[96:99], a[92:95], v[112:115]
    s_add_u32 s67, s67, 196608
    v_mfma_f32_16x16x32_bf16 v[116:119], a[100:103], a[92:95], v[116:119]
    v_mfma_f32_16x16x32_bf16 v[100:103], a[100:103], a[88:91], v[100:103]
    buffer_load_dwordx4 v235, s[44:47], s67 offen lds
    v_mfma_f32_16x16x32_bf16 v[84:87], a[100:103], a[84:87], v[84:87]
    ds_read_b64_tr_b16 a[38:39], v229 offset:34304
    v_mfma_f32_16x16x32_bf16 v[68:71], a[100:103], a[80:83], v[68:71]
    v_mfma_f32_16x16x32_bf16 v[52:55], a[100:103], a[76:79], v[52:55]
    ds_read_b128 a[4:7], v226 offset:2048
    v_mfma_f32_16x16x32_bf16 v[36:39], a[100:103], a[72:75], v[36:39]
    ds_read_b64_tr_b16 a[40:41], v228 offset:32896
    v_mfma_f32_16x16x32_bf16 v[20:23], a[100:103], a[68:71], v[20:23]
    v_mfma_f32_16x16x32_bf16 v[4:7], a[100:103], a[64:67], v[4:7]
    ds_read_b64_tr_b16 a[42:43], v228 offset:34432
    v_mfma_f32_16x16x32_bf16 v[8:11], a[104:107], a[64:67], v[8:11]
    v_mfma_f32_16x16x32_bf16 v[24:27], a[104:107], a[68:71], v[24:27]
    buffer_load_dwordx4 v236, s[44:47], s67 offen offset:1024 lds
    v_mfma_f32_16x16x32_bf16 v[40:43], a[104:107], a[72:75], v[40:43]
    ds_read_b128 a[8:11], v226 offset:4096
    v_mfma_f32_16x16x32_bf16 v[56:59], a[104:107], a[76:79], v[56:59]
    v_mfma_f32_16x16x32_bf16 v[72:75], a[104:107], a[80:83], v[72:75]
    ds_read_b64_tr_b16 a[44:45], v229 offset:32896
    v_mfma_f32_16x16x32_bf16 v[88:91], a[104:107], a[84:87], v[88:91]
    ds_read_b64_tr_b16 a[46:47], v229 offset:34432
    v_mfma_f32_16x16x32_bf16 v[104:107], a[104:107], a[88:91], v[104:107]
    v_mfma_f32_16x16x32_bf16 v[120:123], a[104:107], a[92:95], v[120:123]
    ds_read_b128 a[12:15], v226 offset:6144
    v_mfma_f32_16x16x32_bf16 v[124:127], a[108:111], a[92:95], v[124:127]
    buffer_load_dwordx4 v237, s[44:47], s67 offen offset:2048 lds
    v_mfma_f32_16x16x32_bf16 v[108:111], a[108:111], a[88:91], v[108:111]
    v_mfma_f32_16x16x32_bf16 v[92:95], a[108:111], a[84:87], v[92:95]
    ds_read_b64_tr_b16 a[48:49], v228 offset:33024
    v_mfma_f32_16x16x32_bf16 v[76:79], a[108:111], a[80:83], v[76:79]
    ds_read_b64_tr_b16 a[50:51], v228 offset:34560
    v_mfma_f32_16x16x32_bf16 v[60:63], a[108:111], a[76:79], v[60:63]
    v_mfma_f32_16x16x32_bf16 v[44:47], a[108:111], a[72:75], v[44:47]
    ds_read_b128 a[16:19], v226 offset:8192
    v_mfma_f32_16x16x32_bf16 v[28:31], a[108:111], a[68:71], v[28:31]
    ds_read_b64_tr_b16 a[52:53], v229 offset:33024
    v_mfma_f32_16x16x32_bf16 v[12:15], a[108:111], a[64:67], v[12:15]
    v_mfma_f32_16x16x32_bf16 v[128:131], a[64:67], a[112:115], v[128:131]
    s_add_u32 m0, s68, s72
    v_mfma_f32_16x16x32_bf16 v[132:135], a[68:71], a[112:115], v[132:135]
    v_mfma_f32_16x16x32_bf16 v[144:147], a[72:75], a[112:115], v[144:147]
    s_add_u32 s80, s64, s66
    v_mfma_f32_16x16x32_bf16 v[148:151], a[76:79], a[112:115], v[148:151]
    buffer_load_dwordx4 v231, s[40:43], s80 offen lds
    v_mfma_f32_16x16x32_bf16 v[160:163], a[80:83], a[112:115], v[160:163]
    v_mfma_f32_16x16x32_bf16 v[164:167], a[84:87], a[112:115], v[164:167]
    ds_read_b64_tr_b16 a[54:55], v229 offset:34560
    v_mfma_f32_16x16x32_bf16 v[176:179], a[88:91], a[112:115], v[176:179]
    ds_read_b128 a[20:23], v226 offset:10240
    v_mfma_f32_16x16x32_bf16 v[180:183], a[92:95], a[112:115], v[180:183]
    v_mfma_f32_16x16x32_bf16 v[188:191], a[92:95], a[116:119], v[188:191]
    ds_read_b128 a[24:27], v226 offset:12288
    v_mfma_f32_16x16x32_bf16 v[184:187], a[88:91], a[116:119], v[184:187]
    ds_read_b128 a[28:31], v226 offset:14336
    v_mfma_f32_16x16x32_bf16 v[172:175], a[84:87], a[116:119], v[172:175]
    v_mfma_f32_16x16x32_bf16 v[168:171], a[80:83], a[116:119], v[168:171]
    buffer_load_dwordx4 v232, s[40:43], s80 offen offset:1024 lds
    v_mfma_f32_16x16x32_bf16 v[156:159], a[76:79], a[116:119], v[156:159]
    buffer_load_dwordx4 v233, s[40:43], s80 offen offset:2048 lds
    v_mfma_f32_16x16x32_bf16 v[152:155], a[72:75], a[116:119], v[152:155]
    v_mfma_f32_16x16x32_bf16 v[140:143], a[68:71], a[116:119], v[140:143]
    buffer_load_dwordx4 v234, s[40:43], s80 offen offset:3072 lds
    v_mfma_f32_16x16x32_bf16 v[136:139], a[64:67], a[116:119], v[136:139]
    s_waitcnt vmcnt(14) lgkmcnt(0)
    s_barrier
    v_mfma_f32_16x16x32_bf16 v[0:3], a[32:35], a[0:3], v[0:3]
    ds_read_b64_tr_b16 a[96:97], v228 offset:49152
    v_mfma_f32_16x16x32_bf16 v[16:19], a[32:35], a[4:7], v[16:19]
    ds_read_b64_tr_b16 a[98:99], v228 offset:50688
    v_mfma_f32_16x16x32_bf16 v[32:35], a[32:35], a[8:11], v[32:35]
    ds_read_b128 a[64:67], v227 offset:0
    v_mfma_f32_16x16x32_bf16 v[48:51], a[32:35], a[12:15], v[48:51]
    ds_read_b64_tr_b16 a[100:101], v229 offset:49152
    v_mfma_f32_16x16x32_bf16 v[64:67], a[32:35], a[16:19], v[64:67]
    s_add_u32 m0, s70, 32768
    v_mfma_f32_16x16x32_bf16 v[80:83], a[32:35], a[20:23], v[80:83]
    s_add_u32 s67, s67, 196608
    v_mfma_f32_16x16x32_bf16 v[96:99], a[32:35], a[24:27], v[96:99]
    buffer_load_dwordx4 v235, s[44:47], s67 offen lds
    v_mfma_f32_16x16x32_bf16 v[112:115], a[32:35], a[28:31], v[112:115]
    v_mfma_f32_16x16x32_bf16 v[116:119], a[36:39], a[28:31], v[116:119]
    ds_read_b64_tr_b16 a[102:103], v229 offset:50688
    v_mfma_f32_16x16x32_bf16 v[100:103], a[36:39], a[24:27], v[100:103]
    ds_read_b128 a[68:71], v227 offset:2048
    v_mfma_f32_16x16x32_bf16 v[84:87], a[36:39], a[20:23], v[84:87]
    ds_read_b64_tr_b16 a[104:105], v228 offset:49280
    v_mfma_f32_16x16x32_bf16 v[68:71], a[36:39], a[16:19], v[68:71]
    ds_read_b64_tr_b16 a[106:107], v228 offset:50816
    v_mfma_f32_16x16x32_bf16 v[52:55], a[36:39], a[12:15], v[52:55]
    buffer_load_dwordx4 v236, s[44:47], s67 offen offset:1024 lds
    v_mfma_f32_16x16x32_bf16 v[36:39], a[36:39], a[8:11], v[36:39]
    ds_read_b128 a[72:75], v227 offset:4096
    v_mfma_f32_16x16x32_bf16 v[20:23], a[36:39], a[4:7], v[20:23]
    ds_read_b64_tr_b16 a[108:109], v229 offset:49280
    v_mfma_f32_16x16x32_bf16 v[4:7], a[36:39], a[0:3], v[4:7]
    v_mfma_f32_16x16x32_bf16 v[8:11], a[40:43], a[0:3], v[8:11]
    ds_read_b64_tr_b16 a[110:111], v229 offset:50816
    v_mfma_f32_16x16x32_bf16 v[24:27], a[40:43], a[4:7], v[24:27]
    ds_read_b128 a[76:79], v227 offset:6144
    v_mfma_f32_16x16x32_bf16 v[40:43], a[40:43], a[8:11], v[40:43]
    buffer_load_dwordx4 v237, s[44:47], s67 offen offset:2048 lds
    v_mfma_f32_16x16x32_bf16 v[56:59], a[40:43], a[12:15], v[56:59]
    ds_read_b64_tr_b16 a[112:113], v228 offset:49408
    v_mfma_f32_16x16x32_bf16 v[72:75], a[40:43], a[16:19], v[72:75]
    ds_read_b64_tr_b16 a[114:115], v228 offset:50944
    v_mfma_f32_16x16x32_bf16 v[88:91], a[40:43], a[20:23], v[88:91]
    ds_read_b128 a[80:83], v227 offset:8192
    v_mfma_f32_16x16x32_bf16 v[104:107], a[40:43], a[24:27], v[104:107]
    ds_read_b64_tr_b16 a[116:117], v229 offset:49408
    v_mfma_f32_16x16x32_bf16 v[120:123], a[40:43], a[28:31], v[120:123]
    v_mfma_f32_16x16x32_bf16 v[124:127], a[44:47], a[28:31], v[124:127]
    s_add_u32 m0, s69, s72
    v_mfma_f32_16x16x32_bf16 v[108:111], a[44:47], a[24:27], v[108:111]
    s_add_u32 s80, s65, s66
    v_mfma_f32_16x16x32_bf16 v[92:95], a[44:47], a[20:23], v[92:95]
    buffer_load_dwordx4 v231, s[40:43], s80 offen lds
    v_mfma_f32_16x16x32_bf16 v[76:79], a[44:47], a[16:19], v[76:79]
    ds_read_b64_tr_b16 a[118:119], v229 offset:50944
    v_mfma_f32_16x16x32_bf16 v[60:63], a[44:47], a[12:15], v[60:63]
    ds_read_b128 a[84:87], v227 offset:10240
    v_mfma_f32_16x16x32_bf16 v[44:47], a[44:47], a[8:11], v[44:47]
    ds_read_b128 a[88:91], v227 offset:12288
    v_mfma_f32_16x16x32_bf16 v[28:31], a[44:47], a[4:7], v[28:31]
    ds_read_b128 a[92:95], v227 offset:14336
    v_mfma_f32_16x16x32_bf16 v[12:15], a[44:47], a[0:3], v[12:15]
    v_mfma_f32_16x16x32_bf16 v[128:131], a[0:3], a[48:51], v[128:131]
    buffer_load_dwordx4 v232, s[40:43], s80 offen offset:1024 lds
    v_mfma_f32_16x16x32_bf16 v[132:135], a[4:7], a[48:51], v[132:135]
    buffer_load_dwordx4 v233, s[40:43], s80 offen offset:2048 lds
    v_mfma_f32_16x16x32_bf16 v[144:147], a[8:11], a[48:51], v[144:147]
    s_add_u32 s72, s72, 0x8000
    v_mfma_f32_16x16x32_bf16 v[148:151], a[12:15], a[48:51], v[148:151]
    s_cmp_eq_u32 s72, 0x18000
    v_mfma_f32_16x16x32_bf16 v[160:163], a[16:19], a[48:51], v[160:163]
    s_cselect_b32 s72, 0, s72
    v_mfma_f32_16x16x32_bf16 v[164:167], a[20:23], a[48:51], v[164:167]
    buffer_load_dwordx4 v234, s[40:43], s80 offen offset:3072 lds
    v_mfma_f32_16x16x32_bf16 v[176:179], a[24:27], a[48:51], v[176:179]
    s_add_u32 s66, s66, 128
    v_mfma_f32_16x16x32_bf16 v[180:183], a[28:31], a[48:51], v[180:183]
    v_mfma_f32_16x16x32_bf16 v[188:191], a[28:31], a[52:55], v[188:191]
    s_cmp_eq_u32 s66, 2048
    v_mfma_f32_16x16x32_bf16 v[184:187], a[24:27], a[52:55], v[184:187]
    s_cselect_b32 s66, 256, s66
    v_mfma_f32_16x16x32_bf16 v[172:175], a[20:23], a[52:55], v[172:175]
    s_add_u32 s73, s73, 0x8000
    v_mfma_f32_16x16x32_bf16 v[168:171], a[16:19], a[52:55], v[168:171]
    s_cmp_eq_u32 s73, 0x18000
    v_mfma_f32_16x16x32_bf16 v[156:159], a[12:15], a[52:55], v[156:159]
    s_cselect_b32 s73, 0, s73
    v_mfma_f32_16x16x32_bf16 v[152:155], a[8:11], a[52:55], v[152:155]
    v_add_u32_e64 v226, s73, v224
    v_mfma_f32_16x16x32_bf16 v[140:143], a[4:7], a[52:55], v[140:143]
    v_add_u32_e64 v227, s73, v225
    v_mfma_f32_16x16x32_bf16 v[136:139], a[0:3], a[52:55], v[136:139]
    s_waitcnt vmcnt(14) lgkmcnt(0)
    s_barrier
    v_mfma_f32_16x16x32_bf16 v[0:3], a[96:99], a[64:67], v[0:3]
    ds_read_b64_tr_b16 a[32:33], v228 offset:0
    v_mfma_f32_16x16x32_bf16 v[16:19], a[96:99], a[68:71], v[16:19]
    ds_read_b64_tr_b16 a[34:35], v228 offset:1536
    v_mfma_f32_16x16x32_bf16 v[32:35], a[96:99], a[72:75], v[32:35]
    ds_read_b128 a[0:3], v226 offset:0
    v_mfma_f32_16x16x32_bf16 v[48:51], a[96:99], a[76:79], v[48:51]
    v_mfma_f32_16x16x32_bf16 v[64:67], a[96:99], a[80:83], v[64:67]
    ds_read_b64_tr_b16 a[36:37], v229 offset:0
    v_mfma_f32_16x16x32_bf16 v[80:83], a[96:99], a[84:87], v[80:83]
    s_add_u32 m0, s70, 49152
    v_mfma_f32_16x16x32_bf16 v[96:99], a[96:99], a[88:91], v[96:99]
    v_mfma_f32_16x16x32_bf16 v[112:115], a[96:99], a[92:95], v[112:115]
    s_add_u32 s67, s67, 196608
    v_mfma_f32_16x16x32_bf16 v[116:119], a[100:103], a[92:95], v[116:119]
    buffer_load_dwordx4 v235, s[44:47], s67 offen lds
    v_mfma_f32_16x16x32_bf16 v[100:103], a[100:103], a[88:91], v[100:103]
    v_mfma_f32_16x16x32_bf16 v[84:87], a[100:103], a[84:87], v[84:87]
    ds_read_b64_tr_b16 a[38:39], v229 offset:1536
    v_mfma_f32_16x16x32_bf16 v[68:71], a[100:103], a[80:83], v[68:71]
    ds_read_b128 a[4:7], v226 offset:2048
    v_mfma_f32_16x16x32_bf16 v[52:55], a[100:103], a[76:79], v[52:55]
    v_mfma_f32_16x16x32_bf16 v[36:39], a[100:103], a[72:75], v[36:39]
    ds_read_b64_tr_b16 a[40:41], v228 offset:128
    v_mfma_f32_16x16x32_bf16 v[20:23], a[100:103], a[68:71], v[20:23]
    ds_read_b64_tr_b16 a[42:43], v228 offset:1664
    v_mfma_f32_16x16x32_bf16 v[4:7], a[100:103], a[64:67], v[4:7]
    v_mfma_f32_16x16x32_bf16 v[8:11], a[104:107], a[64:67], v[8:11]
    buffer_load_dwordx4 v236, s[44:47], s67 offen offset:1024 lds
    v_mfma_f32_16x16x32_bf16 v[24:27], a[104:107], a[68:71], v[24:27]
    ds_read_b128 a[8:11], v226 offset:4096
    v_mfma_f32_16x16x32_bf16 v[40:43], a[104:107], a[72:75], v[40:43]
    ds_read_b64_tr_b16 a[44:45], v229 offset:128
    v_mfma_f32_16x16x32_bf16 v[56:59], a[104:107], a[76:79], v[56:59]
    v_mfma_f32_16x16x32_bf16 v[72:75], a[104:107], a[80:83], v[72:75]
    ds_read_b64_tr_b16 a[46:47], v229 offset:1664
    v_mfma_f32_16x16x32_bf16 v[88:91], a[104:107], a[84:87], v[88:91]
    ds_read_b128 a[12:15], v226 offset:6144
    v_mfma_f32_16x16x32_bf16 v[104:107], a[104:107], a[88:91], v[104:107]
    v_mfma_f32_16x16x32_bf16 v[120:123], a[104:107], a[92:95], v[120:123]
    buffer_load_dwordx4 v237, s[44:47], s67 offen offset:2048 lds
    v_mfma_f32_16x16x32_bf16 v[124:127], a[108:111], a[92:95], v[124:127]
    ds_read_b64_tr_b16 a[48:49], v228 offset:256
    v_mfma_f32_16x16x32_bf16 v[108:111], a[108:111], a[88:91], v[108:111]
    v_mfma_f32_16x16x32_bf16 v[92:95], a[108:111], a[84:87], v[92:95]
    ds_read_b64_tr_b16 a[50:51], v228 offset:1792
    v_mfma_f32_16x16x32_bf16 v[76:79], a[108:111], a[80:83], v[76:79]
    ds_read_b128 a[16:19], v226 offset:8192
    v_mfma_f32_16x16x32_bf16 v[60:63], a[108:111], a[76:79], v[60:63]
    v_mfma_f32_16x16x32_bf16 v[44:47], a[108:111], a[72:75], v[44:47]
    ds_read_b64_tr_b16 a[52:53], v229 offset:256
    v_mfma_f32_16x16x32_bf16 v[28:31], a[108:111], a[68:71], v[28:31]
    s_add_u32 m0, s68, s72
    v_mfma_f32_16x16x32_bf16 v[12:15], a[108:111], a[64:67], v[12:15]
    v_mfma_f32_16x16x32_bf16 v[128:131], a[64:67], a[112:115], v[128:131]
    s_add_u32 s80, s64, s66
    v_mfma_f32_16x16x32_bf16 v[132:135], a[68:71], a[112:115], v[132:135]
    buffer_load_dwordx4 v231, s[40:43], s80 offen lds
    v_mfma_f32_16x16x32_bf16 v[144:147], a[72:75], a[112:115], v[144:147]
    ds_read_b64_tr_b16 a[54:55], v229 offset:1792
    v_mfma_f32_16x16x32_bf16 v[148:151], a[76:79], a[112:115], v[148:151]
    v_mfma_f32_16x16x32_bf16 v[160:163], a[80:83], a[112:115], v[160:163]
    ds_read_b128 a[20:23], v226 offset:10240
    v_mfma_f32_16x16x32_bf16 v[164:167], a[84:87], a[112:115], v[164:167]
    ds_read_b128 a[24:27], v226 offset:12288
    v_mfma_f32_16x16x32_bf16 v[176:179], a[88:91], a[112:115], v[176:179]
    v_mfma_f32_16x16x32_bf16 v[180:183], a[92:95], a[112:115], v[180:183]
    ds_read_b128 a[28:31], v226 offset:14336
    v_mfma_f32_16x16x32_bf16 v[188:191], a[92:95], a[116:119], v[188:191]
    buffer_load_dwordx4 v232, s[40:43], s80 offen offset:1024 lds
    v_mfma_f32_16x16x32_bf16 v[184:187], a[88:91], a[116:119], v[184:187]
    v_mfma_f32_16x16x32_bf16 v[172:175], a[84:87], a[116:119], v[172:175]
    buffer_load_dwordx4 v233, s[40:43], s80 offen offset:2048 lds
    v_mfma_f32_16x16x32_bf16 v[168:171], a[80:83], a[116:119], v[168:171]
    buffer_load_dwordx4 v234, s[40:43], s80 offen offset:3072 lds
    v_mfma_f32_16x16x32_bf16 v[156:159], a[76:79], a[116:119], v[156:159]
    v_mfma_f32_16x16x32_bf16 v[152:155], a[72:75], a[116:119], v[152:155]
    s_add_u32 s71, s71, 1
    v_mfma_f32_16x16x32_bf16 v[140:143], a[68:71], a[116:119], v[140:143]
    s_bitcmp1_b32 80, s71
    v_mfma_f32_16x16x32_bf16 v[136:139], a[64:67], a[116:119], v[136:139]
    s_waitcnt vmcnt(14) lgkmcnt(0)
    s_barrier
    s_cbranch_scc1 G1_qkv_loop
    s_cmp_gt_u32 s71, 4
    s_cbranch_scc1 G1_qkv_hi
    s_branch G1_qkv_st
G1_qkv_nspin:
    buffer_load_dword v244, off, s[52:55], 0 sc1
    s_sleep 1
    s_sub_u32 s12, s12, 1
    s_cmp_gt_i32 s12, 0
    s_cbranch_scc0 G1_qkv_nok
    s_waitcnt vmcnt(0)
G1_qkv_st:
    v_readfirstlane_b32 s95, v244
    s_cmp_lg_u32 s95, 0
    s_cbranch_scc0 G1_qkv_nspin
G1_qkv_nok:
    s_cmp_lg_u32 s4, 0
    s_cbranch_scc1 G1_qkv_loop
    s_add_u32 s3, s15, 98304
    v_cmp_eq_u32 vcc, 0, v255
    v_mov_b32 v253, 0x80000000
    v_mov_b32_e64 v252, s95
    v_cndmask_b32 v253, v253, 0, vcc
    buffer_store_dword v252, v253, s[36:39], s3 offen sc1
    s_branch G1_qkv_loop
G1_qkv_hi:
    s_cmp_lg_u32 s71, 5
    s_cbranch_scc1 G1_qkv_chk
    buffer_load_dword v244, v249, s[36:39], s75 offen sc1
    buffer_load_dword v248, v245, s[48:51], s74 offen
    s_branch G1_qkv_loop
G1_qkv_spin:
    buffer_load_dword v244, v249, s[36:39], s75 offen sc1
    s_sleep 1
    s_sub_u32 s12, s12, 1
    s_cmp_gt_i32 s12, 0
    s_cbranch_scc0 G1_qkv_arrok
    s_waitcnt vmcnt(0)
G1_qkv_chk:
    v_cmp_eq_u32 vcc, s95, v244
    s_cmp_eq_u64 vcc, -1
    s_cbranch_scc0 G1_qkv_spin
G1_qkv_arrok:
G1_qkv_post:
    v_mfma_f32_16x16x32_bf16 v[0:3], a[32:35], a[0:3], v[0:3]
    s_lshl_b32 s3, s4, 8
    v_lshrrev_b32 v245, 2, v254
    v_mfma_f32_16x16x32_bf16 v[16:19], a[32:35], a[4:7], v[16:19]
    v_add_u32_e64 v245, s3, v245
    v_mfma_f32_16x16x32_bf16 v[32:35], a[32:35], a[8:11], v[32:35]
    v_lshlrev_b32_e64 v243, 1, v245
    v_mfma_f32_16x16x32_bf16 v[48:51], a[32:35], a[12:15], v[48:51]
    s_lshl_b32 s76, s7, 11
    v_mfma_f32_16x16x32_bf16 v[64:67], a[32:35], a[16:19], v[64:67]
    s_add_u32 s76, s76, 0x2800000
    v_mfma_f32_16x16x32_bf16 v[80:83], a[32:35], a[20:23], v[80:83]
    s_lshl_b32 s77, s9, 13
    v_mfma_f32_16x16x32_bf16 v[96:99], a[32:35], a[24:27], v[96:99]
    s_add_u32 s77, s77, 0x2810000
    v_mfma_f32_16x16x32_bf16 v[112:115], a[32:35], a[28:31], v[112:115]
    s_add_u32 s78, s77, 4096
    v_mfma_f32_16x16x32_bf16 v[116:119], a[36:39], a[28:31], v[116:119]
    ds_read_b64_tr_b16 a[96:97], v228 offset:16384
    v_mfma_f32_16x16x32_bf16 v[100:103], a[36:39], a[24:27], v[100:103]
    ds_read_b64_tr_b16 a[98:99], v228 offset:17920
    v_mfma_f32_16x16x32_bf16 v[84:87], a[36:39], a[20:23], v[84:87]
    ds_read_b128 a[64:67], v227 offset:0
    v_mfma_f32_16x16x32_bf16 v[68:71], a[36:39], a[16:19], v[68:71]
    ds_read_b64_tr_b16 a[100:101], v229 offset:16384
    v_mfma_f32_16x16x32_bf16 v[52:55], a[36:39], a[12:15], v[52:55]
    buffer_load_dwordx2 v[232:233], v243, s[36:39], s76 offen sc1
    v_mfma_f32_16x16x32_bf16 v[36:39], a[36:39], a[8:11], v[36:39]
    buffer_load_dword v234, v245, s[36:39], s77 offen offset:0 sc1
    ds_read_b64_tr_b16 a[102:103], v229 offset:17920
    v_mfma_f32_16x16x32_bf16 v[20:23], a[36:39], a[4:7], v[20:23]
    ds_read_b128 a[68:71], v227 offset:2048
    v_mfma_f32_16x16x32_bf16 v[4:7], a[36:39], a[0:3], v[4:7]
    ds_read_b64_tr_b16 a[104:105], v228 offset:16512
    v_mfma_f32_16x16x32_bf16 v[8:11], a[40:43], a[0:3], v[8:11]
    ds_read_b64_tr_b16 a[106:107], v228 offset:18048
    v_mfma_f32_16x16x32_bf16 v[24:27], a[40:43], a[4:7], v[24:27]
    buffer_load_dword v235, v245, s[36:39], s77 offen offset:1024 sc1
    v_mfma_f32_16x16x32_bf16 v[40:43], a[40:43], a[8:11], v[40:43]
    buffer_load_dword v236, v245, s[36:39], s77 offen offset:2048 sc1
    v_mfma_f32_16x16x32_bf16 v[56:59], a[40:43], a[12:15], v[56:59]
    ds_read_b128 a[72:75], v227 offset:4096
    v_mfma_f32_16x16x32_bf16 v[72:75], a[40:43], a[16:19], v[72:75]
    ds_read_b64_tr_b16 a[108:109], v229 offset:16512
    v_mfma_f32_16x16x32_bf16 v[88:91], a[40:43], a[20:23], v[88:91]
    ds_read_b64_tr_b16 a[110:111], v229 offset:18048
    v_mfma_f32_16x16x32_bf16 v[104:107], a[40:43], a[24:27], v[104:107]
    ds_read_b128 a[76:79], v227 offset:6144
    v_mfma_f32_16x16x32_bf16 v[120:123], a[40:43], a[28:31], v[120:123]
    buffer_load_dword v237, v245, s[36:39], s77 offen offset:3072 sc1
    v_mfma_f32_16x16x32_bf16 v[124:127], a[44:47], a[28:31], v[124:127]
    buffer_load_dword v238, v245, s[36:39], s78 offen offset:0 sc1
    v_mfma_f32_16x16x32_bf16 v[108:111], a[44:47], a[24:27], v[108:111]
    ds_read_b64_tr_b16 a[112:113], v228 offset:16640
    v_mfma_f32_16x16x32_bf16 v[92:95], a[44:47], a[20:23], v[92:95]
    ds_read_b64_tr_b16 a[114:115], v228 offset:18176
    ds_read_b128 a[80:83], v227 offset:8192
    v_mfma_f32_16x16x32_bf16 v[76:79], a[44:47], a[16:19], v[76:79]
    ds_read_b64_tr_b16 a[116:117], v229 offset:16640
    v_mfma_f32_16x16x32_bf16 v[60:63], a[44:47], a[12:15], v[60:63]
    buffer_load_dword v239, v245, s[36:39], s78 offen offset:1024 sc1
    v_mfma_f32_16x16x32_bf16 v[44:47], a[44:47], a[8:11], v[44:47]
    buffer_load_dword v240, v245, s[36:39], s78 offen offset:2048 sc1
    v_mfma_f32_16x16x32_bf16 v[28:31], a[44:47], a[4:7], v[28:31]
    ds_read_b64_tr_b16 a[118:119], v229 offset:18176
    v_mfma_f32_16x16x32_bf16 v[12:15], a[44:47], a[0:3], v[12:15]
    ds_read_b128 a[84:87], v227 offset:10240
    v_mfma_f32_16x16x32_bf16 v[128:131], a[0:3], a[48:51], v[128:131]
    ds_read_b128 a[88:91], v227 offset:12288
    v_mfma_f32_16x16x32_bf16 v[132:135], a[4:7], a[48:51], v[132:135]
    ds_read_b128 a[92:95], v227 offset:14336
    v_mfma_f32_16x16x32_bf16 v[144:147], a[8:11], a[48:51], v[144:147]
    buffer_load_dword v241, v245, s[36:39], s78 offen offset:3072 sc1
    v_mfma_f32_16x16x32_bf16 v[148:151], a[12:15], a[48:51], v[148:151]
    s_add_u32 s73, s73, 0x8000
    v_mfma_f32_16x16x32_bf16 v[160:163], a[16:19], a[48:51], v[160:163]
    s_cmp_eq_u32 s73, 0x18000
    v_mfma_f32_16x16x32_bf16 v[164:167], a[20:23], a[48:51], v[164:167]
    s_cselect_b32 s73, 0, s73
    v_mfma_f32_16x16x32_bf16 v[176:179], a[24:27], a[48:51], v[176:179]
    v_add_u32 v226, s73, v224
    v_mfma_f32_16x16x32_bf16 v[180:183], a[28:31], a[48:51], v[180:183]
    v_add_u32_e64 v227, s73, v225
    v_mfma_f32_16x16x32_bf16 v[188:191], a[28:31], a[52:55], v[188:191]
    v_mfma_f32_16x16x32_bf16 v[184:187], a[24:27], a[52:55], v[184:187]
    v_mfma_f32_16x16x32_bf16 v[172:175], a[20:23], a[52:55], v[172:175]
    v_mfma_f32_16x16x32_bf16 v[168:171], a[16:19], a[52:55], v[168:171]
    v_mfma_f32_16x16x32_bf16 v[156:159], a[12:15], a[52:55], v[156:159]
    v_mfma_f32_16x16x32_bf16 v[152:155], a[8:11], a[52:55], v[152:155]
    v_mfma_f32_16x16x32_bf16 v[140:143], a[4:7], a[52:55], v[140:143]
    v_mfma_f32_16x16x32_bf16 v[136:139], a[0:3], a[52:55], v[136:139]
    s_waitcnt vmcnt(16) lgkmcnt(0)
    s_barrier
    v_mfma_f32_16x16x32_bf16 v[0:3], a[96:99], a[64:67], v[0:3]
    ds_read_b64_tr_b16 a[32:33], v228 offset:32768
    v_mfma_f32_16x16x32_bf16 v[16:19], a[96:99], a[68:71], v[16:19]
    v_mfma_f32_16x16x32_bf16 v[32:35], a[96:99], a[72:75], v[32:35]
    ds_read_b64_tr_b16 a[34:35], v228 offset:34304
    v_mfma_f32_16x16x32_bf16 v[48:51], a[96:99], a[76:79], v[48:51]
    v_mfma_f32_16x16x32_bf16 v[64:67], a[96:99], a[80:83], v[64:67]
    ds_read_b128 a[0:3], v226 offset:0
    v_mfma_f32_16x16x32_bf16 v[80:83], a[96:99], a[84:87], v[80:83]
    v_mfma_f32_16x16x32_bf16 v[96:99], a[96:99], a[88:91], v[96:99]
    ds_read_b64_tr_b16 a[36:37], v229 offset:32768
    v_mfma_f32_16x16x32_bf16 v[112:115], a[96:99], a[92:95], v[112:115]
    v_mfma_f32_16x16x32_bf16 v[116:119], a[100:103], a[92:95], v[116:119]
    ds_read_b64_tr_b16 a[38:39], v229 offset:34304
    v_mfma_f32_16x16x32_bf16 v[100:103], a[100:103], a[88:91], v[100:103]
    v_mfma_f32_16x16x32_bf16 v[84:87], a[100:103], a[84:87], v[84:87]
    ds_read_b128 a[4:7], v226 offset:2048
    v_mfma_f32_16x16x32_bf16 v[68:71], a[100:103], a[80:83], v[68:71]
    v_mfma_f32_16x16x32_bf16 v[52:55], a[100:103], a[76:79], v[52:55]
    ds_read_b64_tr_b16 a[40:41], v228 offset:32896
    v_mfma_f32_16x16x32_bf16 v[36:39], a[100:103], a[72:75], v[36:39]
    v_mfma_f32_16x16x32_bf16 v[20:23], a[100:103], a[68:71], v[20:23]
    ds_read_b64_tr_b16 a[42:43], v228 offset:34432
    v_mfma_f32_16x16x32_bf16 v[4:7], a[100:103], a[64:67], v[4:7]
    v_mfma_f32_16x16x32_bf16 v[8:11], a[104:107], a[64:67], v[8:11]
    ds_read_b128 a[8:11], v226 offset:4096
    v_mfma_f32_16x16x32_bf16 v[24:27], a[104:107], a[68:71], v[24:27]
    v_mfma_f32_16x16x32_bf16 v[40:43], a[104:107], a[72:75], v[40:43]
    ds_read_b64_tr_b16 a[44:45], v229 offset:32896
    v_mfma_f32_16x16x32_bf16 v[56:59], a[104:107], a[76:79], v[56:59]
    v_mfma_f32_16x16x32_bf16 v[72:75], a[104:107], a[80:83], v[72:75]
    ds_read_b64_tr_b16 a[46:47], v229 offset:34432
    v_mfma_f32_16x16x32_bf16 v[88:91], a[104:107], a[84:87], v[88:91]
    v_mfma_f32_16x16x32_bf16 v[104:107], a[104:107], a[88:91], v[104:107]
    ds_read_b128 a[12:15], v226 offset:6144
    v_mfma_f32_16x16x32_bf16 v[120:123], a[104:107], a[92:95], v[120:123]
    v_mfma_f32_16x16x32_bf16 v[124:127], a[108:111], a[92:95], v[124:127]
    ds_read_b64_tr_b16 a[48:49], v228 offset:33024
    v_mfma_f32_16x16x32_bf16 v[108:111], a[108:111], a[88:91], v[108:111]
    v_mfma_f32_16x16x32_bf16 v[92:95], a[108:111], a[84:87], v[92:95]
    ds_read_b64_tr_b16 a[50:51], v228 offset:34560
    v_mfma_f32_16x16x32_bf16 v[76:79], a[108:111], a[80:83], v[76:79]
    v_mfma_f32_16x16x32_bf16 v[60:63], a[108:111], a[76:79], v[60:63]
    ds_read_b128 a[16:19], v226 offset:8192
    v_mfma_f32_16x16x32_bf16 v[44:47], a[108:111], a[72:75], v[44:47]
    v_mfma_f32_16x16x32_bf16 v[28:31], a[108:111], a[68:71], v[28:31]
    ds_read_b64_tr_b16 a[52:53], v229 offset:33024
    v_mfma_f32_16x16x32_bf16 v[12:15], a[108:111], a[64:67], v[12:15]
    v_mfma_f32_16x16x32_bf16 v[128:131], a[64:67], a[112:115], v[128:131]
    ds_read_b64_tr_b16 a[54:55], v229 offset:34560
    v_mfma_f32_16x16x32_bf16 v[132:135], a[68:71], a[112:115], v[132:135]
    v_mfma_f32_16x16x32_bf16 v[144:147], a[72:75], a[112:115], v[144:147]
    ds_read_b128 a[20:23], v226 offset:10240
    v_mfma_f32_16x16x32_bf16 v[148:151], a[76:79], a[112:115], v[148:151]
    v_mfma_f32_16x16x32_bf16 v[160:163], a[80:83], a[112:115], v[160:163]
    ds_read_b128 a[24:27], v226 offset:12288
    v_mfma_f32_16x16x32_bf16 v[164:167], a[84:87], a[112:115], v[164:167]
    v_mfma_f32_16x16x32_bf16 v[176:179], a[88:91], a[112:115], v[176:179]
    ds_read_b128 a[28:31], v226 offset:14336
    v_mfma_f32_16x16x32_bf16 v[180:183], a[92:95], a[112:115], v[180:183]
    v_mfma_f32_16x16x32_bf16 v[188:191], a[92:95], a[116:119], v[188:191]
    v_mfma_f32_16x16x32_bf16 v[184:187], a[88:91], a[116:119], v[184:187]
    v_mfma_f32_16x16x32_bf16 v[172:175], a[84:87], a[116:119], v[172:175]
    v_mfma_f32_16x16x32_bf16 v[168:171], a[80:83], a[116:119], v[168:171]
    v_mfma_f32_16x16x32_bf16 v[156:159], a[76:79], a[116:119], v[156:159]
    v_mfma_f32_16x16x32_bf16 v[152:155], a[72:75], a[116:119], v[152:155]
    v_mfma_f32_16x16x32_bf16 v[140:143], a[68:71], a[116:119], v[140:143]
    v_mfma_f32_16x16x32_bf16 v[136:139], a[64:67], a[116:119], v[136:139]
    s_waitcnt vmcnt(9) lgkmcnt(0)
    s_barrier
    v_mfma_f32_16x16x32_bf16 v[0:3], a[32:35], a[0:3], v[0:3]
    ds_read_b64_tr_b16 a[96:97], v228 offset:49152
    v_mfma_f32_16x16x32_bf16 v[16:19], a[32:35], a[4:7], v[16:19]
    ds_read_b64_tr_b16 a[98:99], v228 offset:50688
    v_mfma_f32_16x16x32_bf16 v[32:35], a[32:35], a[8:11], v[32:35]
    ds_read_b128 a[64:67], v227 offset:0
    v_mfma_f32_16x16x32_bf16 v[48:51], a[32:35], a[12:15], v[48:51]
    ds_read_b64_tr_b16 a[100:101], v229 offset:49152
    v_mfma_f32_16x16x32_bf16 v[64:67], a[32:35], a[16:19], v[64:67]
    ds_read_b64_tr_b16 a[102:103], v229 offset:50688
    v_mfma_f32_16x16x32_bf16 v[80:83], a[32:35], a[20:23], v[80:83]
    ds_read_b128 a[68:71], v227 offset:2048
    v_mfma_f32_16x16x32_bf16 v[96:99], a[32:35], a[24:27], v[96:99]
    ds_read_b64_tr_b16 a[104:105], v228 offset:49280
    v_mfma_f32_16x16x32_bf16 v[112:115], a[32:35], a[28:31], v[112:115]
    ds_read_b64_tr_b16 a[106:107], v228 offset:50816
    v_mfma_f32_16x16x32_bf16 v[116:119], a[36:39], a[28:31], v[116:119]
    ds_read_b128 a[72:75], v227 offset:4096
    v_mfma_f32_16x16x32_bf16 v[100:103], a[36:39], a[24:27], v[100:103]
    ds_read_b64_tr_b16 a[108:109], v229 offset:49280
    v_mfma_f32_16x16x32_bf16 v[84:87], a[36:39], a[20:23], v[84:87]
    ds_read_b64_tr_b16 a[110:111], v229 offset:50816
    v_mfma_f32_16x16x32_bf16 v[68:71], a[36:39], a[16:19], v[68:71]
    ds_read_b128 a[76:79], v227 offset:6144
    v_mfma_f32_16x16x32_bf16 v[52:55], a[36:39], a[12:15], v[52:55]
    ds_read_b64_tr_b16 a[112:113], v228 offset:49408
    v_mfma_f32_16x16x32_bf16 v[36:39], a[36:39], a[8:11], v[36:39]
    v_mfma_f32_16x16x32_bf16 v[20:23], a[36:39], a[4:7], v[20:23]
    ds_read_b64_tr_b16 a[114:115], v228 offset:50944
    v_mfma_f32_16x16x32_bf16 v[4:7], a[36:39], a[0:3], v[4:7]
    ds_read_b128 a[80:83], v227 offset:8192
    v_mfma_f32_16x16x32_bf16 v[8:11], a[40:43], a[0:3], v[8:11]
    ds_read_b64_tr_b16 a[116:117], v229 offset:49408
    v_mfma_f32_16x16x32_bf16 v[24:27], a[40:43], a[4:7], v[24:27]
    ds_read_b64_tr_b16 a[118:119], v229 offset:50944
    v_mfma_f32_16x16x32_bf16 v[40:43], a[40:43], a[8:11], v[40:43]
    ds_read_b128 a[84:87], v227 offset:10240
    v_mfma_f32_16x16x32_bf16 v[56:59], a[40:43], a[12:15], v[56:59]
    ds_read_b128 a[88:91], v227 offset:12288
    v_mfma_f32_16x16x32_bf16 v[72:75], a[40:43], a[16:19], v[72:75]
    ds_read_b128 a[92:95], v227 offset:14336
    v_mfma_f32_16x16x32_bf16 v[88:91], a[40:43], a[20:23], v[88:91]
    s_add_u32 s73, s73, 0x8000
    v_mfma_f32_16x16x32_bf16 v[104:107], a[40:43], a[24:27], v[104:107]
    s_cmp_eq_u32 s73, 0x18000
    v_mfma_f32_16x16x32_bf16 v[120:123], a[40:43], a[28:31], v[120:123]
    s_cselect_b32 s73, 0, s73
    v_mfma_f32_16x16x32_bf16 v[124:127], a[44:47], a[28:31], v[124:127]
    v_add_u32 v226, s73, v224
    v_mfma_f32_16x16x32_bf16 v[108:111], a[44:47], a[24:27], v[108:111]
    v_add_u32_e64 v227, s73, v225
    v_mfma_f32_16x16x32_bf16 v[92:95], a[44:47], a[20:23], v[92:95]
    v_mfma_f32_16x16x32_bf16 v[76:79], a[44:47], a[16:19], v[76:79]
    s_waitcnt vmcnt(0)
    v_mfma_f32_16x16x32_bf16 v[60:63], a[44:47], a[12:15], v[60:63]
    v_add_f32 v234, v234, v238
    v_mfma_f32_16x16x32_bf16 v[44:47], a[44:47], a[8:11], v[44:47]
    v_add_f32_e64 v235, v235, v239
    v_mfma_f32_16x16x32_bf16 v[28:31], a[44:47], a[4:7], v[28:31]
    v_add_f32_e64 v236, v236, v240
    v_mfma_f32_16x16x32_bf16 v[12:15], a[44:47], a[0:3], v[12:15]
    v_add_f32_e64 v237, v237, v241
    v_mfma_f32_16x16x32_bf16 v[128:131], a[0:3], a[48:51], v[128:131]
    v_add_f32_e64 v234, v234, v235
    v_mfma_f32_16x16x32_bf16 v[132:135], a[4:7], a[48:51], v[132:135]
    v_add_f32_e64 v236, v236, v237
    v_mfma_f32_16x16x32_bf16 v[144:147], a[8:11], a[48:51], v[144:147]
    v_add_u32 v245, 98304, v245
    v_mfma_f32_16x16x32_bf16 v[148:151], a[12:15], a[48:51], v[148:151]
    v_add_f32_e64 v234, v234, v236
    v_mfma_f32_16x16x32_bf16 v[160:163], a[16:19], a[48:51], v[160:163]
    ds_write_b32 v245, v232
    v_mfma_f32_16x16x32_bf16 v[164:167], a[20:23], a[48:51], v[164:167]
    ds_write_b32 v245, v233 offset:1024
    v_mfma_f32_16x16x32_bf16 v[176:179], a[24:27], a[48:51], v[176:179]
    ds_write_b32 v245, v234 offset:2048
    v_mfma_f32_16x16x32_bf16 v[180:183], a[28:31], a[48:51], v[180:183]
    v_mfma_f32_16x16x32_bf16 v[188:191], a[28:31], a[52:55], v[188:191]
    v_mfma_f32_16x16x32_bf16 v[184:187], a[24:27], a[52:55], v[184:187]
    v_mfma_f32_16x16x32_bf16 v[172:175], a[20:23], a[52:55], v[172:175]
    v_mfma_f32_16x16x32_bf16 v[168:171], a[16:19], a[52:55], v[168:171]
    v_mfma_f32_16x16x32_bf16 v[156:159], a[12:15], a[52:55], v[156:159]
    v_mfma_f32_16x16x32_bf16 v[152:155], a[8:11], a[52:55], v[152:155]
    v_mfma_f32_16x16x32_bf16 v[140:143], a[4:7], a[52:55], v[140:143]
    v_mfma_f32_16x16x32_bf16 v[136:139], a[0:3], a[52:55], v[136:139]
    s_waitcnt vmcnt(0) lgkmcnt(0)
    s_barrier
    v_mfma_f32_16x16x32_bf16 v[0:3], a[96:99], a[64:67], v[0:3]
    s_lshl_b32 s3, s10, 9
    s_add_u32 s3, s3, 98304
    v_mfma_f32_16x16x32_bf16 v[16:19], a[96:99], a[68:71], v[16:19]
    v_lshl_add_u32 v242, v251, 2, s3
    v_mfma_f32_16x16x32_bf16 v[32:35], a[96:99], a[72:75], v[32:35]
    s_lshl_b32 s3, s11, 7
    s_add_u32 s3, s3, 100352
    v_mfma_f32_16x16x32_bf16 v[48:51], a[96:99], a[76:79], v[48:51]
    v_lshl_add_u32 v243, v250, 4, s3
    v_mfma_f32_16x16x32_bf16 v[64:67], a[96:99], a[80:83], v[64:67]
    s_lshl_b32 s3, s10, 9
    v_mfma_f32_16x16x32_bf16 v[80:83], a[96:99], a[84:87], v[80:83]
    s_add_u32 s3, s3, 98304
    v_lshl_add_u32 v244, v250, 4, s3
    v_mfma_f32_16x16x32_bf16 v[96:99], a[96:99], a[88:91], v[96:99]
    s_lshl_b32 s3, s11, 7
    v_mfma_f32_16x16x32_bf16 v[112:115], a[96:99], a[92:95], v[112:115]
    s_add_u32 s3, s3, 100864
    v_mfma_f32_16x16x32_bf16 v[116:119], a[100:103], a[92:95], v[116:119]
    v_lshl_add_u32 v245, v251, 2, s3
    ds_read_b32 v192, v242 offset:0
    v_mfma_f32_16x16x32_bf16 v[100:103], a[100:103], a[88:91], v[100:103]
    ds_read_b32 v193, v242 offset:64
    v_mfma_f32_16x16x32_bf16 v[84:87], a[100:103], a[84:87], v[84:87]
    ds_read_b32 v194, v242 offset:128
    ds_read_b32 v195, v242 offset:192
    v_mfma_f32_16x16x32_bf16 v[68:71], a[100:103], a[80:83], v[68:71]
    ds_read_b32 v196, v242 offset:256
    v_mfma_f32_16x16x32_bf16 v[52:55], a[100:103], a[76:79], v[52:55]
    ds_read_b32 v197, v242 offset:320
    v_mfma_f32_16x16x32_bf16 v[36:39], a[100:103], a[72:75], v[36:39]
    ds_read_b32 v198, v242 offset:384
    ds_read_b32 v199, v242 offset:448
    v_mfma_f32_16x16x32_bf16 v[20:23], a[100:103], a[68:71], v[20:23]
    ds_read_b32 v200, v242 offset:1024
    v_mfma_f32_16x16x32_bf16 v[4:7], a[100:103], a[64:67], v[4:7]
    ds_read_b32 v201, v242 offset:1088
    v_mfma_f32_16x16x32_bf16 v[8:11], a[104:107], a[64:67], v[8:11]
    ds_read_b32 v202, v242 offset:1152
    ds_read_b32 v203, v242 offset:1216
    v_mfma_f32_16x16x32_bf16 v[24:27], a[104:107], a[68:71], v[24:27]
    ds_read_b32 v204, v242 offset:1280
    v_mfma_f32_16x16x32_bf16 v[40:43], a[104:107], a[72:75], v[40:43]
    ds_read_b32 v205, v242 offset:1344
    ds_read_b32 v206, v242 offset:1408
    v_mfma_f32_16x16x32_bf16 v[56:59], a[104:107], a[76:79], v[56:59]
    ds_read_b32 v207, v242 offset:1472
    v_mfma_f32_16x16x32_bf16 v[72:75], a[104:107], a[80:83], v[72:75]
    ds_read_b128 v[216:219], v243 offset:0
    v_mfma_f32_16x16x32_bf16 v[88:91], a[104:107], a[84:87], v[88:91]
    ds_read_b128 v[220:223], v243 offset:64
    ds_read_b128 v[224:227], v243 offset:256
    v_mfma_f32_16x16x32_bf16 v[104:107], a[104:107], a[88:91], v[104:107]
    ds_read_b128 v[228:231], v243 offset:320
    v_mfma_f32_16x16x32_bf16 v[120:123], a[104:107], a[92:95], v[120:123]
    ds_read_b32 v232, v245 offset:0
    v_mfma_f32_16x16x32_bf16 v[124:127], a[108:111], a[92:95], v[124:127]
    ds_read_b32 v233, v245 offset:64
    s_lshl_b32 s76, s9, 1
    v_mfma_f32_16x16x32_bf16 v[108:111], a[108:111], a[88:91], v[108:111]
    s_add_u32 s76, s76, s11
    v_mfma_f32_16x16x32_bf16 v[92:95], a[108:111], a[84:87], v[92:95]
    s_lshl_b32 s76, s76, 6
    s_lshl_b32 s3, s7, 3
    v_mfma_f32_16x16x32_bf16 v[76:79], a[108:111], a[80:83], v[76:79]
    s_add_u32 s76, s76, s3
    v_mfma_f32_16x16x32_bf16 v[60:63], a[108:111], a[76:79], v[60:63]
    s_lshl_b32 s3, s10, 2
    v_mfma_f32_16x16x32_bf16 v[44:47], a[108:111], a[72:75], v[44:47]
    s_add_u32 s76, s76, s3
    s_lshl_b32 s77, s76, 11
    v_mfma_f32_16x16x32_bf16 v[28:31], a[108:111], a[68:71], v[28:31]
    s_lshl_b32 s78, s76, 12
    v_mfma_f32_16x16x32_bf16 v[12:15], a[108:111], a[64:67], v[12:15]
    s_add_u32 s78, s78, 0x400000
    v_mfma_f32_16x16x32_bf16 v[128:131], a[64:67], a[112:115], v[128:131]
    v_lshlrev_b32 v248, 9, v250
    v_lshl_add_u32 v246, v251, 4, v248
    v_mfma_f32_16x16x32_bf16 v[132:135], a[68:71], a[112:115], v[132:135]
    v_lshrrev_b32_e64 v249, 3, v251
    v_mfma_f32_16x16x32_bf16 v[144:147], a[72:75], a[112:115], v[144:147]
    v_lshl_add_u32 v248, v249, 8, v248
    v_and_b32_e64 v249, 7, v251
    v_mfma_f32_16x16x32_bf16 v[148:151], a[76:79], a[112:115], v[148:151]
    v_lshl_add_u32 v247, v249, 4, v248
    v_mfma_f32_16x16x32_bf16 v[160:163], a[80:83], a[112:115], v[160:163]
    s_mov_b32 s86, 112
    v_mfma_f32_16x16x32_bf16 v[164:167], a[84:87], a[112:115], v[164:167]
    s_mov_b32 s85, 0
    s_mov_b32 s89, 99
    v_mfma_f32_16x16x32_bf16 v[176:179], a[88:91], a[112:115], v[176:179]
    s_mov_b32 s87, 0
    v_mfma_f32_16x16x32_bf16 v[180:183], a[92:95], a[112:115], v[180:183]
    s_mov_b32 s88, 0
    v_mfma_f32_16x16x32_bf16 v[188:191], a[92:95], a[116:119], v[188:191]
    v_mfma_f32_16x16x32_bf16 v[184:187], a[88:91], a[116:119], v[184:187]
    v_mfma_f32_16x16x32_bf16 v[172:175], a[84:87], a[116:119], v[172:175]
    v_mfma_f32_16x16x32_bf16 v[168:171], a[80:83], a[116:119], v[168:171]
    v_mfma_f32_16x16x32_bf16 v[156:159], a[76:79], a[116:119], v[156:159]
    v_mfma_f32_16x16x32_bf16 v[152:155], a[72:75], a[116:119], v[152:155]
    v_mfma_f32_16x16x32_bf16 v[140:143], a[68:71], a[116:119], v[140:143]
    v_mfma_f32_16x16x32_bf16 v[136:139], a[64:67], a[116:119], v[136:139]
    s_waitcnt lgkmcnt(0)
    v_mul_f32 v208, 0x3e8293ee, v200
    v_mul_f32 v209, 0x3e8293ee, v201
    v_mul_f32 v210, 0x3e8293ee, v202
    v_mul_f32 v211, 0x3e8293ee, v203
    v_mul_f32 v212, 0x3e8293ee, v204
    v_mul_f32 v213, 0x3e8293ee, v205
    v_mul_f32 v214, 0x3e8293ee, v206
    v_mul_f32 v215, 0x3e8293ee, v207
    v_pk_fma_f32 v[8:9], v[224:225], v[192:193], v[8:9] op_sel_hi:[1,0,1]
    v_pk_fma_f32 v[10:11], v[226:227], v[192:193], v[10:11] op_sel_hi:[1,0,1]
    v_pk_fma_f32 v[12:13], v[228:229], v[192:193], v[12:13] op_sel_hi:[1,0,1]
    v_pk_fma_f32 v[14:15], v[230:231], v[192:193], v[14:15] op_sel_hi:[1,0,1]
    v_pk_mul_f32 v[8:9], v[8:9], v[200:201] op_sel_hi:[1,0]
    v_pk_mul_f32 v[10:11], v[10:11], v[200:201] op_sel_hi:[1,0]
    v_pk_mul_f32 v[12:13], v[12:13], v[200:201] op_sel_hi:[1,0]
    v_pk_mul_f32 v[14:15], v[14:15], v[200:201] op_sel_hi:[1,0]
    v_cvt_pk_bf16_f32 v8, v8, v9
    v_cvt_pk_bf16_f32 v9, v10, v11
    v_cvt_pk_bf16_f32 v10, v12, v13
    v_cvt_pk_bf16_f32 v11, v14, v15
    s_add_u32 s3, s78, 0
    s_nop 0
    buffer_store_dwordx4 v[8:11], v247, s[36:39], s3 offen offset:0 sc1
    ds_read_b128 v[12:15], v244 offset:0
    v_pk_fma_f32 v[24:25], v[224:225], v[192:193], v[24:25] op_sel:[0,1,0] op_sel_hi:[1,1,1]
    v_pk_fma_f32 v[26:27], v[226:227], v[192:193], v[26:27] op_sel:[0,1,0] op_sel_hi:[1,1,1]
    v_pk_fma_f32 v[28:29], v[228:229], v[192:193], v[28:29] op_sel:[0,1,0] op_sel_hi:[1,1,1]
    v_pk_fma_f32 v[30:31], v[230:231], v[192:193], v[30:31] op_sel:[0,1,0] op_sel_hi:[1,1,1]
    v_pk_mul_f32 v[24:25], v[24:25], v[200:201] op_sel:[0,1] op_sel_hi:[1,1]
    v_pk_mul_f32 v[26:27], v[26:27], v[200:201] op_sel:[0,1] op_sel_hi:[1,1]
    v_pk_mul_f32 v[28:29], v[28:29], v[200:201] op_sel:[0,1] op_sel_hi:[1,1]
    v_pk_mul_f32 v[30:31], v[30:31], v[200:201] op_sel:[0,1] op_sel_hi:[1,1]
    v_cvt_pk_bf16_f32 v24, v24, v25
    v_cvt_pk_bf16_f32 v25, v26, v27
    v_cvt_pk_bf16_f32 v26, v28, v29
    v_cvt_pk_bf16_f32 v27, v30, v31
    buffer_store_dwordx4 v[24:27], v247, s[36:39], s3 offen offset:128 sc1
    ds_read_b128 v[28:31], v244 offset:64
    v_pk_fma_f32 v[40:41], v[224:225], v[194:195], v[40:41] op_sel_hi:[1,0,1]
    v_pk_fma_f32 v[42:43], v[226:227], v[194:195], v[42:43] op_sel_hi:[1,0,1]
    v_pk_fma_f32 v[44:45], v[228:229], v[194:195], v[44:45] op_sel_hi:[1,0,1]
    v_pk_fma_f32 v[46:47], v[230:231], v[194:195], v[46:47] op_sel_hi:[1,0,1]
    v_pk_mul_f32 v[40:41], v[40:41], v[202:203] op_sel_hi:[1,0]
    v_pk_mul_f32 v[42:43], v[42:43], v[202:203] op_sel_hi:[1,0]
    v_pk_mul_f32 v[44:45], v[44:45], v[202:203] op_sel_hi:[1,0]
    v_pk_mul_f32 v[46:47], v[46:47], v[202:203] op_sel_hi:[1,0]
    v_cvt_pk_bf16_f32 v40, v40, v41
    v_cvt_pk_bf16_f32 v41, v42, v43
    v_cvt_pk_bf16_f32 v42, v44, v45
    v_cvt_pk_bf16_f32 v43, v46, v47
    s_add_u32 s3, s78, 4096
    buffer_store_dwordx4 v[40:43], v247, s[36:39], s3 offen offset:0 sc1
    ds_read_b128 v[44:47], v244 offset:128
    v_pk_fma_f32 v[56:57], v[224:225], v[194:195], v[56:57] op_sel:[0,1,0] op_sel_hi:[1,1,1]
    v_pk_fma_f32 v[58:59], v[226:227], v[194:195], v[58:59] op_sel:[0,1,0] op_sel_hi:[1,1,1]
    v_pk_fma_f32 v[60:61], v[228:229], v[194:195], v[60:61] op_sel:[0,1,0] op_sel_hi:[1,1,1]
    v_pk_fma_f32 v[62:63], v[230:231], v[194:195], v[62:63] op_sel:[0,1,0] op_sel_hi:[1,1,1]
    v_pk_mul_f32 v[56:57], v[56:57], v[202:203] op_sel:[0,1] op_sel_hi:[1,1]
    v_pk_mul_f32 v[58:59], v[58:59], v[202:203] op_sel:[0,1] op_sel_hi:[1,1]
    v_pk_mul_f32 v[60:61], v[60:61], v[202:203] op_sel:[0,1] op_sel_hi:[1,1]
    v_pk_mul_f32 v[62:63], v[62:63], v[202:203] op_sel:[0,1] op_sel_hi:[1,1]
    v_cvt_pk_bf16_f32 v56, v56, v57
    v_cvt_pk_bf16_f32 v57, v58, v59
    v_cvt_pk_bf16_f32 v58, v60, v61
    v_cvt_pk_bf16_f32 v59, v62, v63
    buffer_store_dwordx4 v[56:59], v247, s[36:39], s3 offen offset:128 sc1
    ds_read_b128 v[60:63], v244 offset:192
    v_pk_fma_f32 v[72:73], v[224:225], v[196:197], v[72:73] op_sel_hi:[1,0,1]
    v_pk_fma_f32 v[74:75], v[226:227], v[196:197], v[74:75] op_sel_hi:[1,0,1]
    v_pk_fma_f32 v[76:77], v[228:229], v[196:197], v[76:77] op_sel_hi:[1,0,1]
    v_pk_fma_f32 v[78:79], v[230:231], v[196:197], v[78:79] op_sel_hi:[1,0,1]
    v_pk_mul_f32 v[72:73], v[72:73], v[204:205] op_sel_hi:[1,0]
    v_pk_mul_f32 v[74:75], v[74:75], v[204:205] op_sel_hi:[1,0]
    v_pk_mul_f32 v[76:77], v[76:77], v[204:205] op_sel_hi:[1,0]
    v_pk_mul_f32 v[78:79], v[78:79], v[204:205] op_sel_hi:[1,0]
    v_cvt_pk_bf16_f32 v72, v72, v73
    v_cvt_pk_bf16_f32 v73, v74, v75
    v_cvt_pk_bf16_f32 v74, v76, v77
    v_cvt_pk_bf16_f32 v75, v78, v79
    s_add_u32 s3, s78, 8192
    buffer_store_dwordx4 v[72:75], v247, s[36:39], s3 offen offset:0 sc1
    ds_read_b128 v[76:79], v244 offset:256
    v_pk_fma_f32 v[88:89], v[224:225], v[196:197], v[88:89] op_sel:[0,1,0] op_sel_hi:[1,1,1]
    v_pk_fma_f32 v[90:91], v[226:227], v[196:197], v[90:91] op_sel:[0,1,0] op_sel_hi:[1,1,1]
    v_pk_fma_f32 v[92:93], v[228:229], v[196:197], v[92:93] op_sel:[0,1,0] op_sel_hi:[1,1,1]
    v_pk_fma_f32 v[94:95], v[230:231], v[196:197], v[94:95] op_sel:[0,1,0] op_sel_hi:[1,1,1]
    v_pk_mul_f32 v[88:89], v[88:89], v[204:205] op_sel:[0,1] op_sel_hi:[1,1]
    v_pk_mul_f32 v[90:91], v[90:91], v[204:205] op_sel:[0,1] op_sel_hi:[1,1]
    v_pk_mul_f32 v[92:93], v[92:93], v[204:205] op_sel:[0,1] op_sel_hi:[1,1]
    v_pk_mul_f32 v[94:95], v[94:95], v[204:205] op_sel:[0,1] op_sel_hi:[1,1]
    v_cvt_pk_bf16_f32 v88, v88, v89
    v_cvt_pk_bf16_f32 v89, v90, v91
    v_cvt_pk_bf16_f32 v90, v92, v93
    v_cvt_pk_bf16_f32 v91, v94, v95
    buffer_store_dwordx4 v[88:91], v247, s[36:39], s3 offen offset:128 sc1
    ds_read_b128 v[92:95], v244 offset:320
    v_pk_fma_f32 v[104:105], v[224:225], v[198:199], v[104:105] op_sel_hi:[1,0,1]
    v_pk_fma_f32 v[106:107], v[226:227], v[198:199], v[106:107] op_sel_hi:[1,0,1]
    v_pk_fma_f32 v[108:109], v[228:229], v[198:199], v[108:109] op_sel_hi:[1,0,1]
    v_pk_fma_f32 v[110:111], v[230:231], v[198:199], v[110:111] op_sel_hi:[1,0,1]
    v_pk_mul_f32 v[104:105], v[104:105], v[206:207] op_sel_hi:[1,0]
    v_pk_mul_f32 v[106:107], v[106:107], v[206:207] op_sel_hi:[1,0]
    v_pk_mul_f32 v[108:109], v[108:109], v[206:207] op_sel_hi:[1,0]
    v_pk_mul_f32 v[110:111], v[110:111], v[206:207] op_sel_hi:[1,0]
    v_cvt_pk_bf16_f32 v104, v104, v105
    v_cvt_pk_bf16_f32 v105, v106, v107
    v_cvt_pk_bf16_f32 v106, v108, v109
    v_cvt_pk_bf16_f32 v107, v110, v111
    s_add_u32 s3, s78, 12288
    buffer_store_dwordx4 v[104:107], v247, s[36:39], s3 offen offset:0 sc1
    ds_read_b128 v[108:111], v244 offset:384
    v_pk_fma_f32 v[120:121], v[224:225], v[198:199], v[120:121] op_sel:[0,1,0] op_sel_hi:[1,1,1]
    v_pk_fma_f32 v[122:123], v[226:227], v[198:199], v[122:123] op_sel:[0,1,0] op_sel_hi:[1,1,1]
    v_pk_fma_f32 v[124:125], v[228:229], v[198:199], v[124:125] op_sel:[0,1,0] op_sel_hi:[1,1,1]
    v_pk_fma_f32 v[126:127], v[230:231], v[198:199], v[126:127] op_sel:[0,1,0] op_sel_hi:[1,1,1]
    v_pk_mul_f32 v[120:121], v[120:121], v[206:207] op_sel:[0,1] op_sel_hi:[1,1]
    v_pk_mul_f32 v[122:123], v[122:123], v[206:207] op_sel:[0,1] op_sel_hi:[1,1]
    v_pk_mul_f32 v[124:125], v[124:125], v[206:207] op_sel:[0,1] op_sel_hi:[1,1]
    v_pk_mul_f32 v[126:127], v[126:127], v[206:207] op_sel:[0,1] op_sel_hi:[1,1]
    v_cvt_pk_bf16_f32 v120, v120, v121
    v_cvt_pk_bf16_f32 v121, v122, v123
    v_cvt_pk_bf16_f32 v122, v124, v125
    v_cvt_pk_bf16_f32 v123, v126, v127
    buffer_store_dwordx4 v[120:123], v247, s[36:39], s3 offen offset:128 sc1
    ds_read_b128 v[124:127], v244 offset:448
    v_pk_fma_f32 v[0:1], v[216:217], v[192:193], v[0:1] op_sel_hi:[1,0,1]
    v_pk_fma_f32 v[2:3], v[218:219], v[192:193], v[2:3] op_sel_hi:[1,0,1]
    v_pk_fma_f32 v[4:5], v[220:221], v[192:193], v[4:5] op_sel_hi:[1,0,1]
    v_pk_fma_f32 v[6:7], v[222:223], v[192:193], v[6:7] op_sel_hi:[1,0,1]
    v_pk_mul_f32 v[0:1], v[0:1], v[208:209] op_sel_hi:[1,0]
    v_pk_mul_f32 v[2:3], v[2:3], v[208:209] op_sel_hi:[1,0]
    v_pk_mul_f32 v[4:5], v[4:5], v[208:209] op_sel_hi:[1,0]
    v_pk_mul_f32 v[6:7], v[6:7], v[208:209] op_sel_hi:[1,0]
    v_cvt_pk_bf16_f32 v0, v0, v1
    v_cvt_pk_bf16_f32 v1, v2, v3
    v_cvt_pk_bf16_f32 v2, v4, v5
    v_cvt_pk_bf16_f32 v3, v6, v7
    s_add_u32 s3, s77, 0
    s_nop 0
    buffer_store_dwordx4 v[0:3], v246, s[36:39], s3 offen offset:0 sc1
    ds_read_b128 v[4:7], v244 offset:1024
    v_pk_fma_f32 v[16:17], v[216:217], v[192:193], v[16:17] op_sel:[0,1,0] op_sel_hi:[1,1,1]
    v_pk_fma_f32 v[18:19], v[218:219], v[192:193], v[18:19] op_sel:[0,1,0] op_sel_hi:[1,1,1]
    v_pk_fma_f32 v[20:21], v[220:221], v[192:193], v[20:21] op_sel:[0,1,0] op_sel_hi:[1,1,1]
    v_pk_fma_f32 v[22:23], v[222:223], v[192:193], v[22:23] op_sel:[0,1,0] op_sel_hi:[1,1,1]
    v_pk_mul_f32 v[16:17], v[16:17], v[208:209] op_sel:[0,1] op_sel_hi:[1,1]
    v_pk_mul_f32 v[18:19], v[18:19], v[208:209] op_sel:[0,1] op_sel_hi:[1,1]
    v_pk_mul_f32 v[20:21], v[20:21], v[208:209] op_sel:[0,1] op_sel_hi:[1,1]
    v_pk_mul_f32 v[22:23], v[22:23], v[208:209] op_sel:[0,1] op_sel_hi:[1,1]
    v_cvt_pk_bf16_f32 v16, v16, v17
    v_cvt_pk_bf16_f32 v17, v18, v19
    v_cvt_pk_bf16_f32 v18, v20, v21
    v_cvt_pk_bf16_f32 v19, v22, v23
    buffer_store_dwordx4 v[16:19], v246, s[36:39], s3 offen offset:256 sc1
    ds_read_b128 v[20:23], v244 offset:1088
    v_pk_fma_f32 v[32:33], v[216:217], v[194:195], v[32:33] op_sel_hi:[1,0,1]
    v_pk_fma_f32 v[34:35], v[218:219], v[194:195], v[34:35] op_sel_hi:[1,0,1]
    v_pk_fma_f32 v[36:37], v[220:221], v[194:195], v[36:37] op_sel_hi:[1,0,1]
    v_pk_fma_f32 v[38:39], v[222:223], v[194:195], v[38:39] op_sel_hi:[1,0,1]
    v_pk_mul_f32 v[32:33], v[32:33], v[210:211] op_sel_hi:[1,0]
    v_pk_mul_f32 v[34:35], v[34:35], v[210:211] op_sel_hi:[1,0]
    v_pk_mul_f32 v[36:37], v[36:37], v[210:211] op_sel_hi:[1,0]
    v_pk_mul_f32 v[38:39], v[38:39], v[210:211] op_sel_hi:[1,0]
    v_cvt_pk_bf16_f32 v32, v32, v33
    v_cvt_pk_bf16_f32 v33, v34, v35
    v_cvt_pk_bf16_f32 v34, v36, v37
    v_cvt_pk_bf16_f32 v35, v38, v39
    s_add_u32 s3, s77, 2048
    buffer_store_dwordx4 v[32:35], v246, s[36:39], s3 offen offset:0 sc1
    ds_read_b128 v[36:39], v244 offset:1152
    v_pk_fma_f32 v[48:49], v[216:217], v[194:195], v[48:49] op_sel:[0,1,0] op_sel_hi:[1,1,1]
    v_pk_fma_f32 v[50:51], v[218:219], v[194:195], v[50:51] op_sel:[0,1,0] op_sel_hi:[1,1,1]
    v_pk_fma_f32 v[52:53], v[220:221], v[194:195], v[52:53] op_sel:[0,1,0] op_sel_hi:[1,1,1]
    v_pk_fma_f32 v[54:55], v[222:223], v[194:195], v[54:55] op_sel:[0,1,0] op_sel_hi:[1,1,1]
    v_pk_mul_f32 v[48:49], v[48:49], v[210:211] op_sel:[0,1] op_sel_hi:[1,1]
    v_pk_mul_f32 v[50:51], v[50:51], v[210:211] op_sel:[0,1] op_sel_hi:[1,1]
    v_pk_mul_f32 v[52:53], v[52:53], v[210:211] op_sel:[0,1] op_sel_hi:[1,1]
    v_pk_mul_f32 v[54:55], v[54:55], v[210:211] op_sel:[0,1] op_sel_hi:[1,1]
    v_cvt_pk_bf16_f32 v48, v48, v49
    v_cvt_pk_bf16_f32 v49, v50, v51
    v_cvt_pk_bf16_f32 v50, v52, v53
    v_cvt_pk_bf16_f32 v51, v54, v55
    buffer_store_dwordx4 v[48:51], v246, s[36:39], s3 offen offset:256 sc1
    ds_read_b128 v[52:55], v244 offset:1216
    v_pk_fma_f32 v[64:65], v[216:217], v[196:197], v[64:65] op_sel_hi:[1,0,1]
    v_pk_fma_f32 v[66:67], v[218:219], v[196:197], v[66:67] op_sel_hi:[1,0,1]
    v_pk_fma_f32 v[68:69], v[220:221], v[196:197], v[68:69] op_sel_hi:[1,0,1]
    v_pk_fma_f32 v[70:71], v[222:223], v[196:197], v[70:71] op_sel_hi:[1,0,1]
    v_pk_mul_f32 v[64:65], v[64:65], v[212:213] op_sel_hi:[1,0]
    v_pk_mul_f32 v[66:67], v[66:67], v[212:213] op_sel_hi:[1,0]
    v_pk_mul_f32 v[68:69], v[68:69], v[212:213] op_sel_hi:[1,0]
    v_pk_mul_f32 v[70:71], v[70:71], v[212:213] op_sel_hi:[1,0]
    v_cvt_pk_bf16_f32 v64, v64, v65
    v_cvt_pk_bf16_f32 v65, v66, v67
    v_cvt_pk_bf16_f32 v66, v68, v69
    v_cvt_pk_bf16_f32 v67, v70, v71
    s_add_u32 s3, s77, 4096
    buffer_store_dwordx4 v[64:67], v246, s[36:39], s3 offen offset:0 sc1
    ds_read_b128 v[68:71], v244 offset:1280
    v_pk_fma_f32 v[80:81], v[216:217], v[196:197], v[80:81] op_sel:[0,1,0] op_sel_hi:[1,1,1]
    v_pk_fma_f32 v[82:83], v[218:219], v[196:197], v[82:83] op_sel:[0,1,0] op_sel_hi:[1,1,1]
    v_pk_fma_f32 v[84:85], v[220:221], v[196:197], v[84:85] op_sel:[0,1,0] op_sel_hi:[1,1,1]
    v_pk_fma_f32 v[86:87], v[222:223], v[196:197], v[86:87] op_sel:[0,1,0] op_sel_hi:[1,1,1]
    v_pk_mul_f32 v[80:81], v[80:81], v[212:213] op_sel:[0,1] op_sel_hi:[1,1]
    v_pk_mul_f32 v[82:83], v[82:83], v[212:213] op_sel:[0,1] op_sel_hi:[1,1]
    v_pk_mul_f32 v[84:85], v[84:85], v[212:213] op_sel:[0,1] op_sel_hi:[1,1]
    v_pk_mul_f32 v[86:87], v[86:87], v[212:213] op_sel:[0,1] op_sel_hi:[1,1]
    v_cvt_pk_bf16_f32 v80, v80, v81
    v_cvt_pk_bf16_f32 v81, v82, v83
    v_cvt_pk_bf16_f32 v82, v84, v85
    v_cvt_pk_bf16_f32 v83, v86, v87
    buffer_store_dwordx4 v[80:83], v246, s[36:39], s3 offen offset:256 sc1
    ds_read_b128 v[84:87], v244 offset:1344
    v_pk_fma_f32 v[96:97], v[216:217], v[198:199], v[96:97] op_sel_hi:[1,0,1]
    v_pk_fma_f32 v[98:99], v[218:219], v[198:199], v[98:99] op_sel_hi:[1,0,1]
    v_pk_fma_f32 v[100:101], v[220:221], v[198:199], v[100:101] op_sel_hi:[1,0,1]
    v_pk_fma_f32 v[102:103], v[222:223], v[198:199], v[102:103] op_sel_hi:[1,0,1]
    v_pk_mul_f32 v[96:97], v[96:97], v[214:215] op_sel_hi:[1,0]
    v_pk_mul_f32 v[98:99], v[98:99], v[214:215] op_sel_hi:[1,0]
    v_pk_mul_f32 v[100:101], v[100:101], v[214:215] op_sel_hi:[1,0]
    v_pk_mul_f32 v[102:103], v[102:103], v[214:215] op_sel_hi:[1,0]
    v_cvt_pk_bf16_f32 v96, v96, v97
    v_cvt_pk_bf16_f32 v97, v98, v99
    v_cvt_pk_bf16_f32 v98, v100, v101
    v_cvt_pk_bf16_f32 v99, v102, v103
    s_add_u32 s3, s77, 6144
    buffer_store_dwordx4 v[96:99], v246, s[36:39], s3 offen offset:0 sc1
    ds_read_b128 v[100:103], v244 offset:1408
    v_pk_fma_f32 v[112:113], v[216:217], v[198:199], v[112:113] op_sel:[0,1,0] op_sel_hi:[1,1,1]
    v_pk_fma_f32 v[114:115], v[218:219], v[198:199], v[114:115] op_sel:[0,1,0] op_sel_hi:[1,1,1]
    v_pk_fma_f32 v[116:117], v[220:221], v[198:199], v[116:117] op_sel:[0,1,0] op_sel_hi:[1,1,1]
    v_pk_fma_f32 v[118:119], v[222:223], v[198:199], v[118:119] op_sel:[0,1,0] op_sel_hi:[1,1,1]
    v_pk_mul_f32 v[112:113], v[112:113], v[214:215] op_sel:[0,1] op_sel_hi:[1,1]
    v_pk_mul_f32 v[114:115], v[114:115], v[214:215] op_sel:[0,1] op_sel_hi:[1,1]
    v_pk_mul_f32 v[116:117], v[116:117], v[214:215] op_sel:[0,1] op_sel_hi:[1,1]
    v_pk_mul_f32 v[118:119], v[118:119], v[214:215] op_sel:[0,1] op_sel_hi:[1,1]
    v_cvt_pk_bf16_f32 v112, v112, v113
    v_cvt_pk_bf16_f32 v113, v114, v115
    v_cvt_pk_bf16_f32 v114, v116, v117
    v_cvt_pk_bf16_f32 v115, v118, v119
    buffer_store_dwordx4 v[112:115], v246, s[36:39], s3 offen offset:256 sc1
    ds_read_b128 v[116:119], v244 offset:1472
    s_waitcnt lgkmcnt(0)
    s_nop 0
    v_pk_fma_f32 v[128:129], v[12:13], v[232:233], v[128:129] op_sel_hi:[1,0,1]
    v_pk_fma_f32 v[130:131], v[14:15], v[232:233], v[130:131] op_sel_hi:[1,0,1]
    v_pk_mul_f32 v[128:129], v[128:129], v[4:5]
    v_pk_mul_f32 v[130:131], v[130:131], v[6:7]
    v_pk_fma_f32 v[132:133], v[28:29], v[232:233], v[132:133] op_sel_hi:[1,0,1]
    v_pk_fma_f32 v[134:135], v[30:31], v[232:233], v[134:135] op_sel_hi:[1,0,1]
    v_pk_mul_f32 v[132:133], v[132:133], v[20:21]
    v_pk_mul_f32 v[134:135], v[134:135], v[22:23]
    v_cvt_pk_bf16_f32 v128, v128, v129
    v_cvt_pk_bf16_f32 v129, v130, v131
    v_cvt_pk_bf16_f32 v130, v132, v133
    v_cvt_pk_bf16_f32 v131, v134, v135
    s_add_u32 s3, s78, 0
    s_nop 0
    buffer_store_dwordx4 v[128:131], v246, s[36:39], s3 offen offset:2048 sc1
    v_pk_fma_f32 v[136:137], v[12:13], v[232:233], v[136:137] op_sel:[0,1,0] op_sel_hi:[1,1,1]
    v_pk_fma_f32 v[138:139], v[14:15], v[232:233], v[138:139] op_sel:[0,1,0] op_sel_hi:[1,1,1]
    v_pk_mul_f32 v[136:137], v[136:137], v[4:5]
    v_pk_mul_f32 v[138:139], v[138:139], v[6:7]
    v_pk_fma_f32 v[140:141], v[28:29], v[232:233], v[140:141] op_sel:[0,1,0] op_sel_hi:[1,1,1]
    v_pk_fma_f32 v[142:143], v[30:31], v[232:233], v[142:143] op_sel:[0,1,0] op_sel_hi:[1,1,1]
    v_pk_mul_f32 v[140:141], v[140:141], v[20:21]
    v_pk_mul_f32 v[142:143], v[142:143], v[22:23]
    v_cvt_pk_bf16_f32 v136, v136, v137
    v_cvt_pk_bf16_f32 v137, v138, v139
    v_cvt_pk_bf16_f32 v138, v140, v141
    v_cvt_pk_bf16_f32 v139, v142, v143
    buffer_store_dwordx4 v[136:139], v246, s[36:39], s3 offen offset:2304 sc1
    v_pk_fma_f32 v[144:145], v[44:45], v[232:233], v[144:145] op_sel_hi:[1,0,1]
    v_pk_fma_f32 v[146:147], v[46:47], v[232:233], v[146:147] op_sel_hi:[1,0,1]
    v_pk_mul_f32 v[144:145], v[144:145], v[36:37]
    v_pk_mul_f32 v[146:147], v[146:147], v[38:39]
    v_pk_fma_f32 v[148:149], v[60:61], v[232:233], v[148:149] op_sel_hi:[1,0,1]
    v_pk_fma_f32 v[150:151], v[62:63], v[232:233], v[150:151] op_sel_hi:[1,0,1]
    v_pk_mul_f32 v[148:149], v[148:149], v[52:53]
    v_pk_mul_f32 v[150:151], v[150:151], v[54:55]
    v_cvt_pk_bf16_f32 v144, v144, v145
    v_cvt_pk_bf16_f32 v145, v146, v147
    v_cvt_pk_bf16_f32 v146, v148, v149
    v_cvt_pk_bf16_f32 v147, v150, v151
    s_add_u32 s3, s78, 4096
    buffer_store_dwordx4 v[144:147], v246, s[36:39], s3 offen offset:2048 sc1
    v_pk_fma_f32 v[152:153], v[44:45], v[232:233], v[152:153] op_sel:[0,1,0] op_sel_hi:[1,1,1]
    v_pk_fma_f32 v[154:155], v[46:47], v[232:233], v[154:155] op_sel:[0,1,0] op_sel_hi:[1,1,1]
    v_pk_mul_f32 v[152:153], v[152:153], v[36:37]
    v_pk_mul_f32 v[154:155], v[154:155], v[38:39]
    v_pk_fma_f32 v[156:157], v[60:61], v[232:233], v[156:157] op_sel:[0,1,0] op_sel_hi:[1,1,1]
    v_pk_fma_f32 v[158:159], v[62:63], v[232:233], v[158:159] op_sel:[0,1,0] op_sel_hi:[1,1,1]
    v_pk_mul_f32 v[156:157], v[156:157], v[52:53]
    v_pk_mul_f32 v[158:159], v[158:159], v[54:55]
    v_cvt_pk_bf16_f32 v152, v152, v153
    v_cvt_pk_bf16_f32 v153, v154, v155
    v_cvt_pk_bf16_f32 v154, v156, v157
    v_cvt_pk_bf16_f32 v155, v158, v159
    buffer_store_dwordx4 v[152:155], v246, s[36:39], s3 offen offset:2304 sc1
    v_pk_fma_f32 v[160:161], v[76:77], v[232:233], v[160:161] op_sel_hi:[1,0,1]
    v_pk_fma_f32 v[162:163], v[78:79], v[232:233], v[162:163] op_sel_hi:[1,0,1]
    v_pk_mul_f32 v[160:161], v[160:161], v[68:69]
    v_pk_mul_f32 v[162:163], v[162:163], v[70:71]
    v_pk_fma_f32 v[164:165], v[92:93], v[232:233], v[164:165] op_sel_hi:[1,0,1]
    v_pk_fma_f32 v[166:167], v[94:95], v[232:233], v[166:167] op_sel_hi:[1,0,1]
    v_pk_mul_f32 v[164:165], v[164:165], v[84:85]
    v_pk_mul_f32 v[166:167], v[166:167], v[86:87]
    v_cvt_pk_bf16_f32 v160, v160, v161
    v_cvt_pk_bf16_f32 v161, v162, v163
    v_cvt_pk_bf16_f32 v162, v164, v165
    v_cvt_pk_bf16_f32 v163, v166, v167
    s_add_u32 s3, s78, 8192
    buffer_store_dwordx4 v[160:163], v246, s[36:39], s3 offen offset:2048 sc1
    v_pk_fma_f32 v[168:169], v[76:77], v[232:233], v[168:169] op_sel:[0,1,0] op_sel_hi:[1,1,1]
    v_pk_fma_f32 v[170:171], v[78:79], v[232:233], v[170:171] op_sel:[0,1,0] op_sel_hi:[1,1,1]
    v_pk_mul_f32 v[168:169], v[168:169], v[68:69]
    v_pk_mul_f32 v[170:171], v[170:171], v[70:71]
    v_pk_fma_f32 v[172:173], v[92:93], v[232:233], v[172:173] op_sel:[0,1,0] op_sel_hi:[1,1,1]
    v_pk_fma_f32 v[174:175], v[94:95], v[232:233], v[174:175] op_sel:[0,1,0] op_sel_hi:[1,1,1]
    v_pk_mul_f32 v[172:173], v[172:173], v[84:85]
    v_pk_mul_f32 v[174:175], v[174:175], v[86:87]
    v_cvt_pk_bf16_f32 v168, v168, v169
    v_cvt_pk_bf16_f32 v169, v170, v171
    v_cvt_pk_bf16_f32 v170, v172, v173
    v_cvt_pk_bf16_f32 v171, v174, v175
    buffer_store_dwordx4 v[168:171], v246, s[36:39], s3 offen offset:2304 sc1
    v_pk_fma_f32 v[176:177], v[108:109], v[232:233], v[176:177] op_sel_hi:[1,0,1]
    v_pk_fma_f32 v[178:179], v[110:111], v[232:233], v[178:179] op_sel_hi:[1,0,1]
    v_pk_mul_f32 v[176:177], v[176:177], v[100:101]
    v_pk_mul_f32 v[178:179], v[178:179], v[102:103]
    v_pk_fma_f32 v[180:181], v[124:125], v[232:233], v[180:181] op_sel_hi:[1,0,1]
    v_pk_fma_f32 v[182:183], v[126:127], v[232:233], v[182:183] op_sel_hi:[1,0,1]
    v_pk_mul_f32 v[180:181], v[180:181], v[116:117]
    v_pk_mul_f32 v[182:183], v[182:183], v[118:119]
    v_cvt_pk_bf16_f32 v176, v176, v177
    v_cvt_pk_bf16_f32 v177, v178, v179
    v_cvt_pk_bf16_f32 v178, v180, v181
    v_cvt_pk_bf16_f32 v179, v182, v183
    s_add_u32 s3, s78, 12288
    buffer_store_dwordx4 v[176:179], v246, s[36:39], s3 offen offset:2048 sc1
    v_pk_fma_f32 v[184:185], v[108:109], v[232:233], v[184:185] op_sel:[0,1,0] op_sel_hi:[1,1,1]
    v_pk_fma_f32 v[186:187], v[110:111], v[232:233], v[186:187] op_sel:[0,1,0] op_sel_hi:[1,1,1]
    v_pk_mul_f32 v[184:185], v[184:185], v[100:101]
    v_pk_mul_f32 v[186:187], v[186:187], v[102:103]
    v_pk_fma_f32 v[188:189], v[124:125], v[232:233], v[188:189] op_sel:[0,1,0] op_sel_hi:[1,1,1]
    v_pk_fma_f32 v[190:191], v[126:127], v[232:233], v[190:191] op_sel:[0,1,0] op_sel_hi:[1,1,1]
    v_pk_mul_f32 v[188:189], v[188:189], v[116:117]
    v_pk_mul_f32 v[190:191], v[190:191], v[118:119]
    v_cvt_pk_bf16_f32 v184, v184, v185
    v_cvt_pk_bf16_f32 v185, v186, v187
    v_cvt_pk_bf16_f32 v186, v188, v189
    v_cvt_pk_bf16_f32 v187, v190, v191
    buffer_store_dwordx4 v[184:187], v246, s[36:39], s3 offen offset:2304 sc1
    s_waitcnt vmcnt(0)
    s_barrier
    s_cmp_lg_u32 s4, 0
    s_cbranch_scc1 G1_pub
    v_cmp_eq_u32 vcc, 0, v255
    v_mov_b32 v253, 0x80000000
    v_mov_b32 v252, s95
    v_cndmask_b32 v253, v253, 0, vcc
    buffer_store_dword v252, v253, s[36:39], s14 offen sc1
G1_pub:
    s_branch AT_init
G1_ffn:
    s_mul_i32 s70, s4, 4096
    s_add_u32 m0, s68, s72
    s_add_u32 s80, s64, s66
    s_nop 0
    buffer_load_dwordx4 v231, s[40:43], s80 offen lds
    s_add_u32 s70, s70, 98304
    s_mov_b32 s67, 4294737920
    s_mul_i32 s77, s9, 448
    s_mul_i32 s3, s4, 256
    s_mov_b32 s81, 2341
    s_mov_b32 s82, 7168
    v_add_u32_e64 v239, s3, v255
    v_mul_lo_u32 v240, v239, s81
    buffer_load_dwordx4 v232, s[40:43], s80 offen offset:1024 lds
    v_lshrrev_b32 v240, 16, v240
    v_mul_u32_u24 v241, 28, v240
    v_sub_u32_e64 v239, v239, v241
    v_bfe_u32 v241, v240, 3, 1
    v_lshlrev_b32 v241, 1, v241
    v_xor_b32 v239, v239, v241
    v_lshlrev_b32_e64 v239, 4, v239
    v_mul_lo_u32 v241, v240, s82
    buffer_load_dwordx4 v233, s[40:43], s80 offen offset:2048 lds
    v_add3_u32 v235, v241, v239, s77
    v_add_u32 v239, s3, v255
    v_add_u32 v239, 64, v239
    v_mul_lo_u32 v240, v239, s81
    v_lshrrev_b32 v240, 16, v240
    v_mul_u32_u24 v241, 28, v240
    v_sub_u32_e64 v239, v239, v241
    v_bfe_u32 v241, v240, 3, 1
    buffer_load_dwordx4 v234, s[40:43], s80 offen offset:3072 lds
    v_lshlrev_b32 v241, 1, v241
    v_xor_b32 v239, v239, v241
    v_lshlrev_b32_e64 v239, 4, v239
    v_mul_lo_u32 v241, v240, s82
    v_add3_u32 v236, v241, v239, s77
    v_subrev_u32 v236, 1024, v236
    v_add_u32_e64 v239, s3, v255
    v_add_u32 v239, 128, v239
    s_add_u32 m0, s69, s72
    s_add_u32 s80, s65, s66
    buffer_load_dwordx4 v231, s[40:43], s80 offen lds
    v_mul_lo_u32 v240, v239, s81
    v_lshrrev_b32 v240, 16, v240
    v_mul_u32_u24 v241, 28, v240
    v_sub_u32_e64 v239, v239, v241
    v_bfe_u32 v241, v240, 3, 1
    v_lshlrev_b32 v241, 1, v241
    v_xor_b32 v239, v239, v241
    v_lshlrev_b32_e64 v239, 4, v239
    buffer_load_dwordx4 v232, s[40:43], s80 offen offset:1024 lds
    v_mul_lo_u32 v241, v240, s82
    v_add3_u32 v237, v241, v239, s77
    v_subrev_u32 v237, 2048, v237
    v_cmp_lt_u32 vcc, 31, v240
    v_mov_b32 v241, 0x80000000
    s_nop 0
    v_cndmask_b32 v237, v237, v241, vcc
    v_add_u32 v239, s3, v255
    buffer_load_dwordx4 v233, s[40:43], s80 offen offset:2048 lds
    s_add_u32 s72, s72, 0x8000
    s_cmp_eq_u32 s72, 0x18000
    s_cselect_b32 s72, 0, s72
    v_add_u32 v239, 192, v239
    v_mul_lo_u32 v240, v239, s81
    v_lshrrev_b32 v240, 16, v240
    v_mul_u32_u24 v241, 28, v240
    v_sub_u32 v239, v239, v241
    v_bfe_u32 v241, v240, 3, 1
    v_lshlrev_b32 v241, 1, v241
    v_xor_b32 v239, v239, v241
    buffer_load_dwordx4 v234, s[40:43], s80 offen offset:3072 lds
    s_add_u32 s66, s66, 128
    s_cmp_eq_u32 s66, 2048
    s_cselect_b32 s66, 256, s66
    v_lshlrev_b32_e64 v239, 4, v239
    v_mul_lo_u32 v241, v240, s82
    v_add3_u32 v238, v241, v239, s77
    v_subrev_u32 v238, 3072, v238
    v_cmp_lt_u32 vcc, 31, v240
    v_mov_b32 v241, 0x80000000
    s_nop 0
    v_cndmask_b32 v238, v238, v241, vcc
    s_mov_b32 s44, s24
    s_mov_b32 s45, s25
    s_mov_b32 s46, 0x700000
    s_mov_b32 s47, 0x00020000
    s_add_u32 m0, s70, 0
    s_add_u32 s67, s67, 229376
    s_cmp_eq_u32 s67, 7340032
    s_cselect_b32 s67, 917504, s67
    buffer_load_dwordx4 v235, s[44:47], s67 offen lds
    buffer_load_dwordx4 v236, s[44:47], s67 offen offset:1024 lds
    buffer_load_dwordx4 v237, s[44:47], s67 offen offset:2048 lds
    buffer_load_dwordx4 v238, s[44:47], s67 offen offset:3072 lds
    s_mov_b32 s36, s32
    s_mov_b32 s37, s33
    s_mov_b32 s38, 0x2c00000
    s_mov_b32 s39, 0x00020000
    s_lshl_b32 s13, s2, 2
    s_add_u32 s13, s13, s4
    s_lshl_b32 s13, s13, 9
    s_add_u32 s13, s13, 0x2a00000
    s_mov_b32 s52, s30
    s_mov_b32 s53, s31
    s_mov_b32 s54, 0x100
    s_mov_b32 s55, 0x00020000
    s_lshr_b32 s60, s5, 2
    s_add_u32 m0, s70, 16384
    s_add_u32 s67, s67, 229376
    buffer_load_dwordx4 v235, s[44:47], s67 offen lds
    s_lshl_b32 s3, s60, 4
    s_xor_b32 s6, s6, s3
    s_bfe_u32 s61, s5, 0x10001
    s_lshl_b32 s61, s61, 3
    s_and_b32 s3, s6, 7
    s_add_u32 s61, s61, s3
    s_and_b32 s62, s5, 1
    buffer_load_dwordx4 v236, s[44:47], s67 offen offset:1024 lds
    s_lshl_b32 s62, s62, 2
    s_lshr_b32 s3, s6, 3
    s_add_u32 s62, s62, s3
    s_mov_b32 s12, 0x40000
    s_lshl_b32 s63, s61, 3
    s_add_u32 s63, s63, s62
    s_lshl_b32 s34, s63, 2
    buffer_load_dwordx4 v237, s[44:47], s67 offen offset:2048 lds
    s_add_u32 s34, s34, s4
    s_lshl_b32 s34, s34, 7
    s_add_u32 s34, s34, 0x2910000
    s_lshl_b32 s15, s7, 12
    s_lshl_b32 s3, s35, 7
    s_add_u32 s15, s15, s3
    s_add_u32 s15, s15, 0x2908000
    s_lshr_b32 s22, s35, 1
    buffer_load_dwordx4 v238, s[44:47], s67 offen offset:3072 lds
    s_lshl_b32 s22, s22, 10
    s_add_u32 s22, s22, 0x2900000
    s_lshr_b32 s23, s61, 1
    s_lshl_b32 s83, s23, 12
    s_add_u32 s83, s83, 0x2908000
    s_lshl_b32 s23, s23, 11
    s_add_u32 s23, s23, 0x2904000
    s_add_u32 m0, s68, s72
    s_add_u32 s80, s64, s66
    buffer_load_dwordx4 v231, s[40:43], s80 offen lds
    s_mov_b32 s84, 1
    s_mov_b32 s95, 0
    s_mov_b32 s56, s26
    s_mov_b32 s57, s27
    s_mov_b32 s58, 0x700000
    s_mov_b32 s59, 0x00020000
    v_lshrrev_b32 v239, 1, v251
    v_xor_b32 v239, v239, v250
    buffer_load_dwordx4 v232, s[40:43], s80 offen offset:1024 lds
    v_lshlrev_b32_e64 v239, 4, v239
    v_lshl_add_u32 v239, v251, 7, v239
    s_lshl_b32 s3, s10, 14
    v_add_u32 v224, s3, v239
    v_xor_b32 v225, 64, v224
    v_mov_b32 v226, v224
    v_mov_b32_e64 v227, v225
    buffer_load_dwordx4 v233, s[40:43], s80 offen offset:2048 lds
    v_lshrrev_b32_e64 v239, 2, v251
    v_lshl_add_u32 v240, v250, 3, v239
    v_mul_u32_u24 v240, 448, v240
    v_and_b32_e64 v241, 3, v255
    v_lshl_add_u32 v240, v241, 3, v240
    v_add_u32 v240, 98304, v240
    v_and_b32 v241, 1, v250
    v_lshlrev_b32 v242, 5, v241
    buffer_load_dwordx4 v234, s[40:43], s80 offen offset:3072 lds
    s_lshl_b32 s3, s11, 8
    v_add3_u32 v228, v240, v242, s3
    v_sub_u32 v229, v240, v242
    v_add_u32 v229, s3, v229
    s_add_u32 s3, s11, 6
    v_xor_b32_e64 v242, s3, v241
    v_lshl_add_u32 v230, v242, 5, v240
    s_add_u32 m0, s70, 32768
    s_add_u32 s67, s67, 229376
    buffer_load_dwordx4 v235, s[44:47], s67 offen lds
    s_lshl_b32 s14, s7, 11
    s_lshl_b32 s3, s9, 7
    s_add_u32 s14, s14, s3
    s_add_u32 s14, s14, 0x2904000
    s_lshl_b32 s3, s11, 3
    v_add_u32 v239, s3, v251
    s_add_u32 s3, s11, 6
    buffer_load_dwordx4 v236, s[44:47], s67 offen offset:1024 lds
    v_mov_b32 v240, s3
    v_cmp_eq_u32 vcc, 6, v251
    s_nop 1
    v_cndmask_b32 v239, v239, v240, vcc
    v_lshlrev_b32_e64 v243, 4, v250
    v_lshl_add_u32 v243, v239, 6, v243
    v_lshl_or_b32 v239, s10, 4, v251
    v_cmp_gt_u32 vcc, 7, v239
    buffer_load_dwordx4 v237, s[44:47], s67 offen offset:2048 lds
    v_mov_b32 v240, 0x80000000
    v_mov_b32 v241, 0x3f803f80
    v_cndmask_b32 v243, v240, v243, vcc
    v_cmp_eq_u32 vcc, 0, v251
    s_nop 1
    v_cndmask_b32 v242, 0, v241, vcc
    v_accvgpr_write_b32 a128, v242
    buffer_load_dwordx4 v238, s[44:47], s67 offen offset:3072 lds
    v_accvgpr_write_b32 a129, v242
    v_cmp_eq_u32 vcc, 1, v251
    v_accvgpr_write_b32 a130, v242
    v_accvgpr_write_b32 a131, v242
    v_cndmask_b32 v239, 0, v241, vcc
    v_accvgpr_write_b32 a132, v239
    v_accvgpr_write_b32 a133, v239
    v_cmp_eq_u32 vcc, 2, v251
    s_add_u32 m0, s69, s72
    s_add_u32 s80, s65, s66
    buffer_load_dwordx4 v231, s[40:43], s80 offen lds
    v_accvgpr_write_b32 a134, v239
    v_accvgpr_write_b32 a135, v239
    v_cndmask_b32 v242, 0, v241, vcc
    v_accvgpr_write_b32 a136, v242
    v_accvgpr_write_b32 a137, v242
    v_cmp_eq_u32 vcc, 3, v251
    v_accvgpr_write_b32 a138, v242
    buffer_load_dwordx4 v232, s[40:43], s80 offen offset:1024 lds
    v_accvgpr_write_b32 a139, v242
    v_cndmask_b32 v239, 0, v241, vcc
    v_accvgpr_write_b32 a140, v239
    v_accvgpr_write_b32 a141, v239
    v_cmp_eq_u32 vcc, 4, v251
    v_accvgpr_write_b32 a142, v239
    v_accvgpr_write_b32 a143, v239
    v_cndmask_b32 v242, 0, v241, vcc
    buffer_load_dwordx4 v233, s[40:43], s80 offen offset:2048 lds
    s_add_u32 s72, s72, 0x8000
    s_cmp_eq_u32 s72, 0x18000
    s_cselect_b32 s72, 0, s72
    v_accvgpr_write_b32 a144, v242
    v_accvgpr_write_b32 a145, v242
    v_cmp_eq_u32 vcc, 5, v251
    v_accvgpr_write_b32 a146, v242
    v_accvgpr_write_b32 a147, v242
    v_cndmask_b32 v239, 0, v241, vcc
    v_accvgpr_write_b32 a148, v239
    buffer_load_dwordx4 v234, s[40:43], s80 offen offset:3072 lds
    s_add_u32 s66, s66, 128
    s_cmp_eq_u32 s66, 2048
    s_cselect_b32 s66, 256, s66
    v_accvgpr_write_b32 a149, v239
    v_cmp_eq_u32 vcc, 6, v251
    v_accvgpr_write_b32 a150, v239
    v_accvgpr_write_b32 a151, v239
    v_cndmask_b32 v242, 0, v241, vcc
    v_accvgpr_write_b32 a152, v242
    v_accvgpr_write_b32 a153, v242
    v_accvgpr_write_b32 a154, v242
    v_accvgpr_write_b32 a155, v242
    v_cmp_eq_u32 vcc, 0, v2
    v_lshlrev_b32 v4, 3, v1
    s_lshl_b32 s82, s76, 3
    v_cndmask_b32 v248, v240, v4, vcc
    s_add_u32 s82, s82, 0x2800000
    buffer_load_dwordx4 a[160:163], v3, s[40:43], s79 offen offset:0
    buffer_load_dwordx4 a[164:167], v3, s[40:43], s79 offen offset:512
    buffer_load_dwordx4 a[168:171], v3, s[40:43], s79 offen offset:1024
    buffer_load_dwordx4 a[172:175], v3, s[40:43], s79 offen offset:1536
    s_lshl_b32 s66, s78, 8
    s_waitcnt vmcnt(20)
    s_barrier
    s_nop 0
    ds_read_b64_tr_b16 a[32:33], v228 offset:0
    ds_read_b64_tr_b16 a[34:35], v228 offset:1792
    ds_read_b128 a[0:3], v226 offset:0
    ds_read_b64_tr_b16 a[36:37], v229 offset:32
    ds_read_b64_tr_b16 a[38:39], v229 offset:1824
    ds_read_b128 a[4:7], v226 offset:2048
    ds_read_b64_tr_b16 a[40:41], v228 offset:64
    ds_read_b64_tr_b16 a[42:43], v228 offset:1856
    ds_read_b128 a[8:11], v226 offset:4096
    ds_read_b64_tr_b16 a[44:45], v229 offset:96
    ds_read_b64_tr_b16 a[46:47], v229 offset:1888
    ds_read_b128 a[12:15], v226 offset:6144
    ds_read_b64_tr_b16 a[48:49], v228 offset:128
    ds_read_b64_tr_b16 a[50:51], v228 offset:1920
    ds_read_b128 a[16:19], v226 offset:8192
    ds_read_b64_tr_b16 a[52:53], v229 offset:160
    ds_read_b64_tr_b16 a[54:55], v229 offset:1952
    ds_read_b128 a[20:23], v226 offset:10240
    ds_read_b64_tr_b16 a[56:57], v230 offset:0
    ds_read_b64_tr_b16 a[58:59], v230 offset:1792
    ds_read_b128 a[24:27], v226 offset:12288
    ds_read_b128 a[28:31], v226 offset:14336
    s_waitcnt vmcnt(16) lgkmcnt(0)
    s_barrier
    v_mfma_f32_16x16x32_bf16 v[0:3], a[32:35], a[0:3], 0
    ds_read_b64_tr_b16 a[96:97], v228 offset:16384
    v_mfma_f32_16x16x32_bf16 v[28:31], a[32:35], a[4:7], 0
    ds_read_b64_tr_b16 a[98:99], v228 offset:18176
    v_mfma_f32_16x16x32_bf16 v[56:59], a[32:35], a[8:11], 0
    s_add_u32 m0, s70, 49152
    v_mfma_f32_16x16x32_bf16 v[84:87], a[32:35], a[12:15], 0
    s_add_u32 s67, s67, 229376
    v_mfma_f32_16x16x32_bf16 v[112:115], a[32:35], a[16:19], 0
    buffer_load_dwordx4 v235, s[44:47], s67 offen lds
    v_mfma_f32_16x16x32_bf16 v[140:143], a[32:35], a[20:23], 0
    ds_read_b128 a[64:67], v227 offset:0
    v_mfma_f32_16x16x32_bf16 v[168:171], a[32:35], a[24:27], 0
    ds_read_b64_tr_b16 a[100:101], v229 offset:16416
    v_mfma_f32_16x16x32_bf16 v[196:199], a[32:35], a[28:31], 0
    buffer_load_dwordx4 v236, s[44:47], s67 offen offset:1024 lds
    v_mfma_f32_16x16x32_bf16 a[60:63], a[32:35], a[128:131], 0
    ds_read_b64_tr_b16 a[102:103], v229 offset:18208
    v_mfma_f32_16x16x32_bf16 v[200:203], a[36:39], a[28:31], 0
    ds_read_b128 a[68:71], v227 offset:2048
    v_mfma_f32_16x16x32_bf16 v[172:175], a[36:39], a[24:27], 0
    buffer_load_dwordx4 v237, s[44:47], s67 offen offset:2048 lds
    v_mfma_f32_16x16x32_bf16 v[144:147], a[36:39], a[20:23], 0
    ds_read_b64_tr_b16 a[104:105], v228 offset:16448
    v_mfma_f32_16x16x32_bf16 v[116:119], a[36:39], a[16:19], 0
    ds_read_b64_tr_b16 a[106:107], v228 offset:18240
    v_mfma_f32_16x16x32_bf16 v[88:91], a[36:39], a[12:15], 0
    buffer_load_dwordx4 v238, s[44:47], s67 offen offset:3072 lds
    v_mfma_f32_16x16x32_bf16 v[60:63], a[36:39], a[8:11], 0
    ds_read_b128 a[72:75], v227 offset:4096
    v_mfma_f32_16x16x32_bf16 v[32:35], a[36:39], a[4:7], 0
    ds_read_b64_tr_b16 a[108:109], v229 offset:16480
    v_mfma_f32_16x16x32_bf16 v[4:7], a[36:39], a[0:3], 0
    s_mul_i32 s67, s78, 917504
    v_mfma_f32_16x16x32_bf16 a[60:63], a[36:39], a[132:135], a[60:63]
    s_sub_u32 s67, s67, 229376
    v_mfma_f32_16x16x32_bf16 v[8:11], a[40:43], a[0:3], 0
    ds_read_b64_tr_b16 a[110:111], v229 offset:18272
    v_mfma_f32_16x16x32_bf16 v[36:39], a[40:43], a[4:7], 0
    ds_read_b128 a[76:79], v227 offset:6144
    v_mfma_f32_16x16x32_bf16 v[64:67], a[40:43], a[8:11], 0
    s_add_u32 m0, s68, s72
    v_mfma_f32_16x16x32_bf16 v[92:95], a[40:43], a[12:15], 0
    s_add_u32 s80, s64, s66
    v_mfma_f32_16x16x32_bf16 v[120:123], a[40:43], a[16:19], 0
    buffer_load_dwordx4 v231, s[40:43], s80 offen lds
    v_mfma_f32_16x16x32_bf16 v[148:151], a[40:43], a[20:23], 0
    ds_read_b64_tr_b16 a[112:113], v228 offset:16512
    v_mfma_f32_16x16x32_bf16 v[176:179], a[40:43], a[24:27], 0
    ds_read_b64_tr_b16 a[114:115], v228 offset:18304
    v_mfma_f32_16x16x32_bf16 v[204:207], a[40:43], a[28:31], 0
    buffer_load_dwordx4 v232, s[40:43], s80 offen offset:1024 lds
    v_mfma_f32_16x16x32_bf16 a[60:63], a[40:43], a[136:139], a[60:63]
    ds_read_b128 a[80:83], v227 offset:8192
    v_mfma_f32_16x16x32_bf16 v[208:211], a[44:47], a[28:31], 0
    ds_read_b64_tr_b16 a[116:117], v229 offset:16544
    v_mfma_f32_16x16x32_bf16 v[180:183], a[44:47], a[24:27], 0
    buffer_load_dwordx4 v233, s[40:43], s80 offen offset:2048 lds
    v_mfma_f32_16x16x32_bf16 v[152:155], a[44:47], a[20:23], 0
    ds_read_b64_tr_b16 a[118:119], v229 offset:18336
    v_mfma_f32_16x16x32_bf16 v[124:127], a[44:47], a[16:19], 0
    ds_read_b128 a[84:87], v227 offset:10240
    v_mfma_f32_16x16x32_bf16 v[96:99], a[44:47], a[12:15], 0
    v_mfma_f32_16x16x32_bf16 v[68:71], a[44:47], a[8:11], 0
    buffer_load_dwordx4 v234, s[40:43], s80 offen offset:3072 lds
    v_mfma_f32_16x16x32_bf16 v[40:43], a[44:47], a[4:7], 0
    ds_read_b64_tr_b16 a[120:121], v230 offset:16384
    v_mfma_f32_16x16x32_bf16 v[12:15], a[44:47], a[0:3], 0
    ds_read_b64_tr_b16 a[122:123], v230 offset:18176
    v_mfma_f32_16x16x32_bf16 a[60:63], a[44:47], a[140:143], a[60:63]
    s_add_u32 m0, s70, 0
    v_mfma_f32_16x16x32_bf16 v[16:19], a[48:51], a[0:3], 0
    s_add_u32 s67, s67, 229376
    v_mfma_f32_16x16x32_bf16 v[44:47], a[48:51], a[4:7], 0
    s_cmp_eq_u32 s67, 7340032
    v_mfma_f32_16x16x32_bf16 v[72:75], a[48:51], a[8:11], 0
    s_cselect_b32 s67, 917504, s67
    v_mfma_f32_16x16x32_bf16 v[100:103], a[48:51], a[12:15], 0
    buffer_load_dwordx4 v235, s[44:47], s67 offen lds
    v_mfma_f32_16x16x32_bf16 v[128:131], a[48:51], a[16:19], 0
    ds_read_b128 a[88:91], v227 offset:12288
    v_mfma_f32_16x16x32_bf16 v[156:159], a[48:51], a[20:23], 0
    ds_read_b128 a[92:95], v227 offset:14336
    v_mfma_f32_16x16x32_bf16 v[184:187], a[48:51], a[24:27], 0
    buffer_load_dwordx4 v236, s[44:47], s67 offen offset:1024 lds
    v_mfma_f32_16x16x32_bf16 v[212:215], a[48:51], a[28:31], 0
    buffer_load_dwordx4 v237, s[44:47], s67 offen offset:2048 lds
    v_mfma_f32_16x16x32_bf16 a[60:63], a[48:51], a[144:147], a[60:63]
    buffer_load_dwordx4 v238, s[44:47], s67 offen offset:3072 lds
    v_mfma_f32_16x16x32_bf16 v[216:219], a[52:55], a[28:31], 0
    s_add_u32 m0, s69, s72
    v_mfma_f32_16x16x32_bf16 v[188:191], a[52:55], a[24:27], 0
    s_add_u32 s80, s65, s66
    v_mfma_f32_16x16x32_bf16 v[160:163], a[52:55], a[20:23], 0
    buffer_load_dwordx4 v231, s[40:43], s80 offen lds
    v_mfma_f32_16x16x32_bf16 v[132:135], a[52:55], a[16:19], 0
    buffer_load_dwordx4 v232, s[40:43], s80 offen offset:1024 lds
    v_mfma_f32_16x16x32_bf16 v[104:107], a[52:55], a[12:15], 0
    buffer_load_dwordx4 v233, s[40:43], s80 offen offset:2048 lds
    v_mfma_f32_16x16x32_bf16 v[76:79], a[52:55], a[8:11], 0
    s_add_u32 s72, s72, 0x8000
    v_mfma_f32_16x16x32_bf16 v[48:51], a[52:55], a[4:7], 0
    s_cmp_eq_u32 s72, 0x18000
    v_mfma_f32_16x16x32_bf16 v[20:23], a[52:55], a[0:3], 0
    s_cselect_b32 s72, 0, s72
    v_mfma_f32_16x16x32_bf16 a[60:63], a[52:55], a[148:151], a[60:63]
    buffer_load_dwordx4 v234, s[40:43], s80 offen offset:3072 lds
    v_mfma_f32_16x16x32_bf16 v[24:27], a[56:59], a[0:3], 0
    s_add_u32 s66, s66, 128
    v_mfma_f32_16x16x32_bf16 v[52:55], a[56:59], a[4:7], 0
    s_cmp_eq_u32 s66, 2048
    v_mfma_f32_16x16x32_bf16 v[80:83], a[56:59], a[8:11], 0
    s_cselect_b32 s66, 256, s66
    v_mfma_f32_16x16x32_bf16 v[108:111], a[56:59], a[12:15], 0
    s_add_u32 s73, s73, 0x8000
    v_mfma_f32_16x16x32_bf16 v[136:139], a[56:59], a[16:19], 0
    s_cmp_eq_u32 s73, 0x18000
    v_mfma_f32_16x16x32_bf16 v[164:167], a[56:59], a[20:23], 0
    s_cselect_b32 s73, 0, s73
    v_mfma_f32_16x16x32_bf16 v[192:195], a[56:59], a[24:27], 0
    v_add_u32 v226, s73, v224
    v_mfma_f32_16x16x32_bf16 v[220:223], a[56:59], a[28:31], 0
    v_add_u32_e64 v227, s73, v225
    v_mfma_f32_16x16x32_bf16 a[60:63], a[56:59], a[152:155], a[60:63]
    s_waitcnt vmcnt(20) lgkmcnt(0)
    s_barrier
    v_mfma_f32_16x16x32_bf16 v[0:3], a[96:99], a[64:67], v[0:3]
    ds_read_b64_tr_b16 a[32:33], v228 offset:32768
    v_mfma_f32_16x16x32_bf16 v[28:31], a[96:99], a[68:71], v[28:31]
    ds_read_b64_tr_b16 a[34:35], v228 offset:34560
    v_mfma_f32_16x16x32_bf16 v[56:59], a[96:99], a[72:75], v[56:59]
    ds_read_b128 a[0:3], v226 offset:0
    v_mfma_f32_16x16x32_bf16 v[84:87], a[96:99], a[76:79], v[84:87]
    ds_read_b64_tr_b16 a[36:37], v229 offset:32800
    v_mfma_f32_16x16x32_bf16 v[112:115], a[96:99], a[80:83], v[112:115]
    s_add_u32 m0, s70, 16384
    v_mfma_f32_16x16x32_bf16 v[140:143], a[96:99], a[84:87], v[140:143]
    v_mfma_f32_16x16x32_bf16 v[168:171], a[96:99], a[88:91], v[168:171]
    s_add_u32 s67, s67, 229376
    v_mfma_f32_16x16x32_bf16 v[196:199], a[96:99], a[92:95], v[196:199]
    buffer_load_dwordx4 v235, s[44:47], s67 offen lds
    v_mfma_f32_16x16x32_bf16 a[60:63], a[96:99], a[128:131], a[60:63]
    ds_read_b64_tr_b16 a[38:39], v229 offset:34592
    v_mfma_f32_16x16x32_bf16 v[200:203], a[100:103], a[92:95], v[200:203]
    ds_read_b128 a[4:7], v226 offset:2048
    v_mfma_f32_16x16x32_bf16 v[172:175], a[100:103], a[88:91], v[172:175]
    ds_read_b64_tr_b16 a[40:41], v228 offset:32832
    v_mfma_f32_16x16x32_bf16 v[144:147], a[100:103], a[84:87], v[144:147]
    v_mfma_f32_16x16x32_bf16 v[116:119], a[100:103], a[80:83], v[116:119]
    ds_read_b64_tr_b16 a[42:43], v228 offset:34624
    v_mfma_f32_16x16x32_bf16 v[88:91], a[100:103], a[76:79], v[88:91]
    buffer_load_dwordx4 v236, s[44:47], s67 offen offset:1024 lds
    v_mfma_f32_16x16x32_bf16 v[60:63], a[100:103], a[72:75], v[60:63]
    ds_read_b128 a[8:11], v226 offset:4096
    v_mfma_f32_16x16x32_bf16 v[32:35], a[100:103], a[68:71], v[32:35]
    ds_read_b64_tr_b16 a[44:45], v229 offset:32864
    v_mfma_f32_16x16x32_bf16 v[4:7], a[100:103], a[64:67], v[4:7]
    ds_read_b64_tr_b16 a[46:47], v229 offset:34656
    v_mfma_f32_16x16x32_bf16 a[60:63], a[100:103], a[132:135], a[60:63]
    v_mfma_f32_16x16x32_bf16 v[8:11], a[104:107], a[64:67], v[8:11]
    ds_read_b128 a[12:15], v226 offset:6144
    v_mfma_f32_16x16x32_bf16 v[36:39], a[104:107], a[68:71], v[36:39]
    buffer_load_dwordx4 v237, s[44:47], s67 offen offset:2048 lds
    v_mfma_f32_16x16x32_bf16 v[64:67], a[104:107], a[72:75], v[64:67]
    ds_read_b64_tr_b16 a[48:49], v228 offset:32896
    v_mfma_f32_16x16x32_bf16 v[92:95], a[104:107], a[76:79], v[92:95]
    ds_read_b64_tr_b16 a[50:51], v228 offset:34688
    v_mfma_f32_16x16x32_bf16 v[120:123], a[104:107], a[80:83], v[120:123]
    v_mfma_f32_16x16x32_bf16 v[148:151], a[104:107], a[84:87], v[148:151]
    ds_read_b128 a[16:19], v226 offset:8192
    v_mfma_f32_16x16x32_bf16 v[176:179], a[104:107], a[88:91], v[176:179]
    ds_read_b64_tr_b16 a[52:53], v229 offset:32928
    v_mfma_f32_16x16x32_bf16 v[204:207], a[104:107], a[92:95], v[204:207]
    buffer_load_dwordx4 v238, s[44:47], s67 offen offset:3072 lds
    v_mfma_f32_16x16x32_bf16 a[60:63], a[104:107], a[136:139], a[60:63]
    ds_read_b64_tr_b16 a[54:55], v229 offset:34720
    v_mfma_f32_16x16x32_bf16 v[208:211], a[108:111], a[92:95], v[208:211]
    ds_read_b128 a[20:23], v226 offset:10240
    v_mfma_f32_16x16x32_bf16 v[180:183], a[108:111], a[88:91], v[180:183]
    v_mfma_f32_16x16x32_bf16 v[152:155], a[108:111], a[84:87], v[152:155]
    ds_read_b64_tr_b16 a[56:57], v230 offset:32768
    v_mfma_f32_16x16x32_bf16 v[124:127], a[108:111], a[80:83], v[124:127]
    ds_read_b64_tr_b16 a[58:59], v230 offset:34560
    v_mfma_f32_16x16x32_bf16 v[96:99], a[108:111], a[76:79], v[96:99]
    s_add_u32 m0, s68, s72
    v_mfma_f32_16x16x32_bf16 v[68:71], a[108:111], a[72:75], v[68:71]
    s_add_u32 s80, s64, s66
    v_mfma_f32_16x16x32_bf16 v[40:43], a[108:111], a[68:71], v[40:43]
    buffer_load_dwordx4 v231, s[40:43], s80 offen lds
    v_mfma_f32_16x16x32_bf16 v[12:15], a[108:111], a[64:67], v[12:15]
    v_mfma_f32_16x16x32_bf16 a[60:63], a[108:111], a[140:143], a[60:63]
    ds_read_b128 a[24:27], v226 offset:12288
    v_mfma_f32_16x16x32_bf16 v[16:19], a[112:115], a[64:67], v[16:19]
    ds_read_b128 a[28:31], v226 offset:14336
    v_mfma_f32_16x16x32_bf16 v[44:47], a[112:115], a[68:71], v[44:47]
    buffer_load_dwordx4 v232, s[40:43], s80 offen offset:1024 lds
    v_mfma_f32_16x16x32_bf16 v[72:75], a[112:115], a[72:75], v[72:75]
    buffer_load_dwordx4 v233, s[40:43], s80 offen offset:2048 lds
    v_mfma_f32_16x16x32_bf16 v[100:103], a[112:115], a[76:79], v[100:103]
    buffer_load_dwordx4 v234, s[40:43], s80 offen offset:3072 lds
    v_mfma_f32_16x16x32_bf16 v[128:131], a[112:115], a[80:83], v[128:131]
    v_mfma_f32_16x16x32_bf16 v[156:159], a[112:115], a[84:87], v[156:159]
    s_lshl_b32 s76, s9, 3
    v_mfma_f32_16x16x32_bf16 v[184:187], a[112:115], a[88:91], v[184:187]
    s_add_u32 s81, s7, s76
    v_mfma_f32_16x16x32_bf16 v[212:215], a[112:115], a[92:95], v[212:215]
    s_lshl_b32 s81, s81, 10
    v_mfma_f32_16x16x32_bf16 a[60:63], a[112:115], a[144:147], a[60:63]
    s_add_u32 s81, s81, 0x2830000
    v_mfma_f32_16x16x32_bf16 v[216:219], a[116:119], a[92:95], v[216:219]
    v_mfma_f32_16x16x32_bf16 v[188:191], a[116:119], a[88:91], v[188:191]
    s_cmp_eq_u32 s7, 7
    v_mfma_f32_16x16x32_bf16 v[160:163], a[116:119], a[84:87], v[160:163]
    s_cselect_b32 s76, s81, 0x40000000
    v_mfma_f32_16x16x32_bf16 v[132:135], a[116:119], a[80:83], v[132:135]
    s_cselect_b32 s81, 0x40000000, s81
    v_mfma_f32_16x16x32_bf16 v[104:107], a[116:119], a[76:79], v[104:107]
    s_lshl_b32 s3, s7, 5
    v_mfma_f32_16x16x32_bf16 v[76:79], a[116:119], a[72:75], v[76:79]
    v_add_u32 v249, s3, v255
    v_mfma_f32_16x16x32_bf16 v[48:51], a[116:119], a[68:71], v[48:51]
    v_mfma_f32_16x16x32_bf16 v[20:23], a[116:119], a[64:67], v[20:23]
    v_and_b32_e64 v245, 7, v255
    v_mfma_f32_16x16x32_bf16 a[60:63], a[116:119], a[148:151], a[60:63]
    v_cmp_gt_u32 vcc, 32, v255
    v_mfma_f32_16x16x32_bf16 v[24:27], a[120:123], a[64:67], v[24:27]
    v_lshl_add_u32 v245, v245, 5, s35
    v_mfma_f32_16x16x32_bf16 v[52:55], a[120:123], a[68:71], v[52:55]
    s_mov_b32 s75, 0x2920000
    v_mfma_f32_16x16x32_bf16 v[80:83], a[120:123], a[72:75], v[80:83]
    v_cndmask_b32 v249, v245, v249, vcc
    v_mfma_f32_16x16x32_bf16 v[108:111], a[120:123], a[76:79], v[108:111]
    v_mfma_f32_16x16x32_bf16 v[136:139], a[120:123], a[80:83], v[136:139]
    v_lshlrev_b32_e64 v249, 7, v249
    v_mfma_f32_16x16x32_bf16 v[164:167], a[120:123], a[84:87], v[164:167]
    v_lshlrev_b32_e64 v245, 7, v255
    v_mfma_f32_16x16x32_bf16 v[192:195], a[120:123], a[88:91], v[192:195]
    s_lshl_b32 s74, s4, 13
    v_mfma_f32_16x16x32_bf16 v[220:223], a[120:123], a[92:95], v[220:223]
    s_add_u32 s74, s74, G1_ffn_post-parallel_sum__softmax_full_mha__dense_activation_relu__prompt_kernel
    v_mfma_f32_16x16x32_bf16 a[60:63], a[120:123], a[152:155], a[60:63]
    s_waitcnt vmcnt(16) lgkmcnt(0)
    s_barrier
    v_mfma_f32_16x16x32_bf16 v[0:3], a[32:35], a[0:3], v[0:3]
    ds_read_b64_tr_b16 a[96:97], v228 offset:49152
    v_mfma_f32_16x16x32_bf16 v[28:31], a[32:35], a[4:7], v[28:31]
    ds_read_b64_tr_b16 a[98:99], v228 offset:50944
    v_mfma_f32_16x16x32_bf16 v[56:59], a[32:35], a[8:11], v[56:59]
    ds_read_b128 a[64:67], v227 offset:0
    v_mfma_f32_16x16x32_bf16 v[84:87], a[32:35], a[12:15], v[84:87]
    ds_read_b64_tr_b16 a[100:101], v229 offset:49184
    v_mfma_f32_16x16x32_bf16 v[112:115], a[32:35], a[16:19], v[112:115]
    s_add_u32 m0, s70, 32768
    v_mfma_f32_16x16x32_bf16 v[140:143], a[32:35], a[20:23], v[140:143]
    s_add_u32 s67, s67, 229376
    v_mfma_f32_16x16x32_bf16 v[168:171], a[32:35], a[24:27], v[168:171]
    buffer_load_dwordx4 v235, s[44:47], s67 offen lds
    v_mfma_f32_16x16x32_bf16 v[196:199], a[32:35], a[28:31], v[196:199]
    ds_read_b64_tr_b16 a[102:103], v229 offset:50976
    v_mfma_f32_16x16x32_bf16 a[60:63], a[32:35], a[128:131], a[60:63]
    ds_read_b128 a[68:71], v227 offset:2048
    v_mfma_f32_16x16x32_bf16 v[200:203], a[36:39], a[28:31], v[200:203]
    ds_read_b64_tr_b16 a[104:105], v228 offset:49216
    v_mfma_f32_16x16x32_bf16 v[172:175], a[36:39], a[24:27], v[172:175]
    ds_read_b64_tr_b16 a[106:107], v228 offset:51008
    v_mfma_f32_16x16x32_bf16 v[144:147], a[36:39], a[20:23], v[144:147]
    buffer_load_dwordx4 v236, s[44:47], s67 offen offset:1024 lds
    v_mfma_f32_16x16x32_bf16 v[116:119], a[36:39], a[16:19], v[116:119]
    ds_read_b128 a[72:75], v227 offset:4096
    v_mfma_f32_16x16x32_bf16 v[88:91], a[36:39], a[12:15], v[88:91]
    ds_read_b64_tr_b16 a[108:109], v229 offset:49248
    v_mfma_f32_16x16x32_bf16 v[60:63], a[36:39], a[8:11], v[60:63]
    ds_read_b64_tr_b16 a[110:111], v229 offset:51040
    v_mfma_f32_16x16x32_bf16 v[32:35], a[36:39], a[4:7], v[32:35]
    v_mfma_f32_16x16x32_bf16 v[4:7], a[36:39], a[0:3], v[4:7]
    ds_read_b128 a[76:79], v227 offset:6144
    v_mfma_f32_16x16x32_bf16 a[60:63], a[36:39], a[132:135], a[60:63]
    buffer_load_dwordx4 v237, s[44:47], s67 offen offset:2048 lds
    v_mfma_f32_16x16x32_bf16 v[8:11], a[40:43], a[0:3], v[8:11]
    ds_read_b64_tr_b16 a[112:113], v228 offset:49280
    v_mfma_f32_16x16x32_bf16 v[36:39], a[40:43], a[4:7], v[36:39]
    ds_read_b64_tr_b16 a[114:115], v228 offset:51072
    v_mfma_f32_16x16x32_bf16 v[64:67], a[40:43], a[8:11], v[64:67]
    ds_read_b128 a[80:83], v227 offset:8192
    v_mfma_f32_16x16x32_bf16 v[92:95], a[40:43], a[12:15], v[92:95]
    ds_read_b64_tr_b16 a[116:117], v229 offset:49312
    v_mfma_f32_16x16x32_bf16 v[120:123], a[40:43], a[16:19], v[120:123]
    buffer_load_dwordx4 v238, s[44:47], s67 offen offset:3072 lds
    v_mfma_f32_16x16x32_bf16 v[148:151], a[40:43], a[20:23], v[148:151]
    ds_read_b64_tr_b16 a[118:119], v229 offset:51104
    v_mfma_f32_16x16x32_bf16 v[176:179], a[40:43], a[24:27], v[176:179]
    ds_read_b128 a[84:87], v227 offset:10240
    v_mfma_f32_16x16x32_bf16 v[204:207], a[40:43], a[28:31], v[204:207]
    ds_read_b64_tr_b16 a[120:121], v230 offset:49152
    v_mfma_f32_16x16x32_bf16 a[60:63], a[40:43], a[136:139], a[60:63]
    ds_read_b64_tr_b16 a[122:123], v230 offset:50944
    v_mfma_f32_16x16x32_bf16 v[208:211], a[44:47], a[28:31], v[208:211]
    s_add_u32 m0, s69, s72
    v_mfma_f32_16x16x32_bf16 v[180:183], a[44:47], a[24:27], v[180:183]
    s_add_u32 s80, s65, s66
    v_mfma_f32_16x16x32_bf16 v[152:155], a[44:47], a[20:23], v[152:155]
    buffer_load_dwordx4 v231, s[40:43], s80 offen lds
    v_mfma_f32_16x16x32_bf16 v[124:127], a[44:47], a[16:19], v[124:127]
    ds_read_b128 a[88:91], v227 offset:12288
    v_mfma_f32_16x16x32_bf16 v[96:99], a[44:47], a[12:15], v[96:99]
    v_mfma_f32_16x16x32_bf16 v[68:71], a[44:47], a[8:11], v[68:71]
    ds_read_b128 a[92:95], v227 offset:14336
    v_mfma_f32_16x16x32_bf16 v[40:43], a[44:47], a[4:7], v[40:43]
    buffer_load_dwordx4 v232, s[40:43], s80 offen offset:1024 lds
    v_mfma_f32_16x16x32_bf16 v[12:15], a[44:47], a[0:3], v[12:15]
    buffer_load_dwordx4 v233, s[40:43], s80 offen offset:2048 lds
    v_mfma_f32_16x16x32_bf16 a[60:63], a[44:47], a[140:143], a[60:63]
    s_add_u32 s72, s72, 0x8000
    v_mfma_f32_16x16x32_bf16 v[16:19], a[48:51], a[0:3], v[16:19]
    s_cmp_eq_u32 s72, 0x18000
    v_mfma_f32_16x16x32_bf16 v[44:47], a[48:51], a[4:7], v[44:47]
    s_cselect_b32 s72, 0, s72
    v_mfma_f32_16x16x32_bf16 v[72:75], a[48:51], a[8:11], v[72:75]
    buffer_load_dwordx4 v234, s[40:43], s80 offen offset:3072 lds
    v_mfma_f32_16x16x32_bf16 v[100:103], a[48:51], a[12:15], v[100:103]
    s_add_u32 s66, s66, 128
    v_mfma_f32_16x16x32_bf16 v[128:131], a[48:51], a[16:19], v[128:131]
    s_cmp_eq_u32 s66, 2048
    v_mfma_f32_16x16x32_bf16 v[156:159], a[48:51], a[20:23], v[156:159]
    s_cselect_b32 s66, 256, s66
    v_mfma_f32_16x16x32_bf16 v[184:187], a[48:51], a[24:27], v[184:187]
    s_add_u32 s73, s73, 0x8000
    v_mfma_f32_16x16x32_bf16 v[212:215], a[48:51], a[28:31], v[212:215]
    s_cmp_eq_u32 s73, 0x18000
    v_mfma_f32_16x16x32_bf16 a[60:63], a[48:51], a[144:147], a[60:63]
    s_cselect_b32 s73, 0, s73
    v_mfma_f32_16x16x32_bf16 v[216:219], a[52:55], a[28:31], v[216:219]
    v_add_u32 v226, s73, v224
    v_mfma_f32_16x16x32_bf16 v[188:191], a[52:55], a[24:27], v[188:191]
    v_add_u32_e64 v227, s73, v225
    v_mfma_f32_16x16x32_bf16 v[160:163], a[52:55], a[20:23], v[160:163]
    v_mfma_f32_16x16x32_bf16 v[132:135], a[52:55], a[16:19], v[132:135]
    v_accvgpr_read_b32 v239, a160
    v_mfma_f32_16x16x32_bf16 v[104:107], a[52:55], a[12:15], v[104:107]
    v_accvgpr_read_b32 v240, a161
    v_mfma_f32_16x16x32_bf16 v[76:79], a[52:55], a[8:11], v[76:79]
    v_dot2_f32_bf16 v246, v239, v241, 0
    v_mfma_f32_16x16x32_bf16 v[48:51], a[52:55], a[4:7], v[48:51]
    v_dot2_f32_bf16 v247, v239, v239, 0
    v_mfma_f32_16x16x32_bf16 v[20:23], a[52:55], a[0:3], v[20:23]
    v_accvgpr_read_b32 v239, a162
    v_mfma_f32_16x16x32_bf16 a[60:63], a[52:55], a[148:151], a[60:63]
    v_dot2_f32_bf16 v246, v240, v241, v246
    v_mfma_f32_16x16x32_bf16 v[24:27], a[56:59], a[0:3], v[24:27]
    v_dot2_f32_bf16 v247, v240, v240, v247
    v_mfma_f32_16x16x32_bf16 v[52:55], a[56:59], a[4:7], v[52:55]
    v_accvgpr_read_b32 v240, a163
    v_mfma_f32_16x16x32_bf16 v[80:83], a[56:59], a[8:11], v[80:83]
    v_dot2_f32_bf16 v246, v239, v241, v246
    v_mfma_f32_16x16x32_bf16 v[108:111], a[56:59], a[12:15], v[108:111]
    v_dot2_f32_bf16 v247, v239, v239, v247
    v_mfma_f32_16x16x32_bf16 v[136:139], a[56:59], a[16:19], v[136:139]
    v_accvgpr_read_b32 v239, a164
    v_mfma_f32_16x16x32_bf16 v[164:167], a[56:59], a[20:23], v[164:167]
    v_dot2_f32_bf16 v246, v240, v241, v246
    v_mfma_f32_16x16x32_bf16 v[192:195], a[56:59], a[24:27], v[192:195]
    v_dot2_f32_bf16 v247, v240, v240, v247
    v_mfma_f32_16x16x32_bf16 v[220:223], a[56:59], a[28:31], v[220:223]
    v_accvgpr_read_b32 v240, a165
    v_mfma_f32_16x16x32_bf16 a[60:63], a[56:59], a[152:155], a[60:63]
    s_waitcnt vmcnt(16) lgkmcnt(0)
    s_barrier
    v_mfma_f32_16x16x32_bf16 v[0:3], a[96:99], a[64:67], v[0:3]
    ds_read_b64_tr_b16 a[32:33], v228 offset:0
    v_mfma_f32_16x16x32_bf16 v[28:31], a[96:99], a[68:71], v[28:31]
    ds_read_b64_tr_b16 a[34:35], v228 offset:1792
    v_mfma_f32_16x16x32_bf16 v[56:59], a[96:99], a[72:75], v[56:59]
    ds_read_b128 a[0:3], v226 offset:0
    v_mfma_f32_16x16x32_bf16 v[84:87], a[96:99], a[76:79], v[84:87]
    ds_read_b64_tr_b16 a[36:37], v229 offset:32
    v_mfma_f32_16x16x32_bf16 v[112:115], a[96:99], a[80:83], v[112:115]
    v_mfma_f32_16x16x32_bf16 v[140:143], a[96:99], a[84:87], v[140:143]
    s_add_u32 m0, s70, 49152
    v_mfma_f32_16x16x32_bf16 v[168:171], a[96:99], a[88:91], v[168:171]
    s_add_u32 s67, s67, 229376
    v_mfma_f32_16x16x32_bf16 v[196:199], a[96:99], a[92:95], v[196:199]
    buffer_load_dwordx4 v235, s[44:47], s67 offen lds
    v_mfma_f32_16x16x32_bf16 a[60:63], a[96:99], a[128:131], a[60:63]
    v_mfma_f32_16x16x32_bf16 v[200:203], a[100:103], a[92:95], v[200:203]
    ds_read_b64_tr_b16 a[38:39], v229 offset:1824
    v_mfma_f32_16x16x32_bf16 v[172:175], a[100:103], a[88:91], v[172:175]
    ds_read_b128 a[4:7], v226 offset:2048
    v_mfma_f32_16x16x32_bf16 v[144:147], a[100:103], a[84:87], v[144:147]
    ds_read_b64_tr_b16 a[40:41], v228 offset:64
    v_mfma_f32_16x16x32_bf16 v[116:119], a[100:103], a[80:83], v[116:119]
    v_mfma_f32_16x16x32_bf16 v[88:91], a[100:103], a[76:79], v[88:91]
    ds_read_b64_tr_b16 a[42:43], v228 offset:1856
    v_mfma_f32_16x16x32_bf16 v[60:63], a[100:103], a[72:75], v[60:63]
    buffer_load_dwordx4 v236, s[44:47], s67 offen offset:1024 lds
    v_mfma_f32_16x16x32_bf16 v[32:35], a[100:103], a[68:71], v[32:35]
    ds_read_b128 a[8:11], v226 offset:4096
    v_mfma_f32_16x16x32_bf16 v[4:7], a[100:103], a[64:67], v[4:7]
    v_mfma_f32_16x16x32_bf16 a[60:63], a[100:103], a[132:135], a[60:63]
    ds_read_b64_tr_b16 a[44:45], v229 offset:96
    v_mfma_f32_16x16x32_bf16 v[8:11], a[104:107], a[64:67], v[8:11]
    ds_read_b64_tr_b16 a[46:47], v229 offset:1888
    v_mfma_f32_16x16x32_bf16 v[36:39], a[104:107], a[68:71], v[36:39]
    ds_read_b128 a[12:15], v226 offset:6144
    v_mfma_f32_16x16x32_bf16 v[64:67], a[104:107], a[72:75], v[64:67]
    v_mfma_f32_16x16x32_bf16 v[92:95], a[104:107], a[76:79], v[92:95]
    buffer_load_dwordx4 v237, s[44:47], s67 offen offset:2048 lds
    v_mfma_f32_16x16x32_bf16 v[120:123], a[104:107], a[80:83], v[120:123]
    ds_read_b64_tr_b16 a[48:49], v228 offset:128
    v_mfma_f32_16x16x32_bf16 v[148:151], a[104:107], a[84:87], v[148:151]
    ds_read_b64_tr_b16 a[50:51], v228 offset:1920
    v_mfma_f32_16x16x32_bf16 v[176:179], a[104:107], a[88:91], v[176:179]
    ds_read_b128 a[16:19], v226 offset:8192
    v_mfma_f32_16x16x32_bf16 v[204:207], a[104:107], a[92:95], v[204:207]
    v_mfma_f32_16x16x32_bf16 a[60:63], a[104:107], a[136:139], a[60:63]
    ds_read_b64_tr_b16 a[52:53], v229 offset:160
    v_mfma_f32_16x16x32_bf16 v[208:211], a[108:111], a[92:95], v[208:211]
    buffer_load_dwordx4 v238, s[44:47], s67 offen offset:3072 lds
    v_mfma_f32_16x16x32_bf16 v[180:183], a[108:111], a[88:91], v[180:183]
    ds_read_b64_tr_b16 a[54:55], v229 offset:1952
    v_mfma_f32_16x16x32_bf16 v[152:155], a[108:111], a[84:87], v[152:155]
    v_mfma_f32_16x16x32_bf16 v[124:127], a[108:111], a[80:83], v[124:127]
    ds_read_b128 a[20:23], v226 offset:10240
    v_mfma_f32_16x16x32_bf16 v[96:99], a[108:111], a[76:79], v[96:99]
    ds_read_b64_tr_b16 a[56:57], v230 offset:0
    v_mfma_f32_16x16x32_bf16 v[68:71], a[108:111], a[72:75], v[68:71]
    ds_read_b64_tr_b16 a[58:59], v230 offset:1792
    v_mfma_f32_16x16x32_bf16 v[40:43], a[108:111], a[68:71], v[40:43]
    v_mfma_f32_16x16x32_bf16 v[12:15], a[108:111], a[64:67], v[12:15]
    s_add_u32 m0, s68, s72
    v_mfma_f32_16x16x32_bf16 a[60:63], a[108:111], a[140:143], a[60:63]
    s_add_u32 s80, s64, s66
    v_mfma_f32_16x16x32_bf16 v[16:19], a[112:115], a[64:67], v[16:19]
    buffer_load_dwordx4 v231, s[40:43], s80 offen lds
    v_mfma_f32_16x16x32_bf16 v[44:47], a[112:115], a[68:71], v[44:47]
    v_mfma_f32_16x16x32_bf16 v[72:75], a[112:115], a[72:75], v[72:75]
    ds_read_b128 a[24:27], v226 offset:12288
    v_mfma_f32_16x16x32_bf16 v[100:103], a[112:115], a[76:79], v[100:103]
    ds_read_b128 a[28:31], v226 offset:14336
    v_mfma_f32_16x16x32_bf16 v[128:131], a[112:115], a[80:83], v[128:131]
    buffer_load_dwordx4 v232, s[40:43], s80 offen offset:1024 lds
    v_mfma_f32_16x16x32_bf16 v[156:159], a[112:115], a[84:87], v[156:159]
    v_mfma_f32_16x16x32_bf16 v[184:187], a[112:115], a[88:91], v[184:187]
    buffer_load_dwordx4 v233, s[40:43], s80 offen offset:2048 lds
    v_mfma_f32_16x16x32_bf16 v[212:215], a[112:115], a[92:95], v[212:215]
    buffer_load_dwordx4 v234, s[40:43], s80 offen offset:3072 lds
    v_mfma_f32_16x16x32_bf16 a[60:63], a[112:115], a[144:147], a[60:63]
    v_dot2_f32_bf16 v246, v239, v241, v246
    v_mfma_f32_16x16x32_bf16 v[216:219], a[116:119], a[92:95], v[216:219]
    v_dot2_f32_bf16 v247, v239, v239, v247
    v_mfma_f32_16x16x32_bf16 v[188:191], a[116:119], a[88:91], v[188:191]
    v_mfma_f32_16x16x32_bf16 v[160:163], a[116:119], a[84:87], v[160:163]
    v_accvgpr_read_b32 v239, a166
    v_mfma_f32_16x16x32_bf16 v[132:135], a[116:119], a[80:83], v[132:135]
    v_dot2_f32_bf16 v246, v240, v241, v246
    v_mfma_f32_16x16x32_bf16 v[104:107], a[116:119], a[76:79], v[104:107]
    v_dot2_f32_bf16 v247, v240, v240, v247
    v_mfma_f32_16x16x32_bf16 v[76:79], a[116:119], a[72:75], v[76:79]
    v_mfma_f32_16x16x32_bf16 v[48:51], a[116:119], a[68:71], v[48:51]
    v_accvgpr_read_b32 v240, a167
    v_mfma_f32_16x16x32_bf16 v[20:23], a[116:119], a[64:67], v[20:23]
    v_dot2_f32_bf16 v246, v239, v241, v246
    v_mfma_f32_16x16x32_bf16 a[60:63], a[116:119], a[148:151], a[60:63]
    v_dot2_f32_bf16 v247, v239, v239, v247
    v_mfma_f32_16x16x32_bf16 v[24:27], a[120:123], a[64:67], v[24:27]
    v_mfma_f32_16x16x32_bf16 v[52:55], a[120:123], a[68:71], v[52:55]
    v_accvgpr_read_b32 v239, a168
    v_mfma_f32_16x16x32_bf16 v[80:83], a[120:123], a[72:75], v[80:83]
    v_dot2_f32_bf16 v246, v240, v241, v246
    v_mfma_f32_16x16x32_bf16 v[108:111], a[120:123], a[76:79], v[108:111]
    v_dot2_f32_bf16 v247, v240, v240, v247
    v_mfma_f32_16x16x32_bf16 v[136:139], a[120:123], a[80:83], v[136:139]
    v_mfma_f32_16x16x32_bf16 v[164:167], a[120:123], a[84:87], v[164:167]
    v_accvgpr_read_b32 v240, a169
    v_mfma_f32_16x16x32_bf16 v[192:195], a[120:123], a[88:91], v[192:195]
    v_dot2_f32_bf16 v246, v239, v241, v246
    v_mfma_f32_16x16x32_bf16 v[220:223], a[120:123], a[92:95], v[220:223]
    v_dot2_f32_bf16 v247, v239, v239, v247
    v_mfma_f32_16x16x32_bf16 a[60:63], a[120:123], a[152:155], a[60:63]
    s_waitcnt vmcnt(16) lgkmcnt(0)
    s_barrier
    v_mfma_f32_16x16x32_bf16 v[0:3], a[32:35], a[0:3], v[0:3]
    ds_read_b64_tr_b16 a[96:97], v228 offset:16384
    v_mfma_f32_16x16x32_bf16 v[28:31], a[32:35], a[4:7], v[28:31]
    ds_read_b64_tr_b16 a[98:99], v228 offset:18176
    v_mfma_f32_16x16x32_bf16 v[56:59], a[32:35], a[8:11], v[56:59]
    ds_read_b128 a[64:67], v227 offset:0
    v_mfma_f32_16x16x32_bf16 v[84:87], a[32:35], a[12:15], v[84:87]
    ds_read_b64_tr_b16 a[100:101], v229 offset:16416
    v_mfma_f32_16x16x32_bf16 v[112:115], a[32:35], a[16:19], v[112:115]
    s_add_u32 m0, s70, 0
    v_mfma_f32_16x16x32_bf16 v[140:143], a[32:35], a[20:23], v[140:143]
    s_add_u32 s67, s67, 229376
    v_mfma_f32_16x16x32_bf16 v[168:171], a[32:35], a[24:27], v[168:171]
    s_cmp_eq_u32 s67, 7340032
    v_mfma_f32_16x16x32_bf16 v[196:199], a[32:35], a[28:31], v[196:199]
    s_cselect_b32 s67, 917504, s67
    v_mfma_f32_16x16x32_bf16 a[124:127], a[32:35], a[128:131], 0
    buffer_load_dwordx4 v235, s[44:47], s67 offen lds
    v_mfma_f32_16x16x32_bf16 v[200:203], a[36:39], a[28:31], v[200:203]
    ds_read_b64_tr_b16 a[102:103], v229 offset:18208
    v_mfma_f32_16x16x32_bf16 v[172:175], a[36:39], a[24:27], v[172:175]
    ds_read_b128 a[68:71], v227 offset:2048
    v_mfma_f32_16x16x32_bf16 v[144:147], a[36:39], a[20:23], v[144:147]
    ds_read_b64_tr_b16 a[104:105], v228 offset:16448
    v_mfma_f32_16x16x32_bf16 v[116:119], a[36:39], a[16:19], v[116:119]
    ds_read_b64_tr_b16 a[106:107], v228 offset:18240
    v_mfma_f32_16x16x32_bf16 v[88:91], a[36:39], a[12:15], v[88:91]
    buffer_load_dwordx4 v236, s[44:47], s67 offen offset:1024 lds
    v_mfma_f32_16x16x32_bf16 v[60:63], a[36:39], a[8:11], v[60:63]
    ds_read_b128 a[72:75], v227 offset:4096
    v_mfma_f32_16x16x32_bf16 v[32:35], a[36:39], a[4:7], v[32:35]
    ds_read_b64_tr_b16 a[108:109], v229 offset:16480
    v_mfma_f32_16x16x32_bf16 v[4:7], a[36:39], a[0:3], v[4:7]
    ds_read_b64_tr_b16 a[110:111], v229 offset:18272
    v_mfma_f32_16x16x32_bf16 a[124:127], a[36:39], a[132:135], a[124:127]
    ds_read_b128 a[76:79], v227 offset:6144
    v_mfma_f32_16x16x32_bf16 v[8:11], a[40:43], a[0:3], v[8:11]
    buffer_load_dwordx4 v237, s[44:47], s67 offen offset:2048 lds
    v_mfma_f32_16x16x32_bf16 v[36:39], a[40:43], a[4:7], v[36:39]
    ds_read_b64_tr_b16 a[112:113], v228 offset:16512
    v_mfma_f32_16x16x32_bf16 v[64:67], a[40:43], a[8:11], v[64:67]
    ds_read_b64_tr_b16 a[114:115], v228 offset:18304
    v_mfma_f32_16x16x32_bf16 v[92:95], a[40:43], a[12:15], v[92:95]
    ds_read_b128 a[80:83], v227 offset:8192
    v_mfma_f32_16x16x32_bf16 v[120:123], a[40:43], a[16:19], v[120:123]
    ds_read_b64_tr_b16 a[116:117], v229 offset:16544
    v_mfma_f32_16x16x32_bf16 v[148:151], a[40:43], a[20:23], v[148:151]
    buffer_load_dwordx4 v238, s[44:47], s67 offen offset:3072 lds
    v_mfma_f32_16x16x32_bf16 v[176:179], a[40:43], a[24:27], v[176:179]
    ds_read_b64_tr_b16 a[118:119], v229 offset:18336
    v_mfma_f32_16x16x32_bf16 v[204:207], a[40:43], a[28:31], v[204:207]
    ds_read_b128 a[84:87], v227 offset:10240
    v_mfma_f32_16x16x32_bf16 a[124:127], a[40:43], a[136:139], a[124:127]
    ds_read_b64_tr_b16 a[120:121], v230 offset:16384
    v_mfma_f32_16x16x32_bf16 v[208:211], a[44:47], a[28:31], v[208:211]
    ds_read_b64_tr_b16 a[122:123], v230 offset:18176
    v_mfma_f32_16x16x32_bf16 v[180:183], a[44:47], a[24:27], v[180:183]
    s_add_u32 m0, s69, s72
    v_mfma_f32_16x16x32_bf16 v[152:155], a[44:47], a[20:23], v[152:155]
    s_add_u32 s80, s65, s66
    v_mfma_f32_16x16x32_bf16 v[124:127], a[44:47], a[16:19], v[124:127]
    buffer_load_dwordx4 v231, s[40:43], s80 offen lds
    v_mfma_f32_16x16x32_bf16 v[96:99], a[44:47], a[12:15], v[96:99]
    v_mfma_f32_16x16x32_bf16 v[68:71], a[44:47], a[8:11], v[68:71]
    ds_read_b128 a[88:91], v227 offset:12288
    v_mfma_f32_16x16x32_bf16 v[40:43], a[44:47], a[4:7], v[40:43]
    ds_read_b128 a[92:95], v227 offset:14336
    v_mfma_f32_16x16x32_bf16 v[12:15], a[44:47], a[0:3], v[12:15]
    buffer_load_dwordx4 v232, s[40:43], s80 offen offset:1024 lds
    v_mfma_f32_16x16x32_bf16 a[124:127], a[44:47], a[140:143], a[124:127]
    buffer_load_dwordx4 v233, s[40:43], s80 offen offset:2048 lds
    v_mfma_f32_16x16x32_bf16 v[16:19], a[48:51], a[0:3], v[16:19]
    s_add_u32 s72, s72, 0x8000
    v_mfma_f32_16x16x32_bf16 v[44:47], a[48:51], a[4:7], v[44:47]
    s_cmp_eq_u32 s72, 0x18000
    v_mfma_f32_16x16x32_bf16 v[72:75], a[48:51], a[8:11], v[72:75]
    s_cselect_b32 s72, 0, s72
    v_mfma_f32_16x16x32_bf16 v[100:103], a[48:51], a[12:15], v[100:103]
    buffer_load_dwordx4 v234, s[40:43], s80 offen offset:3072 lds
    v_mfma_f32_16x16x32_bf16 v[128:131], a[48:51], a[16:19], v[128:131]
    s_add_u32 s66, s66, 128
    v_mfma_f32_16x16x32_bf16 v[156:159], a[48:51], a[20:23], v[156:159]
    s_cmp_eq_u32 s66, 2048
    v_mfma_f32_16x16x32_bf16 v[184:187], a[48:51], a[24:27], v[184:187]
    s_cselect_b32 s66, 256, s66
    v_mfma_f32_16x16x32_bf16 v[212:215], a[48:51], a[28:31], v[212:215]
    s_add_u32 s73, s73, 0x8000
    v_mfma_f32_16x16x32_bf16 a[124:127], a[48:51], a[144:147], a[124:127]
    s_cmp_eq_u32 s73, 0x18000
    v_mfma_f32_16x16x32_bf16 v[216:219], a[52:55], a[28:31], v[216:219]
    s_cselect_b32 s73, 0, s73
    v_mfma_f32_16x16x32_bf16 v[188:191], a[52:55], a[24:27], v[188:191]
    v_add_u32 v226, s73, v224
    v_mfma_f32_16x16x32_bf16 v[160:163], a[52:55], a[20:23], v[160:163]
    v_add_u32_e64 v227, s73, v225
    v_mfma_f32_16x16x32_bf16 v[132:135], a[52:55], a[16:19], v[132:135]
    v_accvgpr_read_b32 v239, a170
    v_mfma_f32_16x16x32_bf16 v[104:107], a[52:55], a[12:15], v[104:107]
    v_dot2_f32_bf16 v246, v240, v241, v246
    v_mfma_f32_16x16x32_bf16 v[76:79], a[52:55], a[8:11], v[76:79]
    v_dot2_f32_bf16 v247, v240, v240, v247
    v_mfma_f32_16x16x32_bf16 v[48:51], a[52:55], a[4:7], v[48:51]
    v_accvgpr_read_b32 v240, a171
    v_mfma_f32_16x16x32_bf16 v[20:23], a[52:55], a[0:3], v[20:23]
    v_dot2_f32_bf16 v246, v239, v241, v246
    v_mfma_f32_16x16x32_bf16 a[124:127], a[52:55], a[148:151], a[124:127]
    v_dot2_f32_bf16 v247, v239, v239, v247
    v_mfma_f32_16x16x32_bf16 v[24:27], a[56:59], a[0:3], v[24:27]
    v_accvgpr_read_b32 v239, a172
    v_mfma_f32_16x16x32_bf16 v[52:55], a[56:59], a[4:7], v[52:55]
    v_dot2_f32_bf16 v246, v240, v241, v246
    v_mfma_f32_16x16x32_bf16 v[80:83], a[56:59], a[8:11], v[80:83]
    v_dot2_f32_bf16 v247, v240, v240, v247
    v_mfma_f32_16x16x32_bf16 v[108:111], a[56:59], a[12:15], v[108:111]
    v_accvgpr_read_b32 v240, a173
    v_mfma_f32_16x16x32_bf16 v[136:139], a[56:59], a[16:19], v[136:139]
    v_dot2_f32_bf16 v246, v239, v241, v246
    v_mfma_f32_16x16x32_bf16 v[164:167], a[56:59], a[20:23], v[164:167]
    v_dot2_f32_bf16 v247, v239, v239, v247
    v_mfma_f32_16x16x32_bf16 v[192:195], a[56:59], a[24:27], v[192:195]
    v_accvgpr_read_b32 v239, a174
    v_mfma_f32_16x16x32_bf16 v[220:223], a[56:59], a[28:31], v[220:223]
    v_dot2_f32_bf16 v246, v240, v241, v246
    v_mfma_f32_16x16x32_bf16 a[124:127], a[56:59], a[152:155], a[124:127]
    s_waitcnt vmcnt(16) lgkmcnt(0)
    s_barrier
    v_mfma_f32_16x16x32_bf16 v[0:3], a[96:99], a[64:67], v[0:3]
    ds_read_b64_tr_b16 a[32:33], v228 offset:32768
    v_mfma_f32_16x16x32_bf16 v[28:31], a[96:99], a[68:71], v[28:31]
    ds_read_b64_tr_b16 a[34:35], v228 offset:34560
    v_mfma_f32_16x16x32_bf16 v[56:59], a[96:99], a[72:75], v[56:59]
    ds_read_b128 a[0:3], v226 offset:0
    v_mfma_f32_16x16x32_bf16 v[84:87], a[96:99], a[76:79], v[84:87]
    ds_read_b64_tr_b16 a[36:37], v229 offset:32800
    v_mfma_f32_16x16x32_bf16 v[112:115], a[96:99], a[80:83], v[112:115]
    v_mfma_f32_16x16x32_bf16 v[140:143], a[96:99], a[84:87], v[140:143]
    s_add_u32 m0, s70, 16384
    v_mfma_f32_16x16x32_bf16 v[168:171], a[96:99], a[88:91], v[168:171]
    s_add_u32 s67, s67, 229376
    v_mfma_f32_16x16x32_bf16 v[196:199], a[96:99], a[92:95], v[196:199]
    buffer_load_dwordx4 v235, s[44:47], s67 offen lds
    v_mfma_f32_16x16x32_bf16 a[124:127], a[96:99], a[128:131], a[124:127]
    v_mfma_f32_16x16x32_bf16 v[200:203], a[100:103], a[92:95], v[200:203]
    ds_read_b64_tr_b16 a[38:39], v229 offset:34592
    v_mfma_f32_16x16x32_bf16 v[172:175], a[100:103], a[88:91], v[172:175]
    ds_read_b128 a[4:7], v226 offset:2048
    v_mfma_f32_16x16x32_bf16 v[144:147], a[100:103], a[84:87], v[144:147]
    ds_read_b64_tr_b16 a[40:41], v228 offset:32832
    v_mfma_f32_16x16x32_bf16 v[116:119], a[100:103], a[80:83], v[116:119]
    ds_read_b64_tr_b16 a[42:43], v228 offset:34624
    v_mfma_f32_16x16x32_bf16 v[88:91], a[100:103], a[76:79], v[88:91]
    v_mfma_f32_16x16x32_bf16 v[60:63], a[100:103], a[72:75], v[60:63]
    buffer_load_dwordx4 v236, s[44:47], s67 offen offset:1024 lds
    v_mfma_f32_16x16x32_bf16 v[32:35], a[100:103], a[68:71], v[32:35]
    ds_read_b128 a[8:11], v226 offset:4096
    v_mfma_f32_16x16x32_bf16 v[4:7], a[100:103], a[64:67], v[4:7]
    ds_read_b64_tr_b16 a[44:45], v229 offset:32864
    v_mfma_f32_16x16x32_bf16 a[124:127], a[100:103], a[132:135], a[124:127]
    v_mfma_f32_16x16x32_bf16 v[8:11], a[104:107], a[64:67], v[8:11]
    ds_read_b64_tr_b16 a[46:47], v229 offset:34656
    v_mfma_f32_16x16x32_bf16 v[36:39], a[104:107], a[68:71], v[36:39]
    ds_read_b128 a[12:15], v226 offset:6144
    v_mfma_f32_16x16x32_bf16 v[64:67], a[104:107], a[72:75], v[64:67]
    buffer_load_dwordx4 v237, s[44:47], s67 offen offset:2048 lds
    v_mfma_f32_16x16x32_bf16 v[92:95], a[104:107], a[76:79], v[92:95]
    ds_read_b64_tr_b16 a[48:49], v228 offset:32896
    v_mfma_f32_16x16x32_bf16 v[120:123], a[104:107], a[80:83], v[120:123]
    v_mfma_f32_16x16x32_bf16 v[148:151], a[104:107], a[84:87], v[148:151]
    ds_read_b64_tr_b16 a[50:51], v228 offset:34688
    v_mfma_f32_16x16x32_bf16 v[176:179], a[104:107], a[88:91], v[176:179]
    ds_read_b128 a[16:19], v226 offset:8192
    v_mfma_f32_16x16x32_bf16 v[204:207], a[104:107], a[92:95], v[204:207]
    ds_read_b64_tr_b16 a[52:53], v229 offset:32928
    v_mfma_f32_16x16x32_bf16 a[124:127], a[104:107], a[136:139], a[124:127]
    v_mfma_f32_16x16x32_bf16 v[208:211], a[108:111], a[92:95], v[208:211]
    buffer_load_dwordx4 v238, s[44:47], s67 offen offset:3072 lds
    v_mfma_f32_16x16x32_bf16 v[180:183], a[108:111], a[88:91], v[180:183]
    ds_read_b64_tr_b16 a[54:55], v229 offset:34720
    v_mfma_f32_16x16x32_bf16 v[152:155], a[108:111], a[84:87], v[152:155]
    ds_read_b128 a[20:23], v226 offset:10240
    v_mfma_f32_16x16x32_bf16 v[124:127], a[108:111], a[80:83], v[124:127]
    ds_read_b64_tr_b16 a[56:57], v230 offset:32768
    v_mfma_f32_16x16x32_bf16 v[96:99], a[108:111], a[76:79], v[96:99]
    v_mfma_f32_16x16x32_bf16 v[68:71], a[108:111], a[72:75], v[68:71]
    ds_read_b64_tr_b16 a[58:59], v230 offset:34560
    v_mfma_f32_16x16x32_bf16 v[40:43], a[108:111], a[68:71], v[40:43]
    s_add_u32 m0, s68, s72
    v_mfma_f32_16x16x32_bf16 v[12:15], a[108:111], a[64:67], v[12:15]
    s_add_u32 s80, s64, s66
    v_mfma_f32_16x16x32_bf16 a[124:127], a[108:111], a[140:143], a[124:127]
    v_mfma_f32_16x16x32_bf16 v[16:19], a[112:115], a[64:67], v[16:19]
    buffer_load_dwordx4 v231, s[40:43], s80 offen lds
    v_mfma_f32_16x16x32_bf16 v[44:47], a[112:115], a[68:71], v[44:47]
    ds_read_b128 a[24:27], v226 offset:12288
    v_mfma_f32_16x16x32_bf16 v[72:75], a[112:115], a[72:75], v[72:75]
    ds_read_b128 a[28:31], v226 offset:14336
    v_mfma_f32_16x16x32_bf16 v[100:103], a[112:115], a[76:79], v[100:103]
    buffer_load_dwordx4 v232, s[40:43], s80 offen offset:1024 lds
    v_mfma_f32_16x16x32_bf16 v[128:131], a[112:115], a[80:83], v[128:131]
    v_mfma_f32_16x16x32_bf16 v[156:159], a[112:115], a[84:87], v[156:159]
    buffer_load_dwordx4 v233, s[40:43], s80 offen offset:2048 lds
    v_mfma_f32_16x16x32_bf16 v[184:187], a[112:115], a[88:91], v[184:187]
    buffer_load_dwordx4 v234, s[40:43], s80 offen offset:3072 lds
    v_mfma_f32_16x16x32_bf16 v[212:215], a[112:115], a[92:95], v[212:215]
    v_dot2_f32_bf16 v247, v240, v240, v247
    v_mfma_f32_16x16x32_bf16 a[124:127], a[112:115], a[144:147], a[124:127]
    v_mfma_f32_16x16x32_bf16 v[216:219], a[116:119], a[92:95], v[216:219]
    v_accvgpr_read_b32 v240, a175
    v_mfma_f32_16x16x32_bf16 v[188:191], a[116:119], a[88:91], v[188:191]
    v_dot2_f32_bf16 v246, v239, v241, v246
    v_mfma_f32_16x16x32_bf16 v[160:163], a[116:119], a[84:87], v[160:163]
    v_dot2_f32_bf16 v247, v239, v239, v247
    v_mfma_f32_16x16x32_bf16 v[132:135], a[116:119], a[80:83], v[132:135]
    v_dot2_f32_bf16 v246, v240, v241, v246
    v_mfma_f32_16x16x32_bf16 v[104:107], a[116:119], a[76:79], v[104:107]
    v_mfma_f32_16x16x32_bf16 v[76:79], a[116:119], a[72:75], v[76:79]
    v_dot2_f32_bf16 v247, v240, v240, v247
    v_mfma_f32_16x16x32_bf16 v[48:51], a[116:119], a[68:71], v[48:51]
    s_nop 2
    v_mfma_f32_16x16x32_bf16 v[20:23], a[116:119], a[64:67], v[20:23]
    v_add_f32_dpp v246, v246, v246 quad_perm:[1,0,3,2] row_mask:0xf bank_mask:0xf
    v_mfma_f32_16x16x32_bf16 a[124:127], a[116:119], a[148:151], a[124:127]
    v_mfma_f32_16x16x32_bf16 v[24:27], a[120:123], a[64:67], v[24:27]
    v_add_f32_dpp v247, v247, v247 quad_perm:[1,0,3,2] row_mask:0xf bank_mask:0xf
    v_mfma_f32_16x16x32_bf16 v[52:55], a[120:123], a[68:71], v[52:55]
    s_nop 0
    v_mfma_f32_16x16x32_bf16 v[80:83], a[120:123], a[72:75], v[80:83]
    v_add_f32_dpp v246, v246, v246 quad_perm:[2,3,0,1] row_mask:0xf bank_mask:0xf
    v_mfma_f32_16x16x32_bf16 v[108:111], a[120:123], a[76:79], v[108:111]
    v_add_f32_dpp v247, v247, v247 quad_perm:[2,3,0,1] row_mask:0xf bank_mask:0xf
    v_mfma_f32_16x16x32_bf16 v[136:139], a[120:123], a[80:83], v[136:139]
    v_mfma_f32_16x16x32_bf16 v[164:167], a[120:123], a[84:87], v[164:167]
    s_nop 0
    v_mfma_f32_16x16x32_bf16 v[192:195], a[120:123], a[88:91], v[192:195]
    v_add_f32_dpp v246, v246, v246 row_half_mirror row_mask:0xf bank_mask:0xf
    v_mfma_f32_16x16x32_bf16 v[220:223], a[120:123], a[92:95], v[220:223]
    buffer_store_dwordx4 a[60:63], v243, s[36:39], s76 offen sc1
    v_mfma_f32_16x16x32_bf16 a[124:127], a[120:123], a[152:155], a[124:127]
    s_waitcnt vmcnt(16) lgkmcnt(0)
    s_barrier
    v_mfma_f32_16x16x32_bf16 v[0:3], a[32:35], a[0:3], v[0:3]
    ds_read_b64_tr_b16 a[96:97], v228 offset:49152
    v_mfma_f32_16x16x32_bf16 v[28:31], a[32:35], a[4:7], v[28:31]
    ds_read_b64_tr_b16 a[98:99], v228 offset:50944
    v_mfma_f32_16x16x32_bf16 v[56:59], a[32:35], a[8:11], v[56:59]
    ds_read_b128 a[64:67], v227 offset:0
    v_mfma_f32_16x16x32_bf16 v[84:87], a[32:35], a[12:15], v[84:87]
    ds_read_b64_tr_b16 a[100:101], v229 offset:49184
    v_mfma_f32_16x16x32_bf16 v[112:115], a[32:35], a[16:19], v[112:115]
    s_add_u32 m0, s70, 32768
    v_mfma_f32_16x16x32_bf16 v[140:143], a[32:35], a[20:23], v[140:143]
    s_add_u32 s67, s67, 229376
    v_mfma_f32_16x16x32_bf16 v[168:171], a[32:35], a[24:27], v[168:171]
    buffer_load_dwordx4 v235, s[44:47], s67 offen lds
    v_mfma_f32_16x16x32_bf16 v[196:199], a[32:35], a[28:31], v[196:199]
    ds_read_b64_tr_b16 a[102:103], v229 offset:50976
    v_mfma_f32_16x16x32_bf16 a[124:127], a[32:35], a[128:131], a[124:127]
    ds_read_b128 a[68:71], v227 offset:2048
    v_mfma_f32_16x16x32_bf16 v[200:203], a[36:39], a[28:31], v[200:203]
    ds_read_b64_tr_b16 a[104:105], v228 offset:49216
    v_mfma_f32_16x16x32_bf16 v[172:175], a[36:39], a[24:27], v[172:175]
    ds_read_b64_tr_b16 a[106:107], v228 offset:51008
    v_mfma_f32_16x16x32_bf16 v[144:147], a[36:39], a[20:23], v[144:147]
    buffer_load_dwordx4 v236, s[44:47], s67 offen offset:1024 lds
    v_mfma_f32_16x16x32_bf16 v[116:119], a[36:39], a[16:19], v[116:119]
    ds_read_b128 a[72:75], v227 offset:4096
    v_mfma_f32_16x16x32_bf16 v[88:91], a[36:39], a[12:15], v[88:91]
    ds_read_b64_tr_b16 a[108:109], v229 offset:49248
    v_mfma_f32_16x16x32_bf16 v[60:63], a[36:39], a[8:11], v[60:63]
    ds_read_b64_tr_b16 a[110:111], v229 offset:51040
    v_mfma_f32_16x16x32_bf16 v[32:35], a[36:39], a[4:7], v[32:35]
    v_mfma_f32_16x16x32_bf16 v[4:7], a[36:39], a[0:3], v[4:7]
    ds_read_b128 a[76:79], v227 offset:6144
    v_mfma_f32_16x16x32_bf16 a[124:127], a[36:39], a[132:135], a[124:127]
    buffer_load_dwordx4 v237, s[44:47], s67 offen offset:2048 lds
    v_mfma_f32_16x16x32_bf16 v[8:11], a[40:43], a[0:3], v[8:11]
    ds_read_b64_tr_b16 a[112:113], v228 offset:49280
    v_mfma_f32_16x16x32_bf16 v[36:39], a[40:43], a[4:7], v[36:39]
    ds_read_b64_tr_b16 a[114:115], v228 offset:51072
    v_mfma_f32_16x16x32_bf16 v[64:67], a[40:43], a[8:11], v[64:67]
    ds_read_b128 a[80:83], v227 offset:8192
    v_mfma_f32_16x16x32_bf16 v[92:95], a[40:43], a[12:15], v[92:95]
    ds_read_b64_tr_b16 a[116:117], v229 offset:49312
    v_mfma_f32_16x16x32_bf16 v[120:123], a[40:43], a[16:19], v[120:123]
    buffer_load_dwordx4 v238, s[44:47], s67 offen offset:3072 lds
    v_mfma_f32_16x16x32_bf16 v[148:151], a[40:43], a[20:23], v[148:151]
    ds_read_b64_tr_b16 a[118:119], v229 offset:51104
    v_mfma_f32_16x16x32_bf16 v[176:179], a[40:43], a[24:27], v[176:179]
    ds_read_b128 a[84:87], v227 offset:10240
    v_mfma_f32_16x16x32_bf16 v[204:207], a[40:43], a[28:31], v[204:207]
    ds_read_b64_tr_b16 a[120:121], v230 offset:49152
    v_mfma_f32_16x16x32_bf16 a[124:127], a[40:43], a[136:139], a[124:127]
    ds_read_b64_tr_b16 a[122:123], v230 offset:50944
    v_mfma_f32_16x16x32_bf16 v[208:211], a[44:47], a[28:31], v[208:211]
    s_add_u32 m0, s69, s72
    v_mfma_f32_16x16x32_bf16 v[180:183], a[44:47], a[24:27], v[180:183]
    s_add_u32 s80, s65, s66
    v_mfma_f32_16x16x32_bf16 v[152:155], a[44:47], a[20:23], v[152:155]
    buffer_load_dwordx4 v231, s[40:43], s80 offen lds
    v_mfma_f32_16x16x32_bf16 v[124:127], a[44:47], a[16:19], v[124:127]
    ds_read_b128 a[88:91], v227 offset:12288
    v_mfma_f32_16x16x32_bf16 v[96:99], a[44:47], a[12:15], v[96:99]
    v_mfma_f32_16x16x32_bf16 v[68:71], a[44:47], a[8:11], v[68:71]
    ds_read_b128 a[92:95], v227 offset:14336
    v_mfma_f32_16x16x32_bf16 v[40:43], a[44:47], a[4:7], v[40:43]
    buffer_load_dwordx4 v232, s[40:43], s80 offen offset:1024 lds
    v_mfma_f32_16x16x32_bf16 v[12:15], a[44:47], a[0:3], v[12:15]
    buffer_load_dwordx4 v233, s[40:43], s80 offen offset:2048 lds
    v_mfma_f32_16x16x32_bf16 a[124:127], a[44:47], a[140:143], a[124:127]
    s_add_u32 s72, s72, 0x8000
    v_mfma_f32_16x16x32_bf16 v[16:19], a[48:51], a[0:3], v[16:19]
    s_cmp_eq_u32 s72, 0x18000
    v_mfma_f32_16x16x32_bf16 v[44:47], a[48:51], a[4:7], v[44:47]
    s_cselect_b32 s72, 0, s72
    v_mfma_f32_16x16x32_bf16 v[72:75], a[48:51], a[8:11], v[72:75]
    buffer_load_dwordx4 v234, s[40:43], s80 offen offset:3072 lds
    v_mfma_f32_16x16x32_bf16 v[100:103], a[48:51], a[12:15], v[100:103]
    s_add_u32 s66, s66, 128
    v_mfma_f32_16x16x32_bf16 v[128:131], a[48:51], a[16:19], v[128:131]
    s_cmp_eq_u32 s66, 2048
    v_mfma_f32_16x16x32_bf16 v[156:159], a[48:51], a[20:23], v[156:159]
    s_cselect_b32 s66, 256, s66
    v_mfma_f32_16x16x32_bf16 v[184:187], a[48:51], a[24:27], v[184:187]
    s_add_u32 s73, s73, 0x8000
    v_mfma_f32_16x16x32_bf16 v[212:215], a[48:51], a[28:31], v[212:215]
    s_cmp_eq_u32 s73, 0x18000
    v_mfma_f32_16x16x32_bf16 a[124:127], a[48:51], a[144:147], a[124:127]
    s_cselect_b32 s73, 0, s73
    v_mfma_f32_16x16x32_bf16 v[216:219], a[52:55], a[28:31], v[216:219]
    v_add_u32 v226, s73, v224
    v_mfma_f32_16x16x32_bf16 v[188:191], a[52:55], a[24:27], v[188:191]
    v_add_u32_e64 v227, s73, v225
    v_mfma_f32_16x16x32_bf16 v[160:163], a[52:55], a[20:23], v[160:163]
    v_mfma_f32_16x16x32_bf16 v[132:135], a[52:55], a[16:19], v[132:135]
    v_add_f32_dpp v247, v247, v247 row_half_mirror row_mask:0xf bank_mask:0xf
    v_mfma_f32_16x16x32_bf16 v[104:107], a[52:55], a[12:15], v[104:107]
    s_nop 0
    v_mfma_f32_16x16x32_bf16 v[76:79], a[52:55], a[8:11], v[76:79]
    v_add_f32_dpp v246, v246, v246 row_mirror row_mask:0xf bank_mask:0xf
    v_mfma_f32_16x16x32_bf16 v[48:51], a[52:55], a[4:7], v[48:51]
    v_add_f32_dpp v247, v247, v247 row_mirror row_mask:0xf bank_mask:0xf
    v_mfma_f32_16x16x32_bf16 v[20:23], a[52:55], a[0:3], v[20:23]
    s_nop 0
    v_mfma_f32_16x16x32_bf16 a[124:127], a[52:55], a[148:151], a[124:127]
    v_mov_b32_e64 v239, v246
    v_mfma_f32_16x16x32_bf16 v[24:27], a[56:59], a[0:3], v[24:27]
    v_mov_b32_e64 v240, v247
    v_mfma_f32_16x16x32_bf16 v[52:55], a[56:59], a[4:7], v[52:55]
    s_nop 0
    v_mfma_f32_16x16x32_bf16 v[80:83], a[56:59], a[8:11], v[80:83]
    v_permlane16_swap_b32 v239, v246
    v_mfma_f32_16x16x32_bf16 v[108:111], a[56:59], a[12:15], v[108:111]
    v_permlane16_swap_b32 v240, v247
    v_mfma_f32_16x16x32_bf16 v[136:139], a[56:59], a[16:19], v[136:139]
    v_add_f32 v246, v246, v239
    v_mfma_f32_16x16x32_bf16 v[164:167], a[56:59], a[20:23], v[164:167]
    v_add_f32_e64 v247, v247, v240
    v_mfma_f32_16x16x32_bf16 v[192:195], a[56:59], a[24:27], v[192:195]
    v_mul_f32 v246, 0x3a800000, v246
    v_mfma_f32_16x16x32_bf16 v[220:223], a[56:59], a[28:31], v[220:223]
    v_mul_f32 v247, 0x3a800000, v247
    v_mfma_f32_16x16x32_bf16 a[124:127], a[56:59], a[152:155], a[124:127]
    s_waitcnt vmcnt(16) lgkmcnt(0)
    s_barrier
    v_mfma_f32_16x16x32_bf16 v[0:3], a[96:99], a[64:67], v[0:3]
    ds_read_b64_tr_b16 a[32:33], v228 offset:0
    v_mfma_f32_16x16x32_bf16 v[28:31], a[96:99], a[68:71], v[28:31]
    ds_read_b64_tr_b16 a[34:35], v228 offset:1792
    v_mfma_f32_16x16x32_bf16 v[56:59], a[96:99], a[72:75], v[56:59]
    ds_read_b128 a[0:3], v226 offset:0
    v_mfma_f32_16x16x32_bf16 v[84:87], a[96:99], a[76:79], v[84:87]
    ds_read_b64_tr_b16 a[36:37], v229 offset:32
    v_mfma_f32_16x16x32_bf16 v[112:115], a[96:99], a[80:83], v[112:115]
    v_mfma_f32_16x16x32_bf16 v[140:143], a[96:99], a[84:87], v[140:143]
    s_add_u32 m0, s70, 49152
    v_mfma_f32_16x16x32_bf16 v[168:171], a[96:99], a[88:91], v[168:171]
    s_add_u32 s67, s67, 229376
    v_mfma_f32_16x16x32_bf16 v[196:199], a[96:99], a[92:95], v[196:199]
    buffer_load_dwordx4 v235, s[44:47], s67 offen lds
    v_mfma_f32_16x16x32_bf16 a[124:127], a[96:99], a[128:131], a[124:127]
    ds_read_b64_tr_b16 a[38:39], v229 offset:1824
    v_mfma_f32_16x16x32_bf16 v[200:203], a[100:103], a[92:95], v[200:203]
    v_mfma_f32_16x16x32_bf16 v[172:175], a[100:103], a[88:91], v[172:175]
    ds_read_b128 a[4:7], v226 offset:2048
    v_mfma_f32_16x16x32_bf16 v[144:147], a[100:103], a[84:87], v[144:147]
    ds_read_b64_tr_b16 a[40:41], v228 offset:64
    v_mfma_f32_16x16x32_bf16 v[116:119], a[100:103], a[80:83], v[116:119]
    ds_read_b64_tr_b16 a[42:43], v228 offset:1856
    v_mfma_f32_16x16x32_bf16 v[88:91], a[100:103], a[76:79], v[88:91]
    buffer_load_dwordx4 v236, s[44:47], s67 offen offset:1024 lds
    v_mfma_f32_16x16x32_bf16 v[60:63], a[100:103], a[72:75], v[60:63]
    v_mfma_f32_16x16x32_bf16 v[32:35], a[100:103], a[68:71], v[32:35]
    ds_read_b128 a[8:11], v226 offset:4096
    v_mfma_f32_16x16x32_bf16 v[4:7], a[100:103], a[64:67], v[4:7]
    ds_read_b64_tr_b16 a[44:45], v229 offset:96
    v_mfma_f32_16x16x32_bf16 a[124:127], a[100:103], a[132:135], a[124:127]
    ds_read_b64_tr_b16 a[46:47], v229 offset:1888
    v_mfma_f32_16x16x32_bf16 v[8:11], a[104:107], a[64:67], v[8:11]
    ds_read_b128 a[12:15], v226 offset:6144
    v_mfma_f32_16x16x32_bf16 v[36:39], a[104:107], a[68:71], v[36:39]
    v_mfma_f32_16x16x32_bf16 v[64:67], a[104:107], a[72:75], v[64:67]
    buffer_load_dwordx4 v237, s[44:47], s67 offen offset:2048 lds
    v_mfma_f32_16x16x32_bf16 v[92:95], a[104:107], a[76:79], v[92:95]
    ds_read_b64_tr_b16 a[48:49], v228 offset:128
    v_mfma_f32_16x16x32_bf16 v[120:123], a[104:107], a[80:83], v[120:123]
    ds_read_b64_tr_b16 a[50:51], v228 offset:1920
    v_mfma_f32_16x16x32_bf16 v[148:151], a[104:107], a[84:87], v[148:151]
    ds_read_b128 a[16:19], v226 offset:8192
    v_mfma_f32_16x16x32_bf16 v[176:179], a[104:107], a[88:91], v[176:179]
    v_mfma_f32_16x16x32_bf16 v[204:207], a[104:107], a[92:95], v[204:207]
    ds_read_b64_tr_b16 a[52:53], v229 offset:160
    v_mfma_f32_16x16x32_bf16 a[124:127], a[104:107], a[136:139], a[124:127]
    buffer_load_dwordx4 v238, s[44:47], s67 offen offset:3072 lds
    v_mfma_f32_16x16x32_bf16 v[208:211], a[108:111], a[92:95], v[208:211]
    ds_read_b64_tr_b16 a[54:55], v229 offset:1952
    v_mfma_f32_16x16x32_bf16 v[180:183], a[108:111], a[88:91], v[180:183]
    ds_read_b128 a[20:23], v226 offset:10240
    v_mfma_f32_16x16x32_bf16 v[152:155], a[108:111], a[84:87], v[152:155]
    v_mfma_f32_16x16x32_bf16 v[124:127], a[108:111], a[80:83], v[124:127]
    ds_read_b64_tr_b16 a[56:57], v230 offset:0
    v_mfma_f32_16x16x32_bf16 v[96:99], a[108:111], a[76:79], v[96:99]
    ds_read_b64_tr_b16 a[58:59], v230 offset:1792
    v_mfma_f32_16x16x32_bf16 v[68:71], a[108:111], a[72:75], v[68:71]
    s_add_u32 m0, s68, s72
    v_mfma_f32_16x16x32_bf16 v[40:43], a[108:111], a[68:71], v[40:43]
    v_mfma_f32_16x16x32_bf16 v[12:15], a[108:111], a[64:67], v[12:15]
    s_add_u32 s80, s64, s66
    v_mfma_f32_16x16x32_bf16 a[124:127], a[108:111], a[140:143], a[124:127]
    buffer_load_dwordx4 v231, s[40:43], s80 offen lds
    v_mfma_f32_16x16x32_bf16 v[16:19], a[112:115], a[64:67], v[16:19]
    ds_read_b128 a[24:27], v226 offset:12288
    v_mfma_f32_16x16x32_bf16 v[44:47], a[112:115], a[68:71], v[44:47]
    ds_read_b128 a[28:31], v226 offset:14336
    v_mfma_f32_16x16x32_bf16 v[72:75], a[112:115], a[72:75], v[72:75]
    v_mfma_f32_16x16x32_bf16 v[100:103], a[112:115], a[76:79], v[100:103]
    buffer_load_dwordx4 v232, s[40:43], s80 offen offset:1024 lds
    v_mfma_f32_16x16x32_bf16 v[128:131], a[112:115], a[80:83], v[128:131]
    buffer_load_dwordx4 v233, s[40:43], s80 offen offset:2048 lds
    v_mfma_f32_16x16x32_bf16 v[156:159], a[112:115], a[84:87], v[156:159]
    buffer_load_dwordx4 v234, s[40:43], s80 offen offset:3072 lds
    v_mfma_f32_16x16x32_bf16 v[184:187], a[112:115], a[88:91], v[184:187]
    v_fma_f32 v247, -v246, v246, v247
    v_mfma_f32_16x16x32_bf16 v[212:215], a[112:115], a[92:95], v[212:215]
    v_mfma_f32_16x16x32_bf16 a[124:127], a[112:115], a[144:147], a[124:127]
    v_max_f32_e64 v247, 0, v247
    v_mfma_f32_16x16x32_bf16 v[216:219], a[116:119], a[92:95], v[216:219]
    v_cvt_pk_bf16_f32 v246, v246, v246
    v_mfma_f32_16x16x32_bf16 v[188:191], a[116:119], a[88:91], v[188:191]
    v_cvt_pk_bf16_f32 v247, v247, v247
    v_mfma_f32_16x16x32_bf16 v[160:163], a[116:119], a[84:87], v[160:163]
    v_lshlrev_b32_e64 v246, 16, v246
    v_mfma_f32_16x16x32_bf16 v[132:135], a[116:119], a[80:83], v[132:135]
    v_mfma_f32_16x16x32_bf16 v[104:107], a[116:119], a[76:79], v[104:107]
    v_lshlrev_b32_e64 v247, 16, v247
    v_mfma_f32_16x16x32_bf16 v[76:79], a[116:119], a[72:75], v[76:79]
    v_add_f32 v247, 0x3727c5ac, v247
    v_mfma_f32_16x16x32_bf16 v[48:51], a[116:119], a[68:71], v[48:51]
    v_cvt_pk_bf16_f32 v247, v247, v247
    v_mfma_f32_16x16x32_bf16 v[20:23], a[116:119], a[64:67], v[20:23]
    v_lshlrev_b32_e64 v247, 16, v247
    v_mfma_f32_16x16x32_bf16 a[124:127], a[116:119], a[148:151], a[124:127]
    v_mfma_f32_16x16x32_bf16 v[24:27], a[120:123], a[64:67], v[24:27]
    v_sqrt_f32_e64 v247, v247
    v_mfma_f32_16x16x32_bf16 v[52:55], a[120:123], a[68:71], v[52:55]
    v_xor_b32 v246, 0x80000000, v246
    v_mfma_f32_16x16x32_bf16 v[80:83], a[120:123], a[72:75], v[80:83]
    v_cvt_pk_bf16_f32 v247, v247, v247
    v_mfma_f32_16x16x32_bf16 v[108:111], a[120:123], a[76:79], v[108:111]
    v_lshlrev_b32_e64 v247, 16, v247
    v_mfma_f32_16x16x32_bf16 v[136:139], a[120:123], a[80:83], v[136:139]
    v_mfma_f32_16x16x32_bf16 v[164:167], a[120:123], a[84:87], v[164:167]
    v_rcp_f32_e64 v247, v247
    v_mfma_f32_16x16x32_bf16 v[192:195], a[120:123], a[88:91], v[192:195]
    s_mov_b32 s71, 2
    v_mfma_f32_16x16x32_bf16 v[220:223], a[120:123], a[92:95], v[220:223]
    buffer_load_dword v244, off, s[52:55], 0 sc1
    v_mfma_f32_16x16x32_bf16 a[124:127], a[120:123], a[152:155], a[124:127]
    s_waitcnt vmcnt(16) lgkmcnt(0)
    s_barrier
    buffer_store_dwordx2 v[246:247], v248, s[36:39], s82 offen sc1
    s_nop 4
    buffer_store_dwordx4 a[124:127], v243, s[36:39], s81 offen sc1
.p2align 6
G1_ffn_loop:
    v_mfma_f32_16x16x32_bf16 v[0:3], a[32:35], a[0:3], v[0:3]
    ds_read_b64_tr_b16 a[96:97], v228 offset:16384
    v_mfma_f32_16x16x32_bf16 v[28:31], a[32:35], a[4:7], v[28:31]
    ds_read_b64_tr_b16 a[98:99], v228 offset:18176
    v_mfma_f32_16x16x32_bf16 v[56:59], a[32:35], a[8:11], v[56:59]
    ds_read_b128 a[64:67], v227 offset:0
    v_mfma_f32_16x16x32_bf16 v[84:87], a[32:35], a[12:15], v[84:87]
    ds_read_b64_tr_b16 a[100:101], v229 offset:16416
    v_mfma_f32_16x16x32_bf16 v[112:115], a[32:35], a[16:19], v[112:115]
    s_add_u32 m0, s70, 0
    v_mfma_f32_16x16x32_bf16 v[140:143], a[32:35], a[20:23], v[140:143]
    s_add_u32 s67, s67, 229376
    v_mfma_f32_16x16x32_bf16 v[168:171], a[32:35], a[24:27], v[168:171]
    v_mfma_f32_16x16x32_bf16 v[196:199], a[32:35], a[28:31], v[196:199]
    s_cmp_eq_u32 s67, 7340032
    v_mfma_f32_16x16x32_bf16 v[200:203], a[36:39], a[28:31], v[200:203]
    s_cselect_b32 s67, 917504, s67
    v_mfma_f32_16x16x32_bf16 v[172:175], a[36:39], a[24:27], v[172:175]
    buffer_load_dwordx4 v235, s[44:47], s67 offen lds
    v_mfma_f32_16x16x32_bf16 v[144:147], a[36:39], a[20:23], v[144:147]
    ds_read_b64_tr_b16 a[102:103], v229 offset:18208
    v_mfma_f32_16x16x32_bf16 v[116:119], a[36:39], a[16:19], v[116:119]
    ds_read_b128 a[68:71], v227 offset:2048
    v_mfma_f32_16x16x32_bf16 v[88:91], a[36:39], a[12:15], v[88:91]
    v_mfma_f32_16x16x32_bf16 v[60:63], a[36:39], a[8:11], v[60:63]
    ds_read_b64_tr_b16 a[104:105], v228 offset:16448
    v_mfma_f32_16x16x32_bf16 v[32:35], a[36:39], a[4:7], v[32:35]
    ds_read_b64_tr_b16 a[106:107], v228 offset:18240
    v_mfma_f32_16x16x32_bf16 v[4:7], a[36:39], a[0:3], v[4:7]
    buffer_load_dwordx4 v236, s[44:47], s67 offen offset:1024 lds
    v_mfma_f32_16x16x32_bf16 v[8:11], a[40:43], a[0:3], v[8:11]
    ds_read_b128 a[72:75], v227 offset:4096
    v_mfma_f32_16x16x32_bf16 v[36:39], a[40:43], a[4:7], v[36:39]
    ds_read_b64_tr_b16 a[108:109], v229 offset:16480
    v_mfma_f32_16x16x32_bf16 v[64:67], a[40:43], a[8:11], v[64:67]
    v_mfma_f32_16x16x32_bf16 v[92:95], a[40:43], a[12:15], v[92:95]
    ds_read_b64_tr_b16 a[110:111], v229 offset:18272
    v_mfma_f32_16x16x32_bf16 v[120:123], a[40:43], a[16:19], v[120:123]
    ds_read_b128 a[76:79], v227 offset:6144
    v_mfma_f32_16x16x32_bf16 v[148:151], a[40:43], a[20:23], v[148:151]
    buffer_load_dwordx4 v237, s[44:47], s67 offen offset:2048 lds
    v_mfma_f32_16x16x32_bf16 v[176:179], a[40:43], a[24:27], v[176:179]
    ds_read_b64_tr_b16 a[112:113], v228 offset:16512
    v_mfma_f32_16x16x32_bf16 v[204:207], a[40:43], a[28:31], v[204:207]
    ds_read_b64_tr_b16 a[114:115], v228 offset:18304
    v_mfma_f32_16x16x32_bf16 v[208:211], a[44:47], a[28:31], v[208:211]
    v_mfma_f32_16x16x32_bf16 v[180:183], a[44:47], a[24:27], v[180:183]
    ds_read_b128 a[80:83], v227 offset:8192
    v_mfma_f32_16x16x32_bf16 v[152:155], a[44:47], a[20:23], v[152:155]
    ds_read_b64_tr_b16 a[116:117], v229 offset:16544
    v_mfma_f32_16x16x32_bf16 v[124:127], a[44:47], a[16:19], v[124:127]
    buffer_load_dwordx4 v238, s[44:47], s67 offen offset:3072 lds
    v_mfma_f32_16x16x32_bf16 v[96:99], a[44:47], a[12:15], v[96:99]
    ds_read_b64_tr_b16 a[118:119], v229 offset:18336
    v_mfma_f32_16x16x32_bf16 v[68:71], a[44:47], a[8:11], v[68:71]
    ds_read_b128 a[84:87], v227 offset:10240
    v_mfma_f32_16x16x32_bf16 v[40:43], a[44:47], a[4:7], v[40:43]
    ds_read_b64_tr_b16 a[120:121], v230 offset:16384
    v_mfma_f32_16x16x32_bf16 v[12:15], a[44:47], a[0:3], v[12:15]
    v_mfma_f32_16x16x32_bf16 v[16:19], a[48:51], a[0:3], v[16:19]
    ds_read_b64_tr_b16 a[122:123], v230 offset:18176
    v_mfma_f32_16x16x32_bf16 v[44:47], a[48:51], a[4:7], v[44:47]
    s_add_u32 m0, s69, s72
    v_mfma_f32_16x16x32_bf16 v[72:75], a[48:51], a[8:11], v[72:75]
    s_add_u32 s80, s65, s66
    v_mfma_f32_16x16x32_bf16 v[100:103], a[48:51], a[12:15], v[100:103]
    buffer_load_dwordx4 v231, s[40:43], s80 offen lds
    v_mfma_f32_16x16x32_bf16 v[128:131], a[48:51], a[16:19], v[128:131]
    ds_read_b128 a[88:91], v227 offset:12288
    v_mfma_f32_16x16x32_bf16 v[156:159], a[48:51], a[20:23], v[156:159]
    v_mfma_f32_16x16x32_bf16 v[184:187], a[48:51], a[24:27], v[184:187]
    ds_read_b128 a[92:95], v227 offset:14336
    v_mfma_f32_16x16x32_bf16 v[212:215], a[48:51], a[28:31], v[212:215]
    buffer_load_dwordx4 v232, s[40:43], s80 offen offset:1024 lds
    v_mfma_f32_16x16x32_bf16 v[216:219], a[52:55], a[28:31], v[216:219]
    buffer_load_dwordx4 v233, s[40:43], s80 offen offset:2048 lds
    v_mfma_f32_16x16x32_bf16 v[188:191], a[52:55], a[24:27], v[188:191]
    s_add_u32 s72, s72, 0x8000
    v_mfma_f32_16x16x32_bf16 v[160:163], a[52:55], a[20:23], v[160:163]
    s_cmp_eq_u32 s72, 0x18000
    v_mfma_f32_16x16x32_bf16 v[132:135], a[52:55], a[16:19], v[132:135]
    v_mfma_f32_16x16x32_bf16 v[104:107], a[52:55], a[12:15], v[104:107]
    s_cselect_b32 s72, 0, s72
    v_mfma_f32_16x16x32_bf16 v[76:79], a[52:55], a[8:11], v[76:79]
    buffer_load_dwordx4 v234, s[40:43], s80 offen offset:3072 lds
    v_mfma_f32_16x16x32_bf16 v[48:51], a[52:55], a[4:7], v[48:51]
    s_add_u32 s66, s66, 128
    v_mfma_f32_16x16x32_bf16 v[20:23], a[52:55], a[0:3], v[20:23]
    s_cmp_eq_u32 s66, 2048
    v_mfma_f32_16x16x32_bf16 v[24:27], a[56:59], a[0:3], v[24:27]
    s_cselect_b32 s66, 256, s66
    v_mfma_f32_16x16x32_bf16 v[52:55], a[56:59], a[4:7], v[52:55]
    v_mfma_f32_16x16x32_bf16 v[80:83], a[56:59], a[8:11], v[80:83]
    s_add_u32 s73, s73, 0x8000
    v_mfma_f32_16x16x32_bf16 v[108:111], a[56:59], a[12:15], v[108:111]
    s_cmp_eq_u32 s73, 0x18000
    v_mfma_f32_16x16x32_bf16 v[136:139], a[56:59], a[16:19], v[136:139]
    s_cselect_b32 s73, 0, s73
    v_mfma_f32_16x16x32_bf16 v[164:167], a[56:59], a[20:23], v[164:167]
    v_add_u32 v226, s73, v224
    v_mfma_f32_16x16x32_bf16 v[192:195], a[56:59], a[24:27], v[192:195]
    v_add_u32_e64 v227, s73, v225
    v_mfma_f32_16x16x32_bf16 v[220:223], a[56:59], a[28:31], v[220:223]
    s_waitcnt vmcnt(16) lgkmcnt(0)
    s_barrier
    v_mfma_f32_16x16x32_bf16 v[0:3], a[96:99], a[64:67], v[0:3]
    ds_read_b64_tr_b16 a[32:33], v228 offset:32768
    v_mfma_f32_16x16x32_bf16 v[28:31], a[96:99], a[68:71], v[28:31]
    ds_read_b64_tr_b16 a[34:35], v228 offset:34560
    v_mfma_f32_16x16x32_bf16 v[56:59], a[96:99], a[72:75], v[56:59]
    v_mfma_f32_16x16x32_bf16 v[84:87], a[96:99], a[76:79], v[84:87]
    ds_read_b128 a[0:3], v226 offset:0
    v_mfma_f32_16x16x32_bf16 v[112:115], a[96:99], a[80:83], v[112:115]
    ds_read_b64_tr_b16 a[36:37], v229 offset:32800
    v_mfma_f32_16x16x32_bf16 v[140:143], a[96:99], a[84:87], v[140:143]
    v_mfma_f32_16x16x32_bf16 v[168:171], a[96:99], a[88:91], v[168:171]
    s_add_u32 m0, s70, 16384
    v_mfma_f32_16x16x32_bf16 v[196:199], a[96:99], a[92:95], v[196:199]
    v_mfma_f32_16x16x32_bf16 v[200:203], a[100:103], a[92:95], v[200:203]
    s_add_u32 s67, s67, 229376
    v_mfma_f32_16x16x32_bf16 v[172:175], a[100:103], a[88:91], v[172:175]
    buffer_load_dwordx4 v235, s[44:47], s67 offen lds
    v_mfma_f32_16x16x32_bf16 v[144:147], a[100:103], a[84:87], v[144:147]
    v_mfma_f32_16x16x32_bf16 v[116:119], a[100:103], a[80:83], v[116:119]
    ds_read_b64_tr_b16 a[38:39], v229 offset:34592
    v_mfma_f32_16x16x32_bf16 v[88:91], a[100:103], a[76:79], v[88:91]
    v_mfma_f32_16x16x32_bf16 v[60:63], a[100:103], a[72:75], v[60:63]
    ds_read_b128 a[4:7], v226 offset:2048
    v_mfma_f32_16x16x32_bf16 v[32:35], a[100:103], a[68:71], v[32:35]
    ds_read_b64_tr_b16 a[40:41], v228 offset:32832
    v_mfma_f32_16x16x32_bf16 v[4:7], a[100:103], a[64:67], v[4:7]
    v_mfma_f32_16x16x32_bf16 v[8:11], a[104:107], a[64:67], v[8:11]
    ds_read_b64_tr_b16 a[42:43], v228 offset:34624
    v_mfma_f32_16x16x32_bf16 v[36:39], a[104:107], a[68:71], v[36:39]
    v_mfma_f32_16x16x32_bf16 v[64:67], a[104:107], a[72:75], v[64:67]
    buffer_load_dwordx4 v236, s[44:47], s67 offen offset:1024 lds
    v_mfma_f32_16x16x32_bf16 v[92:95], a[104:107], a[76:79], v[92:95]
    ds_read_b128 a[8:11], v226 offset:4096
    v_mfma_f32_16x16x32_bf16 v[120:123], a[104:107], a[80:83], v[120:123]
    v_mfma_f32_16x16x32_bf16 v[148:151], a[104:107], a[84:87], v[148:151]
    ds_read_b64_tr_b16 a[44:45], v229 offset:32864
    v_mfma_f32_16x16x32_bf16 v[176:179], a[104:107], a[88:91], v[176:179]
    v_mfma_f32_16x16x32_bf16 v[204:207], a[104:107], a[92:95], v[204:207]
    ds_read_b64_tr_b16 a[46:47], v229 offset:34656
    v_mfma_f32_16x16x32_bf16 v[208:211], a[108:111], a[92:95], v[208:211]
    ds_read_b128 a[12:15], v226 offset:6144
    v_mfma_f32_16x16x32_bf16 v[180:183], a[108:111], a[88:91], v[180:183]
    v_mfma_f32_16x16x32_bf16 v[152:155], a[108:111], a[84:87], v[152:155]
    buffer_load_dwordx4 v237, s[44:47], s67 offen offset:2048 lds
    v_mfma_f32_16x16x32_bf16 v[124:127], a[108:111], a[80:83], v[124:127]
    v_mfma_f32_16x16x32_bf16 v[96:99], a[108:111], a[76:79], v[96:99]
    ds_read_b64_tr_b16 a[48:49], v228 offset:32896
    v_mfma_f32_16x16x32_bf16 v[68:71], a[108:111], a[72:75], v[68:71]
    ds_read_b64_tr_b16 a[50:51], v228 offset:34688
    v_mfma_f32_16x16x32_bf16 v[40:43], a[108:111], a[68:71], v[40:43]
    v_mfma_f32_16x16x32_bf16 v[12:15], a[108:111], a[64:67], v[12:15]
    ds_read_b128 a[16:19], v226 offset:8192
    v_mfma_f32_16x16x32_bf16 v[16:19], a[112:115], a[64:67], v[16:19]
    ds_read_b64_tr_b16 a[52:53], v229 offset:32928
    v_mfma_f32_16x16x32_bf16 v[44:47], a[112:115], a[68:71], v[44:47]
    v_mfma_f32_16x16x32_bf16 v[72:75], a[112:115], a[72:75], v[72:75]
    buffer_load_dwordx4 v238, s[44:47], s67 offen offset:3072 lds
    v_mfma_f32_16x16x32_bf16 v[100:103], a[112:115], a[76:79], v[100:103]
    v_mfma_f32_16x16x32_bf16 v[128:131], a[112:115], a[80:83], v[128:131]
    ds_read_b64_tr_b16 a[54:55], v229 offset:34720
    v_mfma_f32_16x16x32_bf16 v[156:159], a[112:115], a[84:87], v[156:159]
    ds_read_b128 a[20:23], v226 offset:10240
    v_mfma_f32_16x16x32_bf16 v[184:187], a[112:115], a[88:91], v[184:187]
    v_mfma_f32_16x16x32_bf16 v[212:215], a[112:115], a[92:95], v[212:215]
    ds_read_b64_tr_b16 a[56:57], v230 offset:32768
    v_mfma_f32_16x16x32_bf16 v[216:219], a[116:119], a[92:95], v[216:219]
    v_mfma_f32_16x16x32_bf16 v[188:191], a[116:119], a[88:91], v[188:191]
    ds_read_b64_tr_b16 a[58:59], v230 offset:34560
    v_mfma_f32_16x16x32_bf16 v[160:163], a[116:119], a[84:87], v[160:163]
    s_add_u32 m0, s68, s72
    v_mfma_f32_16x16x32_bf16 v[132:135], a[116:119], a[80:83], v[132:135]
    v_mfma_f32_16x16x32_bf16 v[104:107], a[116:119], a[76:79], v[104:107]
    s_add_u32 s80, s64, s66
    v_mfma_f32_16x16x32_bf16 v[76:79], a[116:119], a[72:75], v[76:79]
    v_mfma_f32_16x16x32_bf16 v[48:51], a[116:119], a[68:71], v[48:51]
    buffer_load_dwordx4 v231, s[40:43], s80 offen lds
    v_mfma_f32_16x16x32_bf16 v[20:23], a[116:119], a[64:67], v[20:23]
    ds_read_b128 a[24:27], v226 offset:12288
    v_mfma_f32_16x16x32_bf16 v[24:27], a[120:123], a[64:67], v[24:27]
    v_mfma_f32_16x16x32_bf16 v[52:55], a[120:123], a[68:71], v[52:55]
    ds_read_b128 a[28:31], v226 offset:14336
    v_mfma_f32_16x16x32_bf16 v[80:83], a[120:123], a[72:75], v[80:83]
    v_mfma_f32_16x16x32_bf16 v[108:111], a[120:123], a[76:79], v[108:111]
    buffer_load_dwordx4 v232, s[40:43], s80 offen offset:1024 lds
    v_mfma_f32_16x16x32_bf16 v[136:139], a[120:123], a[80:83], v[136:139]
    buffer_load_dwordx4 v233, s[40:43], s80 offen offset:2048 lds
    v_mfma_f32_16x16x32_bf16 v[164:167], a[120:123], a[84:87], v[164:167]
    v_mfma_f32_16x16x32_bf16 v[192:195], a[120:123], a[88:91], v[192:195]
    buffer_load_dwordx4 v234, s[40:43], s80 offen offset:3072 lds
    v_mfma_f32_16x16x32_bf16 v[220:223], a[120:123], a[92:95], v[220:223]
    s_waitcnt vmcnt(16) lgkmcnt(0)
    s_barrier
    v_mfma_f32_16x16x32_bf16 v[0:3], a[32:35], a[0:3], v[0:3]
    ds_read_b64_tr_b16 a[96:97], v228 offset:49152
    v_mfma_f32_16x16x32_bf16 v[28:31], a[32:35], a[4:7], v[28:31]
    ds_read_b64_tr_b16 a[98:99], v228 offset:50944
    v_mfma_f32_16x16x32_bf16 v[56:59], a[32:35], a[8:11], v[56:59]
    ds_read_b128 a[64:67], v227 offset:0
    v_mfma_f32_16x16x32_bf16 v[84:87], a[32:35], a[12:15], v[84:87]
    ds_read_b64_tr_b16 a[100:101], v229 offset:49184
    v_mfma_f32_16x16x32_bf16 v[112:115], a[32:35], a[16:19], v[112:115]
    s_add_u32 m0, s70, 32768
    v_mfma_f32_16x16x32_bf16 v[140:143], a[32:35], a[20:23], v[140:143]
    v_mfma_f32_16x16x32_bf16 v[168:171], a[32:35], a[24:27], v[168:171]
    s_add_u32 s67, s67, 229376
    v_mfma_f32_16x16x32_bf16 v[196:199], a[32:35], a[28:31], v[196:199]
    buffer_load_dwordx4 v235, s[44:47], s67 offen lds
    v_mfma_f32_16x16x32_bf16 v[200:203], a[36:39], a[28:31], v[200:203]
    ds_read_b64_tr_b16 a[102:103], v229 offset:50976
    v_mfma_f32_16x16x32_bf16 v[172:175], a[36:39], a[24:27], v[172:175]
    ds_read_b128 a[68:71], v227 offset:2048
    v_mfma_f32_16x16x32_bf16 v[144:147], a[36:39], a[20:23], v[144:147]
    v_mfma_f32_16x16x32_bf16 v[116:119], a[36:39], a[16:19], v[116:119]
    ds_read_b64_tr_b16 a[104:105], v228 offset:49216
    v_mfma_f32_16x16x32_bf16 v[88:91], a[36:39], a[12:15], v[88:91]
    ds_read_b64_tr_b16 a[106:107], v228 offset:51008
    v_mfma_f32_16x16x32_bf16 v[60:63], a[36:39], a[8:11], v[60:63]
    buffer_load_dwordx4 v236, s[44:47], s67 offen offset:1024 lds
    v_mfma_f32_16x16x32_bf16 v[32:35], a[36:39], a[4:7], v[32:35]
    ds_read_b128 a[72:75], v227 offset:4096
    v_mfma_f32_16x16x32_bf16 v[4:7], a[36:39], a[0:3], v[4:7]
    v_mfma_f32_16x16x32_bf16 v[8:11], a[40:43], a[0:3], v[8:11]
    ds_read_b64_tr_b16 a[108:109], v229 offset:49248
    v_mfma_f32_16x16x32_bf16 v[36:39], a[40:43], a[4:7], v[36:39]
    ds_read_b64_tr_b16 a[110:111], v229 offset:51040
    v_mfma_f32_16x16x32_bf16 v[64:67], a[40:43], a[8:11], v[64:67]
    ds_read_b128 a[76:79], v227 offset:6144
    v_mfma_f32_16x16x32_bf16 v[92:95], a[40:43], a[12:15], v[92:95]
    buffer_load_dwordx4 v237, s[44:47], s67 offen offset:2048 lds
    v_mfma_f32_16x16x32_bf16 v[120:123], a[40:43], a[16:19], v[120:123]
    v_mfma_f32_16x16x32_bf16 v[148:151], a[40:43], a[20:23], v[148:151]
    ds_read_b64_tr_b16 a[112:113], v228 offset:49280
    v_mfma_f32_16x16x32_bf16 v[176:179], a[40:43], a[24:27], v[176:179]
    ds_read_b64_tr_b16 a[114:115], v228 offset:51072
    v_mfma_f32_16x16x32_bf16 v[204:207], a[40:43], a[28:31], v[204:207]
    ds_read_b128 a[80:83], v227 offset:8192
    v_mfma_f32_16x16x32_bf16 v[208:211], a[44:47], a[28:31], v[208:211]
    ds_read_b64_tr_b16 a[116:117], v229 offset:49312
    v_mfma_f32_16x16x32_bf16 v[180:183], a[44:47], a[24:27], v[180:183]
    v_mfma_f32_16x16x32_bf16 v[152:155], a[44:47], a[20:23], v[152:155]
    buffer_load_dwordx4 v238, s[44:47], s67 offen offset:3072 lds
    v_mfma_f32_16x16x32_bf16 v[124:127], a[44:47], a[16:19], v[124:127]
    ds_read_b64_tr_b16 a[118:119], v229 offset:51104
    v_mfma_f32_16x16x32_bf16 v[96:99], a[44:47], a[12:15], v[96:99]
    ds_read_b128 a[84:87], v227 offset:10240
    v_mfma_f32_16x16x32_bf16 v[68:71], a[44:47], a[8:11], v[68:71]
    ds_read_b64_tr_b16 a[120:121], v230 offset:49152
    v_mfma_f32_16x16x32_bf16 v[40:43], a[44:47], a[4:7], v[40:43]
    v_mfma_f32_16x16x32_bf16 v[12:15], a[44:47], a[0:3], v[12:15]
    ds_read_b64_tr_b16 a[122:123], v230 offset:50944
    v_mfma_f32_16x16x32_bf16 v[16:19], a[48:51], a[0:3], v[16:19]
    s_add_u32 m0, s69, s72
    v_mfma_f32_16x16x32_bf16 v[44:47], a[48:51], a[4:7], v[44:47]
    s_add_u32 s80, s65, s66
    v_mfma_f32_16x16x32_bf16 v[72:75], a[48:51], a[8:11], v[72:75]
    buffer_load_dwordx4 v231, s[40:43], s80 offen lds
    v_mfma_f32_16x16x32_bf16 v[100:103], a[48:51], a[12:15], v[100:103]
    v_mfma_f32_16x16x32_bf16 v[128:131], a[48:51], a[16:19], v[128:131]
    ds_read_b128 a[88:91], v227 offset:12288
    v_mfma_f32_16x16x32_bf16 v[156:159], a[48:51], a[20:23], v[156:159]
    ds_read_b128 a[92:95], v227 offset:14336
    v_mfma_f32_16x16x32_bf16 v[184:187], a[48:51], a[24:27], v[184:187]
    buffer_load_dwordx4 v232, s[40:43], s80 offen offset:1024 lds
    v_mfma_f32_16x16x32_bf16 v[212:215], a[48:51], a[28:31], v[212:215]
    buffer_load_dwordx4 v233, s[40:43], s80 offen offset:2048 lds
    v_mfma_f32_16x16x32_bf16 v[216:219], a[52:55], a[28:31], v[216:219]
    v_mfma_f32_16x16x32_bf16 v[188:191], a[52:55], a[24:27], v[188:191]
    s_add_u32 s72, s72, 0x8000
    v_mfma_f32_16x16x32_bf16 v[160:163], a[52:55], a[20:23], v[160:163]
    s_cmp_eq_u32 s72, 0x18000
    v_mfma_f32_16x16x32_bf16 v[132:135], a[52:55], a[16:19], v[132:135]
    s_cselect_b32 s72, 0, s72
    v_mfma_f32_16x16x32_bf16 v[104:107], a[52:55], a[12:15], v[104:107]
    buffer_load_dwordx4 v234, s[40:43], s80 offen offset:3072 lds
    v_mfma_f32_16x16x32_bf16 v[76:79], a[52:55], a[8:11], v[76:79]
    v_mfma_f32_16x16x32_bf16 v[48:51], a[52:55], a[4:7], v[48:51]
    s_add_u32 s66, s66, 128
    v_mfma_f32_16x16x32_bf16 v[20:23], a[52:55], a[0:3], v[20:23]
    s_cmp_eq_u32 s66, 2048
    v_mfma_f32_16x16x32_bf16 v[24:27], a[56:59], a[0:3], v[24:27]
    s_cselect_b32 s66, 256, s66
    v_mfma_f32_16x16x32_bf16 v[52:55], a[56:59], a[4:7], v[52:55]
    s_add_u32 s73, s73, 0x8000
    v_mfma_f32_16x16x32_bf16 v[80:83], a[56:59], a[8:11], v[80:83]
    v_mfma_f32_16x16x32_bf16 v[108:111], a[56:59], a[12:15], v[108:111]
    s_cmp_eq_u32 s73, 0x18000
    v_mfma_f32_16x16x32_bf16 v[136:139], a[56:59], a[16:19], v[136:139]
    s_cselect_b32 s73, 0, s73
    v_mfma_f32_16x16x32_bf16 v[164:167], a[56:59], a[20:23], v[164:167]
    v_add_u32_e64 v226, s73, v224
    v_mfma_f32_16x16x32_bf16 v[192:195], a[56:59], a[24:27], v[192:195]
    v_add_u32_e64 v227, s73, v225
    v_mfma_f32_16x16x32_bf16 v[220:223], a[56:59], a[28:31], v[220:223]
    s_waitcnt vmcnt(16) lgkmcnt(0)
    s_barrier
    v_mfma_f32_16x16x32_bf16 v[0:3], a[96:99], a[64:67], v[0:3]
    ds_read_b64_tr_b16 a[32:33], v228 offset:0
    v_mfma_f32_16x16x32_bf16 v[28:31], a[96:99], a[68:71], v[28:31]
    ds_read_b64_tr_b16 a[34:35], v228 offset:1792
    v_mfma_f32_16x16x32_bf16 v[56:59], a[96:99], a[72:75], v[56:59]
    v_mfma_f32_16x16x32_bf16 v[84:87], a[96:99], a[76:79], v[84:87]
    ds_read_b128 a[0:3], v226 offset:0
    v_mfma_f32_16x16x32_bf16 v[112:115], a[96:99], a[80:83], v[112:115]
    ds_read_b64_tr_b16 a[36:37], v229 offset:32
    v_mfma_f32_16x16x32_bf16 v[140:143], a[96:99], a[84:87], v[140:143]
    v_mfma_f32_16x16x32_bf16 v[168:171], a[96:99], a[88:91], v[168:171]
    s_add_u32 m0, s70, 49152
    v_mfma_f32_16x16x32_bf16 v[196:199], a[96:99], a[92:95], v[196:199]
    s_add_u32 s67, s67, 229376
    v_mfma_f32_16x16x32_bf16 v[200:203], a[100:103], a[92:95], v[200:203]
    v_mfma_f32_16x16x32_bf16 v[172:175], a[100:103], a[88:91], v[172:175]
    buffer_load_dwordx4 v235, s[44:47], s67 offen lds
    v_mfma_f32_16x16x32_bf16 v[144:147], a[100:103], a[84:87], v[144:147]
    ds_read_b64_tr_b16 a[38:39], v229 offset:1824
    v_mfma_f32_16x16x32_bf16 v[116:119], a[100:103], a[80:83], v[116:119]
    v_mfma_f32_16x16x32_bf16 v[88:91], a[100:103], a[76:79], v[88:91]
    ds_read_b128 a[4:7], v226 offset:2048
    v_mfma_f32_16x16x32_bf16 v[60:63], a[100:103], a[72:75], v[60:63]
    v_mfma_f32_16x16x32_bf16 v[32:35], a[100:103], a[68:71], v[32:35]
    ds_read_b64_tr_b16 a[40:41], v228 offset:64
    v_mfma_f32_16x16x32_bf16 v[4:7], a[100:103], a[64:67], v[4:7]
    ds_read_b64_tr_b16 a[42:43], v228 offset:1856
    v_mfma_f32_16x16x32_bf16 v[8:11], a[104:107], a[64:67], v[8:11]
    v_mfma_f32_16x16x32_bf16 v[36:39], a[104:107], a[68:71], v[36:39]
    buffer_load_dwordx4 v236, s[44:47], s67 offen offset:1024 lds
    v_mfma_f32_16x16x32_bf16 v[64:67], a[104:107], a[72:75], v[64:67]
    ds_read_b128 a[8:11], v226 offset:4096
    v_mfma_f32_16x16x32_bf16 v[92:95], a[104:107], a[76:79], v[92:95]
    v_mfma_f32_16x16x32_bf16 v[120:123], a[104:107], a[80:83], v[120:123]
    ds_read_b64_tr_b16 a[44:45], v229 offset:96
    v_mfma_f32_16x16x32_bf16 v[148:151], a[104:107], a[84:87], v[148:151]
    ds_read_b64_tr_b16 a[46:47], v229 offset:1888
    v_mfma_f32_16x16x32_bf16 v[176:179], a[104:107], a[88:91], v[176:179]
    v_mfma_f32_16x16x32_bf16 v[204:207], a[104:107], a[92:95], v[204:207]
    ds_read_b128 a[12:15], v226 offset:6144
    v_mfma_f32_16x16x32_bf16 v[208:211], a[108:111], a[92:95], v[208:211]
    buffer_load_dwordx4 v237, s[44:47], s67 offen offset:2048 lds
    v_mfma_f32_16x16x32_bf16 v[180:183], a[108:111], a[88:91], v[180:183]
    v_mfma_f32_16x16x32_bf16 v[152:155], a[108:111], a[84:87], v[152:155]
    ds_read_b64_tr_b16 a[48:49], v228 offset:128
    v_mfma_f32_16x16x32_bf16 v[124:127], a[108:111], a[80:83], v[124:127]
    v_mfma_f32_16x16x32_bf16 v[96:99], a[108:111], a[76:79], v[96:99]
    ds_read_b64_tr_b16 a[50:51], v228 offset:1920
    v_mfma_f32_16x16x32_bf16 v[68:71], a[108:111], a[72:75], v[68:71]
    ds_read_b128 a[16:19], v226 offset:8192
    v_mfma_f32_16x16x32_bf16 v[40:43], a[108:111], a[68:71], v[40:43]
    v_mfma_f32_16x16x32_bf16 v[12:15], a[108:111], a[64:67], v[12:15]
    ds_read_b64_tr_b16 a[52:53], v229 offset:160
    v_mfma_f32_16x16x32_bf16 v[16:19], a[112:115], a[64:67], v[16:19]
    buffer_load_dwordx4 v238, s[44:47], s67 offen offset:3072 lds
    v_mfma_f32_16x16x32_bf16 v[44:47], a[112:115], a[68:71], v[44:47]
    v_mfma_f32_16x16x32_bf16 v[72:75], a[112:115], a[72:75], v[72:75]
    ds_read_b64_tr_b16 a[54:55], v229 offset:1952
    v_mfma_f32_16x16x32_bf16 v[100:103], a[112:115], a[76:79], v[100:103]
    ds_read_b128 a[20:23], v226 offset:10240
    v_mfma_f32_16x16x32_bf16 v[128:131], a[112:115], a[80:83], v[128:131]
    v_mfma_f32_16x16x32_bf16 v[156:159], a[112:115], a[84:87], v[156:159]
    ds_read_b64_tr_b16 a[56:57], v230 offset:0
    v_mfma_f32_16x16x32_bf16 v[184:187], a[112:115], a[88:91], v[184:187]
    ds_read_b64_tr_b16 a[58:59], v230 offset:1792
    v_mfma_f32_16x16x32_bf16 v[212:215], a[112:115], a[92:95], v[212:215]
    v_mfma_f32_16x16x32_bf16 v[216:219], a[116:119], a[92:95], v[216:219]
    s_add_u32 m0, s68, s72
    v_mfma_f32_16x16x32_bf16 v[188:191], a[116:119], a[88:91], v[188:191]
    v_mfma_f32_16x16x32_bf16 v[160:163], a[116:119], a[84:87], v[160:163]
    s_add_u32 s80, s64, s66
    v_mfma_f32_16x16x32_bf16 v[132:135], a[116:119], a[80:83], v[132:135]
    buffer_load_dwordx4 v231, s[40:43], s80 offen lds
    v_mfma_f32_16x16x32_bf16 v[104:107], a[116:119], a[76:79], v[104:107]
    v_mfma_f32_16x16x32_bf16 v[76:79], a[116:119], a[72:75], v[76:79]
    ds_read_b128 a[24:27], v226 offset:12288
    v_mfma_f32_16x16x32_bf16 v[48:51], a[116:119], a[68:71], v[48:51]
    ds_read_b128 a[28:31], v226 offset:14336
    v_mfma_f32_16x16x32_bf16 v[20:23], a[116:119], a[64:67], v[20:23]
    v_mfma_f32_16x16x32_bf16 v[24:27], a[120:123], a[64:67], v[24:27]
    buffer_load_dwordx4 v232, s[40:43], s80 offen offset:1024 lds
    v_mfma_f32_16x16x32_bf16 v[52:55], a[120:123], a[68:71], v[52:55]
    buffer_load_dwordx4 v233, s[40:43], s80 offen offset:2048 lds
    v_mfma_f32_16x16x32_bf16 v[80:83], a[120:123], a[72:75], v[80:83]
    v_mfma_f32_16x16x32_bf16 v[108:111], a[120:123], a[76:79], v[108:111]
    buffer_load_dwordx4 v234, s[40:43], s80 offen offset:3072 lds
    v_mfma_f32_16x16x32_bf16 v[136:139], a[120:123], a[80:83], v[136:139]
    s_add_u32 s71, s71, 1
    v_mfma_f32_16x16x32_bf16 v[164:167], a[120:123], a[84:87], v[164:167]
    v_mfma_f32_16x16x32_bf16 v[192:195], a[120:123], a[88:91], v[192:195]
    s_bitcmp1_b32 16, s71
    v_mfma_f32_16x16x32_bf16 v[220:223], a[120:123], a[92:95], v[220:223]
    s_waitcnt vmcnt(16) lgkmcnt(0)
    s_barrier
    s_cbranch_scc1 G1_ffn_loop
    s_cmp_gt_u32 s71, 4
    s_cbranch_scc1 G1_ffn_hi
    s_branch G1_ffn_st
G1_ffn_nspin:
    buffer_load_dword v244, off, s[52:55], 0 sc1
    s_sleep 1
    s_sub_u32 s12, s12, 1
    s_cmp_gt_i32 s12, 0
    s_cbranch_scc0 G1_ffn_nok
    s_waitcnt vmcnt(0)
G1_ffn_st:
    v_readfirstlane_b32 s95, v244
    s_cmp_lg_u32 s95, 0
    s_cbranch_scc0 G1_ffn_nspin
G1_ffn_nok:
    s_cmp_lg_u32 s4, 0
    s_cbranch_scc1 G1_ffn_loop
    s_add_u32 s3, s15, 98304
    v_cmp_eq_u32 vcc, 0, v255
    v_mov_b32 v253, 0x80000000
    v_mov_b32 v252, s95
    v_cndmask_b32 v253, v253, 0, vcc
    buffer_store_dword v252, v253, s[36:39], s3 offen sc1
    s_branch G1_ffn_loop
G1_ffn_hi:
    s_cmp_eq_u32 s71, 7
    s_cbranch_scc1 G1_ffn_post
    s_cmp_lg_u32 s71, 5
    s_cbranch_scc1 G1_ffn_chk
    buffer_load_dword v244, v249, s[36:39], s75 offen sc1
    buffer_load_dword v248, v245, s[48:51], s74 offen
    s_branch G1_ffn_loop
G1_ffn_spin:
    buffer_load_dword v244, v249, s[36:39], s75 offen sc1
    s_sleep 1
    s_sub_u32 s12, s12, 1
    s_cmp_gt_i32 s12, 0
    s_cbranch_scc0 G1_ffn_arrok
    s_waitcnt vmcnt(0)
G1_ffn_chk:
    v_cmp_eq_u32 vcc, s95, v244
    s_cmp_eq_u64 vcc, -1
    s_cbranch_scc0 G1_ffn_spin
G1_ffn_arrok:
    s_lshl_b32 s3, s4, 8
    v_lshrrev_b32 v245, 2, v254
    v_add_u32 v245, s3, v245
    v_lshlrev_b32 v243, 1, v245
    s_lshl_b32 s76, s7, 11
    s_add_u32 s76, s76, 0x2800000
    s_lshl_b32 s77, s9, 13
    s_add_u32 s77, s77, 0x2830000
    s_add_u32 s78, s77, 4096
    buffer_load_dwordx2 a[128:129], v243, s[36:39], s76 offen sc1
    buffer_load_dword a130, v245, s[36:39], s77 offen offset:0 sc1
    buffer_load_dword a131, v245, s[36:39], s77 offen offset:1024 sc1
    buffer_load_dword a132, v245, s[36:39], s77 offen offset:2048 sc1
    buffer_load_dword a133, v245, s[36:39], s77 offen offset:3072 sc1
    buffer_load_dword a134, v245, s[36:39], s78 offen offset:0 sc1
    buffer_load_dword a135, v245, s[36:39], s78 offen offset:1024 sc1
    buffer_load_dword a136, v245, s[36:39], s78 offen offset:2048 sc1
    buffer_load_dword a137, v245, s[36:39], s78 offen offset:3072 sc1
    s_branch G1_ffn_loop
G1_ffn_post:
    v_mfma_f32_16x16x32_bf16 v[0:3], a[32:35], a[0:3], v[0:3]
    ds_read_b64_tr_b16 a[96:97], v228 offset:16384
    v_mfma_f32_16x16x32_bf16 v[28:31], a[32:35], a[4:7], v[28:31]
    ds_read_b64_tr_b16 a[98:99], v228 offset:18176
    v_mfma_f32_16x16x32_bf16 v[56:59], a[32:35], a[8:11], v[56:59]
    ds_read_b128 a[64:67], v227 offset:0
    v_mfma_f32_16x16x32_bf16 v[84:87], a[32:35], a[12:15], v[84:87]
    ds_read_b64_tr_b16 a[100:101], v229 offset:16416
    v_mfma_f32_16x16x32_bf16 v[112:115], a[32:35], a[16:19], v[112:115]
    v_mfma_f32_16x16x32_bf16 v[140:143], a[32:35], a[20:23], v[140:143]
    v_accvgpr_read_b32 v232, a128
    v_mfma_f32_16x16x32_bf16 v[168:171], a[32:35], a[24:27], v[168:171]
    v_accvgpr_read_b32 v233, a129
    v_mfma_f32_16x16x32_bf16 v[196:199], a[32:35], a[28:31], v[196:199]
    ds_read_b64_tr_b16 a[102:103], v229 offset:18208
    v_mfma_f32_16x16x32_bf16 v[200:203], a[36:39], a[28:31], v[200:203]
    v_mfma_f32_16x16x32_bf16 v[172:175], a[36:39], a[24:27], v[172:175]
    ds_read_b128 a[68:71], v227 offset:2048
    v_mfma_f32_16x16x32_bf16 v[144:147], a[36:39], a[20:23], v[144:147]
    ds_read_b64_tr_b16 a[104:105], v228 offset:16448
    v_mfma_f32_16x16x32_bf16 v[116:119], a[36:39], a[16:19], v[116:119]
    ds_read_b64_tr_b16 a[106:107], v228 offset:18240
    v_mfma_f32_16x16x32_bf16 v[88:91], a[36:39], a[12:15], v[88:91]
    v_accvgpr_read_b32 v234, a130
    v_mfma_f32_16x16x32_bf16 v[60:63], a[36:39], a[8:11], v[60:63]
    v_mfma_f32_16x16x32_bf16 v[32:35], a[36:39], a[4:7], v[32:35]
    v_accvgpr_read_b32 v235, a131
    v_mfma_f32_16x16x32_bf16 v[4:7], a[36:39], a[0:3], v[4:7]
    ds_read_b128 a[72:75], v227 offset:4096
    v_mfma_f32_16x16x32_bf16 v[8:11], a[40:43], a[0:3], v[8:11]
    ds_read_b64_tr_b16 a[108:109], v229 offset:16480
    v_mfma_f32_16x16x32_bf16 v[36:39], a[40:43], a[4:7], v[36:39]
    v_mfma_f32_16x16x32_bf16 v[64:67], a[40:43], a[8:11], v[64:67]
    ds_read_b64_tr_b16 a[110:111], v229 offset:18272
    v_mfma_f32_16x16x32_bf16 v[92:95], a[40:43], a[12:15], v[92:95]
    ds_read_b128 a[76:79], v227 offset:6144
    v_mfma_f32_16x16x32_bf16 v[120:123], a[40:43], a[16:19], v[120:123]
    v_accvgpr_read_b32 v236, a132
    v_mfma_f32_16x16x32_bf16 v[148:151], a[40:43], a[20:23], v[148:151]
    v_mfma_f32_16x16x32_bf16 v[176:179], a[40:43], a[24:27], v[176:179]
    v_accvgpr_read_b32 v237, a133
    v_mfma_f32_16x16x32_bf16 v[204:207], a[40:43], a[28:31], v[204:207]
    ds_read_b64_tr_b16 a[112:113], v228 offset:16512
    v_mfma_f32_16x16x32_bf16 v[208:211], a[44:47], a[28:31], v[208:211]
    ds_read_b64_tr_b16 a[114:115], v228 offset:18304
    v_mfma_f32_16x16x32_bf16 v[180:183], a[44:47], a[24:27], v[180:183]
    ds_read_b128 a[80:83], v227 offset:8192
    v_mfma_f32_16x16x32_bf16 v[152:155], a[44:47], a[20:23], v[152:155]
    v_mfma_f32_16x16x32_bf16 v[124:127], a[44:47], a[16:19], v[124:127]
    ds_read_b64_tr_b16 a[116:117], v229 offset:16544
    v_mfma_f32_16x16x32_bf16 v[96:99], a[44:47], a[12:15], v[96:99]
    v_accvgpr_read_b32 v238, a134
    v_mfma_f32_16x16x32_bf16 v[68:71], a[44:47], a[8:11], v[68:71]
    v_accvgpr_read_b32 v239, a135
    v_mfma_f32_16x16x32_bf16 v[40:43], a[44:47], a[4:7], v[40:43]
    v_mfma_f32_16x16x32_bf16 v[12:15], a[44:47], a[0:3], v[12:15]
    ds_read_b64_tr_b16 a[118:119], v229 offset:18336
    v_mfma_f32_16x16x32_bf16 v[16:19], a[48:51], a[0:3], v[16:19]
    ds_read_b128 a[84:87], v227 offset:10240
    v_mfma_f32_16x16x32_bf16 v[44:47], a[48:51], a[4:7], v[44:47]
    ds_read_b64_tr_b16 a[120:121], v230 offset:16384
    v_mfma_f32_16x16x32_bf16 v[72:75], a[48:51], a[8:11], v[72:75]
    v_mfma_f32_16x16x32_bf16 v[100:103], a[48:51], a[12:15], v[100:103]
    ds_read_b64_tr_b16 a[122:123], v230 offset:18176
    v_mfma_f32_16x16x32_bf16 v[128:131], a[48:51], a[16:19], v[128:131]
    v_accvgpr_read_b32 v240, a136
    v_mfma_f32_16x16x32_bf16 v[156:159], a[48:51], a[20:23], v[156:159]
    v_accvgpr_read_b32 v241, a137
    v_mfma_f32_16x16x32_bf16 v[184:187], a[48:51], a[24:27], v[184:187]
    ds_read_b128 a[88:91], v227 offset:12288
    v_mfma_f32_16x16x32_bf16 v[212:215], a[48:51], a[28:31], v[212:215]
    v_mfma_f32_16x16x32_bf16 v[216:219], a[52:55], a[28:31], v[216:219]
    ds_read_b128 a[92:95], v227 offset:14336
    v_mfma_f32_16x16x32_bf16 v[188:191], a[52:55], a[24:27], v[188:191]
    s_add_u32 s73, s73, 0x8000
    v_mfma_f32_16x16x32_bf16 v[160:163], a[52:55], a[20:23], v[160:163]
    s_cmp_eq_u32 s73, 0x18000
    v_mfma_f32_16x16x32_bf16 v[132:135], a[52:55], a[16:19], v[132:135]
    v_mfma_f32_16x16x32_bf16 v[104:107], a[52:55], a[12:15], v[104:107]
    s_cselect_b32 s73, 0, s73
    v_mfma_f32_16x16x32_bf16 v[76:79], a[52:55], a[8:11], v[76:79]
    v_add_u32_e64 v226, s73, v224
    v_mfma_f32_16x16x32_bf16 v[48:51], a[52:55], a[4:7], v[48:51]
    v_add_u32_e64 v227, s73, v225
    v_mfma_f32_16x16x32_bf16 v[20:23], a[52:55], a[0:3], v[20:23]
    v_mfma_f32_16x16x32_bf16 v[24:27], a[56:59], a[0:3], v[24:27]
    v_mfma_f32_16x16x32_bf16 v[52:55], a[56:59], a[4:7], v[52:55]
    v_mfma_f32_16x16x32_bf16 v[80:83], a[56:59], a[8:11], v[80:83]
    v_mfma_f32_16x16x32_bf16 v[108:111], a[56:59], a[12:15], v[108:111]
    v_mfma_f32_16x16x32_bf16 v[136:139], a[56:59], a[16:19], v[136:139]
    v_mfma_f32_16x16x32_bf16 v[164:167], a[56:59], a[20:23], v[164:167]
    v_mfma_f32_16x16x32_bf16 v[192:195], a[56:59], a[24:27], v[192:195]
    v_mfma_f32_16x16x32_bf16 v[220:223], a[56:59], a[28:31], v[220:223]
    s_waitcnt vmcnt(8) lgkmcnt(0)
    s_barrier
    v_mfma_f32_16x16x32_bf16 v[0:3], a[96:99], a[64:67], v[0:3]
    ds_read_b64_tr_b16 a[32:33], v228 offset:32768
    v_mfma_f32_16x16x32_bf16 v[28:31], a[96:99], a[68:71], v[28:31]
    v_mfma_f32_16x16x32_bf16 v[56:59], a[96:99], a[72:75], v[56:59]
    ds_read_b64_tr_b16 a[34:35], v228 offset:34560
    v_mfma_f32_16x16x32_bf16 v[84:87], a[96:99], a[76:79], v[84:87]
    v_mfma_f32_16x16x32_bf16 v[112:115], a[96:99], a[80:83], v[112:115]
    ds_read_b128 a[0:3], v226 offset:0
    v_mfma_f32_16x16x32_bf16 v[140:143], a[96:99], a[84:87], v[140:143]
    v_mfma_f32_16x16x32_bf16 v[168:171], a[96:99], a[88:91], v[168:171]
    ds_read_b64_tr_b16 a[36:37], v229 offset:32800
    v_mfma_f32_16x16x32_bf16 v[196:199], a[96:99], a[92:95], v[196:199]
    v_mfma_f32_16x16x32_bf16 v[200:203], a[100:103], a[92:95], v[200:203]
    ds_read_b64_tr_b16 a[38:39], v229 offset:34592
    v_mfma_f32_16x16x32_bf16 v[172:175], a[100:103], a[88:91], v[172:175]
    v_mfma_f32_16x16x32_bf16 v[144:147], a[100:103], a[84:87], v[144:147]
    ds_read_b128 a[4:7], v226 offset:2048
    v_mfma_f32_16x16x32_bf16 v[116:119], a[100:103], a[80:83], v[116:119]
    v_mfma_f32_16x16x32_bf16 v[88:91], a[100:103], a[76:79], v[88:91]
    v_mfma_f32_16x16x32_bf16 v[60:63], a[100:103], a[72:75], v[60:63]
    ds_read_b64_tr_b16 a[40:41], v228 offset:32832
    v_mfma_f32_16x16x32_bf16 v[32:35], a[100:103], a[68:71], v[32:35]
    v_mfma_f32_16x16x32_bf16 v[4:7], a[100:103], a[64:67], v[4:7]
    ds_read_b64_tr_b16 a[42:43], v228 offset:34624
    v_mfma_f32_16x16x32_bf16 v[8:11], a[104:107], a[64:67], v[8:11]
    v_mfma_f32_16x16x32_bf16 v[36:39], a[104:107], a[68:71], v[36:39]
    ds_read_b128 a[8:11], v226 offset:4096
    v_mfma_f32_16x16x32_bf16 v[64:67], a[104:107], a[72:75], v[64:67]
    v_mfma_f32_16x16x32_bf16 v[92:95], a[104:107], a[76:79], v[92:95]
    ds_read_b64_tr_b16 a[44:45], v229 offset:32864
    v_mfma_f32_16x16x32_bf16 v[120:123], a[104:107], a[80:83], v[120:123]
    v_mfma_f32_16x16x32_bf16 v[148:151], a[104:107], a[84:87], v[148:151]
    ds_read_b64_tr_b16 a[46:47], v229 offset:34656
    v_mfma_f32_16x16x32_bf16 v[176:179], a[104:107], a[88:91], v[176:179]
    v_mfma_f32_16x16x32_bf16 v[204:207], a[104:107], a[92:95], v[204:207]
    v_mfma_f32_16x16x32_bf16 v[208:211], a[108:111], a[92:95], v[208:211]
    ds_read_b128 a[12:15], v226 offset:6144
    v_mfma_f32_16x16x32_bf16 v[180:183], a[108:111], a[88:91], v[180:183]
    v_mfma_f32_16x16x32_bf16 v[152:155], a[108:111], a[84:87], v[152:155]
    ds_read_b64_tr_b16 a[48:49], v228 offset:32896
    v_mfma_f32_16x16x32_bf16 v[124:127], a[108:111], a[80:83], v[124:127]
    v_mfma_f32_16x16x32_bf16 v[96:99], a[108:111], a[76:79], v[96:99]
    ds_read_b64_tr_b16 a[50:51], v228 offset:34688
    v_mfma_f32_16x16x32_bf16 v[68:71], a[108:111], a[72:75], v[68:71]
    v_mfma_f32_16x16x32_bf16 v[40:43], a[108:111], a[68:71], v[40:43]
    ds_read_b128 a[16:19], v226 offset:8192
    v_mfma_f32_16x16x32_bf16 v[12:15], a[108:111], a[64:67], v[12:15]
    v_mfma_f32_16x16x32_bf16 v[16:19], a[112:115], a[64:67], v[16:19]
    ds_read_b64_tr_b16 a[52:53], v229 offset:32928
    v_mfma_f32_16x16x32_bf16 v[44:47], a[112:115], a[68:71], v[44:47]
    v_mfma_f32_16x16x32_bf16 v[72:75], a[112:115], a[72:75], v[72:75]
    ds_read_b64_tr_b16 a[54:55], v229 offset:34720
    v_mfma_f32_16x16x32_bf16 v[100:103], a[112:115], a[76:79], v[100:103]
    v_mfma_f32_16x16x32_bf16 v[128:131], a[112:115], a[80:83], v[128:131]
    v_mfma_f32_16x16x32_bf16 v[156:159], a[112:115], a[84:87], v[156:159]
    ds_read_b128 a[20:23], v226 offset:10240
    v_mfma_f32_16x16x32_bf16 v[184:187], a[112:115], a[88:91], v[184:187]
    v_mfma_f32_16x16x32_bf16 v[212:215], a[112:115], a[92:95], v[212:215]
    ds_read_b64_tr_b16 a[56:57], v230 offset:32768
    v_mfma_f32_16x16x32_bf16 v[216:219], a[116:119], a[92:95], v[216:219]
    v_mfma_f32_16x16x32_bf16 v[188:191], a[116:119], a[88:91], v[188:191]
    ds_read_b64_tr_b16 a[58:59], v230 offset:34560
    v_mfma_f32_16x16x32_bf16 v[160:163], a[116:119], a[84:87], v[160:163]
    v_mfma_f32_16x16x32_bf16 v[132:135], a[116:119], a[80:83], v[132:135]
    ds_read_b128 a[24:27], v226 offset:12288
    v_mfma_f32_16x16x32_bf16 v[104:107], a[116:119], a[76:79], v[104:107]
    v_mfma_f32_16x16x32_bf16 v[76:79], a[116:119], a[72:75], v[76:79]
    ds_read_b128 a[28:31], v226 offset:14336
    v_mfma_f32_16x16x32_bf16 v[48:51], a[116:119], a[68:71], v[48:51]
    v_mfma_f32_16x16x32_bf16 v[20:23], a[116:119], a[64:67], v[20:23]
    v_mfma_f32_16x16x32_bf16 v[24:27], a[120:123], a[64:67], v[24:27]
    v_mfma_f32_16x16x32_bf16 v[52:55], a[120:123], a[68:71], v[52:55]
    v_mfma_f32_16x16x32_bf16 v[80:83], a[120:123], a[72:75], v[80:83]
    v_mfma_f32_16x16x32_bf16 v[108:111], a[120:123], a[76:79], v[108:111]
    v_mfma_f32_16x16x32_bf16 v[136:139], a[120:123], a[80:83], v[136:139]
    v_mfma_f32_16x16x32_bf16 v[164:167], a[120:123], a[84:87], v[164:167]
    v_mfma_f32_16x16x32_bf16 v[192:195], a[120:123], a[88:91], v[192:195]
    v_mfma_f32_16x16x32_bf16 v[220:223], a[120:123], a[92:95], v[220:223]
    s_waitcnt vmcnt(0) lgkmcnt(0)
    s_barrier
    v_mfma_f32_16x16x32_bf16 v[0:3], a[32:35], a[0:3], v[0:3]
    ds_read_b64_tr_b16 a[96:97], v228 offset:49152
    v_mfma_f32_16x16x32_bf16 v[28:31], a[32:35], a[4:7], v[28:31]
    ds_read_b64_tr_b16 a[98:99], v228 offset:50944
    v_mfma_f32_16x16x32_bf16 v[56:59], a[32:35], a[8:11], v[56:59]
    ds_read_b128 a[64:67], v227 offset:0
    v_mfma_f32_16x16x32_bf16 v[84:87], a[32:35], a[12:15], v[84:87]
    ds_read_b64_tr_b16 a[100:101], v229 offset:49184
    v_mfma_f32_16x16x32_bf16 v[112:115], a[32:35], a[16:19], v[112:115]
    ds_read_b64_tr_b16 a[102:103], v229 offset:50976
    v_mfma_f32_16x16x32_bf16 v[140:143], a[32:35], a[20:23], v[140:143]
    v_mfma_f32_16x16x32_bf16 v[168:171], a[32:35], a[24:27], v[168:171]
    ds_read_b128 a[68:71], v227 offset:2048
    v_mfma_f32_16x16x32_bf16 v[196:199], a[32:35], a[28:31], v[196:199]
    ds_read_b64_tr_b16 a[104:105], v228 offset:49216
    v_mfma_f32_16x16x32_bf16 v[200:203], a[36:39], a[28:31], v[200:203]
    ds_read_b64_tr_b16 a[106:107], v228 offset:51008
    v_mfma_f32_16x16x32_bf16 v[172:175], a[36:39], a[24:27], v[172:175]
    ds_read_b128 a[72:75], v227 offset:4096
    v_mfma_f32_16x16x32_bf16 v[144:147], a[36:39], a[20:23], v[144:147]
    v_mfma_f32_16x16x32_bf16 v[116:119], a[36:39], a[16:19], v[116:119]
    ds_read_b64_tr_b16 a[108:109], v229 offset:49248
    v_mfma_f32_16x16x32_bf16 v[88:91], a[36:39], a[12:15], v[88:91]
    ds_read_b64_tr_b16 a[110:111], v229 offset:51040
    v_mfma_f32_16x16x32_bf16 v[60:63], a[36:39], a[8:11], v[60:63]
    ds_read_b128 a[76:79], v227 offset:6144
    v_mfma_f32_16x16x32_bf16 v[32:35], a[36:39], a[4:7], v[32:35]
    ds_read_b64_tr_b16 a[112:113], v228 offset:49280
    v_mfma_f32_16x16x32_bf16 v[4:7], a[36:39], a[0:3], v[4:7]
    v_mfma_f32_16x16x32_bf16 v[8:11], a[40:43], a[0:3], v[8:11]
    ds_read_b64_tr_b16 a[114:115], v228 offset:51072
    v_mfma_f32_16x16x32_bf16 v[36:39], a[40:43], a[4:7], v[36:39]
    ds_read_b128 a[80:83], v227 offset:8192
    v_mfma_f32_16x16x32_bf16 v[64:67], a[40:43], a[8:11], v[64:67]
    ds_read_b64_tr_b16 a[116:117], v229 offset:49312
    v_mfma_f32_16x16x32_bf16 v[92:95], a[40:43], a[12:15], v[92:95]
    ds_read_b64_tr_b16 a[118:119], v229 offset:51104
    v_mfma_f32_16x16x32_bf16 v[120:123], a[40:43], a[16:19], v[120:123]
    ds_read_b128 a[84:87], v227 offset:10240
    v_mfma_f32_16x16x32_bf16 v[148:151], a[40:43], a[20:23], v[148:151]
    v_mfma_f32_16x16x32_bf16 v[176:179], a[40:43], a[24:27], v[176:179]
    ds_read_b64_tr_b16 a[120:121], v230 offset:49152
    v_mfma_f32_16x16x32_bf16 v[204:207], a[40:43], a[28:31], v[204:207]
    ds_read_b64_tr_b16 a[122:123], v230 offset:50944
    v_mfma_f32_16x16x32_bf16 v[208:211], a[44:47], a[28:31], v[208:211]
    ds_read_b128 a[88:91], v227 offset:12288
    v_mfma_f32_16x16x32_bf16 v[180:183], a[44:47], a[24:27], v[180:183]
    ds_read_b128 a[92:95], v227 offset:14336
    v_mfma_f32_16x16x32_bf16 v[152:155], a[44:47], a[20:23], v[152:155]
    v_mfma_f32_16x16x32_bf16 v[124:127], a[44:47], a[16:19], v[124:127]
    s_add_u32 s73, s73, 0x8000
    v_mfma_f32_16x16x32_bf16 v[96:99], a[44:47], a[12:15], v[96:99]
    s_cmp_eq_u32 s73, 0x18000
    v_mfma_f32_16x16x32_bf16 v[68:71], a[44:47], a[8:11], v[68:71]
    s_cselect_b32 s73, 0, s73
    v_mfma_f32_16x16x32_bf16 v[40:43], a[44:47], a[4:7], v[40:43]
    v_add_u32 v226, s73, v224
    v_mfma_f32_16x16x32_bf16 v[12:15], a[44:47], a[0:3], v[12:15]
    v_mfma_f32_16x16x32_bf16 v[16:19], a[48:51], a[0:3], v[16:19]
    v_add_u32_e64 v227, s73, v225
    v_mfma_f32_16x16x32_bf16 v[44:47], a[48:51], a[4:7], v[44:47]
    s_waitcnt vmcnt(0)
    v_mfma_f32_16x16x32_bf16 v[72:75], a[48:51], a[8:11], v[72:75]
    v_add_f32 v234, v234, v238
    v_mfma_f32_16x16x32_bf16 v[100:103], a[48:51], a[12:15], v[100:103]
    v_add_f32_e64 v235, v235, v239
    v_mfma_f32_16x16x32_bf16 v[128:131], a[48:51], a[16:19], v[128:131]
    v_add_f32_e64 v236, v236, v240
    v_mfma_f32_16x16x32_bf16 v[156:159], a[48:51], a[20:23], v[156:159]
    v_mfma_f32_16x16x32_bf16 v[184:187], a[48:51], a[24:27], v[184:187]
    v_add_f32_e64 v237, v237, v241
    v_mfma_f32_16x16x32_bf16 v[212:215], a[48:51], a[28:31], v[212:215]
    v_add_f32_e64 v234, v234, v235
    v_mfma_f32_16x16x32_bf16 v[216:219], a[52:55], a[28:31], v[216:219]
    v_add_f32_e64 v236, v236, v237
    v_mfma_f32_16x16x32_bf16 v[188:191], a[52:55], a[24:27], v[188:191]
    v_add_u32 v245, 98304, v245
    v_mfma_f32_16x16x32_bf16 v[160:163], a[52:55], a[20:23], v[160:163]
    v_mfma_f32_16x16x32_bf16 v[132:135], a[52:55], a[16:19], v[132:135]
    v_add_f32_e64 v234, v234, v236
    v_mfma_f32_16x16x32_bf16 v[104:107], a[52:55], a[12:15], v[104:107]
    ds_write_b32 v245, v232
    v_mfma_f32_16x16x32_bf16 v[76:79], a[52:55], a[8:11], v[76:79]
    ds_write_b32 v245, v233 offset:1024
    v_mfma_f32_16x16x32_bf16 v[48:51], a[52:55], a[4:7], v[48:51]
    ds_write_b32 v245, v234 offset:2048
    v_mfma_f32_16x16x32_bf16 v[20:23], a[52:55], a[0:3], v[20:23]
    v_mfma_f32_16x16x32_bf16 v[24:27], a[56:59], a[0:3], v[24:27]
    v_mfma_f32_16x16x32_bf16 v[52:55], a[56:59], a[4:7], v[52:55]
    v_mfma_f32_16x16x32_bf16 v[80:83], a[56:59], a[8:11], v[80:83]
    v_mfma_f32_16x16x32_bf16 v[108:111], a[56:59], a[12:15], v[108:111]
    v_mfma_f32_16x16x32_bf16 v[136:139], a[56:59], a[16:19], v[136:139]
    v_mfma_f32_16x16x32_bf16 v[164:167], a[56:59], a[20:23], v[164:167]
    v_mfma_f32_16x16x32_bf16 v[192:195], a[56:59], a[24:27], v[192:195]
    v_mfma_f32_16x16x32_bf16 v[220:223], a[56:59], a[28:31], v[220:223]
    s_waitcnt vmcnt(0) lgkmcnt(0)
    s_barrier
    v_mfma_f32_16x16x32_bf16 v[0:3], a[96:99], a[64:67], v[0:3]
    v_min_u32_e64 v253, 7, v255
    v_mfma_f32_16x16x32_bf16 v[28:31], a[96:99], a[68:71], v[28:31]
    v_lshlrev_b32_e64 v253, 7, v253
    v_mfma_f32_16x16x32_bf16 v[56:59], a[96:99], a[72:75], v[56:59]
    s_lshl_b32 s3, s10, 9
    v_mfma_f32_16x16x32_bf16 v[84:87], a[96:99], a[76:79], v[84:87]
    s_add_u32 s3, s3, 98304
    v_mfma_f32_16x16x32_bf16 v[112:115], a[96:99], a[80:83], v[112:115]
    v_lshl_add_u32 v242, v251, 2, s3
    v_mfma_f32_16x16x32_bf16 v[140:143], a[96:99], a[84:87], v[140:143]
    v_mfma_f32_16x16x32_bf16 v[168:171], a[96:99], a[88:91], v[168:171]
    s_lshl_b32 s3, s11, 9
    v_mfma_f32_16x16x32_bf16 v[196:199], a[96:99], a[92:95], v[196:199]
    s_add_u32 s3, s3, 100352
    v_mfma_f32_16x16x32_bf16 v[200:203], a[100:103], a[92:95], v[200:203]
    v_lshl_add_u32 v243, v250, 4, s3
    v_mfma_f32_16x16x32_bf16 v[172:175], a[100:103], a[88:91], v[172:175]
    buffer_load_dword v251, v253, s[36:39], s22 offen sc1
    v_mfma_f32_16x16x32_bf16 v[144:147], a[100:103], a[84:87], v[144:147]
    v_mfma_f32_16x16x32_bf16 v[116:119], a[100:103], a[80:83], v[116:119]
    ds_read_b32 v244, v242 offset:0
    v_mfma_f32_16x16x32_bf16 v[88:91], a[100:103], a[76:79], v[88:91]
    ds_read_b32 v245, v242 offset:64
    v_mfma_f32_16x16x32_bf16 v[60:63], a[100:103], a[72:75], v[60:63]
    ds_read_b32 v246, v242 offset:128
    v_mfma_f32_16x16x32_bf16 v[32:35], a[100:103], a[68:71], v[32:35]
    ds_read_b32 v247, v242 offset:192
    v_mfma_f32_16x16x32_bf16 v[4:7], a[100:103], a[64:67], v[4:7]
    v_mfma_f32_16x16x32_bf16 v[8:11], a[104:107], a[64:67], v[8:11]
    ds_read_b32 v248, v242 offset:256
    v_mfma_f32_16x16x32_bf16 v[36:39], a[104:107], a[68:71], v[36:39]
    ds_read_b32 v249, v242 offset:320
    v_mfma_f32_16x16x32_bf16 v[64:67], a[104:107], a[72:75], v[64:67]
    ds_read_b32 v240, v242 offset:384
    v_mfma_f32_16x16x32_bf16 v[92:95], a[104:107], a[76:79], v[92:95]
    ds_read_b32 v241, v242 offset:448
    v_mfma_f32_16x16x32_bf16 v[120:123], a[104:107], a[80:83], v[120:123]
    ds_read_b128 v[224:227], v243 offset:0
    v_mfma_f32_16x16x32_bf16 v[148:151], a[104:107], a[84:87], v[148:151]
    v_mfma_f32_16x16x32_bf16 v[176:179], a[104:107], a[88:91], v[176:179]
    ds_read_b128 v[228:231], v243 offset:64
    v_mfma_f32_16x16x32_bf16 v[204:207], a[104:107], a[92:95], v[204:207]
    ds_read_b128 v[232:235], v243 offset:128
    v_mfma_f32_16x16x32_bf16 v[208:211], a[108:111], a[92:95], v[208:211]
    ds_read_b128 v[236:239], v243 offset:192
    v_mfma_f32_16x16x32_bf16 v[180:183], a[108:111], a[88:91], v[180:183]
    s_mul_i32 s76, s9, 7
    v_mfma_f32_16x16x32_bf16 v[152:155], a[108:111], a[84:87], v[152:155]
    v_mfma_f32_16x16x32_bf16 v[124:127], a[108:111], a[80:83], v[124:127]
    s_add_u32 s76, s76, 32
    v_mfma_f32_16x16x32_bf16 v[96:99], a[108:111], a[76:79], v[96:99]
    s_lshl_b32 s76, s76, 17
    v_mfma_f32_16x16x32_bf16 v[68:71], a[108:111], a[72:75], v[68:71]
    s_lshl_b32 s3, s7, 14
    v_mfma_f32_16x16x32_bf16 v[40:43], a[108:111], a[68:71], v[40:43]
    s_add_u32 s76, s76, s3
    v_mfma_f32_16x16x32_bf16 v[12:15], a[108:111], a[64:67], v[12:15]
    v_mfma_f32_16x16x32_bf16 v[16:19], a[112:115], a[64:67], v[16:19]
    s_lshl_b32 s3, s10, 13
    v_mfma_f32_16x16x32_bf16 v[44:47], a[112:115], a[68:71], v[44:47]
    s_add_u32 s76, s76, s3
    v_mfma_f32_16x16x32_bf16 v[72:75], a[112:115], a[72:75], v[72:75]
    s_add_u32 s76, s76, 0xc00000
    v_mfma_f32_16x16x32_bf16 v[100:103], a[112:115], a[76:79], v[100:103]
    s_lshl_b32 s3, s11, 19
    v_mfma_f32_16x16x32_bf16 v[128:131], a[112:115], a[80:83], v[128:131]
    s_add_u32 s87, s76, s3
    v_mfma_f32_16x16x32_bf16 v[156:159], a[112:115], a[84:87], v[156:159]
    v_mfma_f32_16x16x32_bf16 v[184:187], a[112:115], a[88:91], v[184:187]
    s_lshl_b32 s3, s11, 3
    v_mfma_f32_16x16x32_bf16 v[212:215], a[112:115], a[92:95], v[212:215]
    s_add_u32 s88, s76, s3
    v_mfma_f32_16x16x32_bf16 v[216:219], a[116:119], a[92:95], v[216:219]
    s_add_u32 s88, s88, 393216
    v_mfma_f32_16x16x32_bf16 v[188:191], a[116:119], a[88:91], v[188:191]
    s_mul_i32 s3, s11, -448
    v_mfma_f32_16x16x32_bf16 v[160:163], a[116:119], a[84:87], v[160:163]
    v_mfma_f32_16x16x32_bf16 v[132:135], a[116:119], a[80:83], v[132:135]
    v_add_u32 v242, s3, v243
    v_mfma_f32_16x16x32_bf16 v[104:107], a[116:119], a[76:79], v[104:107]
    s_mov_b32 s86, 0
    v_mfma_f32_16x16x32_bf16 v[76:79], a[116:119], a[72:75], v[76:79]
    s_cmp_eq_u32 s4, 0
    v_mfma_f32_16x16x32_bf16 v[48:51], a[116:119], a[68:71], v[48:51]
    s_cselect_b32 s89, 5, 99
    v_mfma_f32_16x16x32_bf16 v[20:23], a[116:119], a[64:67], v[20:23]
    v_mfma_f32_16x16x32_bf16 v[24:27], a[120:123], a[64:67], v[24:27]
    v_mfma_f32_16x16x32_bf16 v[52:55], a[120:123], a[68:71], v[52:55]
    v_mfma_f32_16x16x32_bf16 v[80:83], a[120:123], a[72:75], v[80:83]
    v_mfma_f32_16x16x32_bf16 v[108:111], a[120:123], a[76:79], v[108:111]
    v_mfma_f32_16x16x32_bf16 v[136:139], a[120:123], a[80:83], v[136:139]
    v_mfma_f32_16x16x32_bf16 v[164:167], a[120:123], a[84:87], v[164:167]
    v_mfma_f32_16x16x32_bf16 v[192:195], a[120:123], a[88:91], v[192:195]
    v_mfma_f32_16x16x32_bf16 v[220:223], a[120:123], a[92:95], v[220:223]
    s_waitcnt lgkmcnt(0)
    s_nop 0
    v_pk_fma_f32 v[0:1], v[224:225], v[244:245], v[0:1] op_sel_hi:[1,0,1]
    v_pk_fma_f32 v[2:3], v[226:227], v[244:245], v[2:3] op_sel_hi:[1,0,1]
    v_pk_fma_f32 v[4:5], v[228:229], v[244:245], v[4:5] op_sel_hi:[1,0,1]
    v_pk_fma_f32 v[6:7], v[230:231], v[244:245], v[6:7] op_sel_hi:[1,0,1]
    v_pk_fma_f32 v[28:29], v[224:225], v[244:245], v[28:29] op_sel:[0,1,0] op_sel_hi:[1,1,1]
    v_pk_fma_f32 v[30:31], v[226:227], v[244:245], v[30:31] op_sel:[0,1,0] op_sel_hi:[1,1,1]
    v_pk_fma_f32 v[32:33], v[228:229], v[244:245], v[32:33] op_sel:[0,1,0] op_sel_hi:[1,1,1]
    v_pk_fma_f32 v[34:35], v[230:231], v[244:245], v[34:35] op_sel:[0,1,0] op_sel_hi:[1,1,1]
    v_pk_fma_f32 v[56:57], v[224:225], v[246:247], v[56:57] op_sel_hi:[1,0,1]
    v_pk_fma_f32 v[58:59], v[226:227], v[246:247], v[58:59] op_sel_hi:[1,0,1]
    v_pk_fma_f32 v[60:61], v[228:229], v[246:247], v[60:61] op_sel_hi:[1,0,1]
    v_pk_fma_f32 v[62:63], v[230:231], v[246:247], v[62:63] op_sel_hi:[1,0,1]
    v_pk_fma_f32 v[84:85], v[224:225], v[246:247], v[84:85] op_sel:[0,1,0] op_sel_hi:[1,1,1]
    v_pk_fma_f32 v[86:87], v[226:227], v[246:247], v[86:87] op_sel:[0,1,0] op_sel_hi:[1,1,1]
    v_pk_fma_f32 v[88:89], v[228:229], v[246:247], v[88:89] op_sel:[0,1,0] op_sel_hi:[1,1,1]
    v_pk_fma_f32 v[90:91], v[230:231], v[246:247], v[90:91] op_sel:[0,1,0] op_sel_hi:[1,1,1]
    v_pk_fma_f32 v[112:113], v[224:225], v[248:249], v[112:113] op_sel_hi:[1,0,1]
    v_pk_fma_f32 v[114:115], v[226:227], v[248:249], v[114:115] op_sel_hi:[1,0,1]
    v_pk_fma_f32 v[116:117], v[228:229], v[248:249], v[116:117] op_sel_hi:[1,0,1]
    v_pk_fma_f32 v[118:119], v[230:231], v[248:249], v[118:119] op_sel_hi:[1,0,1]
    v_pk_fma_f32 v[140:141], v[224:225], v[248:249], v[140:141] op_sel:[0,1,0] op_sel_hi:[1,1,1]
    v_pk_fma_f32 v[142:143], v[226:227], v[248:249], v[142:143] op_sel:[0,1,0] op_sel_hi:[1,1,1]
    v_pk_fma_f32 v[144:145], v[228:229], v[248:249], v[144:145] op_sel:[0,1,0] op_sel_hi:[1,1,1]
    v_pk_fma_f32 v[146:147], v[230:231], v[248:249], v[146:147] op_sel:[0,1,0] op_sel_hi:[1,1,1]
    v_pk_fma_f32 v[168:169], v[224:225], v[240:241], v[168:169] op_sel_hi:[1,0,1]
    v_pk_fma_f32 v[170:171], v[226:227], v[240:241], v[170:171] op_sel_hi:[1,0,1]
    v_pk_fma_f32 v[172:173], v[228:229], v[240:241], v[172:173] op_sel_hi:[1,0,1]
    v_pk_fma_f32 v[174:175], v[230:231], v[240:241], v[174:175] op_sel_hi:[1,0,1]
    v_pk_fma_f32 v[196:197], v[224:225], v[240:241], v[196:197] op_sel:[0,1,0] op_sel_hi:[1,1,1]
    v_pk_fma_f32 v[198:199], v[226:227], v[240:241], v[198:199] op_sel:[0,1,0] op_sel_hi:[1,1,1]
    v_pk_fma_f32 v[200:201], v[228:229], v[240:241], v[200:201] op_sel:[0,1,0] op_sel_hi:[1,1,1]
    v_pk_fma_f32 v[202:203], v[230:231], v[240:241], v[202:203] op_sel:[0,1,0] op_sel_hi:[1,1,1]
    ds_read_b128 v[224:227], v243 offset:256
    ds_read_b128 v[228:231], v243 offset:320
    v_pk_fma_f32 v[8:9], v[232:233], v[244:245], v[8:9] op_sel_hi:[1,0,1]
    v_pk_fma_f32 v[10:11], v[234:235], v[244:245], v[10:11] op_sel_hi:[1,0,1]
    v_pk_fma_f32 v[12:13], v[236:237], v[244:245], v[12:13] op_sel_hi:[1,0,1]
    v_pk_fma_f32 v[14:15], v[238:239], v[244:245], v[14:15] op_sel_hi:[1,0,1]
    v_pk_fma_f32 v[36:37], v[232:233], v[244:245], v[36:37] op_sel:[0,1,0] op_sel_hi:[1,1,1]
    v_pk_fma_f32 v[38:39], v[234:235], v[244:245], v[38:39] op_sel:[0,1,0] op_sel_hi:[1,1,1]
    v_pk_fma_f32 v[40:41], v[236:237], v[244:245], v[40:41] op_sel:[0,1,0] op_sel_hi:[1,1,1]
    v_pk_fma_f32 v[42:43], v[238:239], v[244:245], v[42:43] op_sel:[0,1,0] op_sel_hi:[1,1,1]
    v_pk_fma_f32 v[64:65], v[232:233], v[246:247], v[64:65] op_sel_hi:[1,0,1]
    v_pk_fma_f32 v[66:67], v[234:235], v[246:247], v[66:67] op_sel_hi:[1,0,1]
    v_pk_fma_f32 v[68:69], v[236:237], v[246:247], v[68:69] op_sel_hi:[1,0,1]
    v_pk_fma_f32 v[70:71], v[238:239], v[246:247], v[70:71] op_sel_hi:[1,0,1]
    v_pk_fma_f32 v[92:93], v[232:233], v[246:247], v[92:93] op_sel:[0,1,0] op_sel_hi:[1,1,1]
    v_pk_fma_f32 v[94:95], v[234:235], v[246:247], v[94:95] op_sel:[0,1,0] op_sel_hi:[1,1,1]
    v_pk_fma_f32 v[96:97], v[236:237], v[246:247], v[96:97] op_sel:[0,1,0] op_sel_hi:[1,1,1]
    v_pk_fma_f32 v[98:99], v[238:239], v[246:247], v[98:99] op_sel:[0,1,0] op_sel_hi:[1,1,1]
    v_pk_fma_f32 v[120:121], v[232:233], v[248:249], v[120:121] op_sel_hi:[1,0,1]
    v_pk_fma_f32 v[122:123], v[234:235], v[248:249], v[122:123] op_sel_hi:[1,0,1]
    v_pk_fma_f32 v[124:125], v[236:237], v[248:249], v[124:125] op_sel_hi:[1,0,1]
    v_pk_fma_f32 v[126:127], v[238:239], v[248:249], v[126:127] op_sel_hi:[1,0,1]
    v_pk_fma_f32 v[148:149], v[232:233], v[248:249], v[148:149] op_sel:[0,1,0] op_sel_hi:[1,1,1]
    v_pk_fma_f32 v[150:151], v[234:235], v[248:249], v[150:151] op_sel:[0,1,0] op_sel_hi:[1,1,1]
    v_pk_fma_f32 v[152:153], v[236:237], v[248:249], v[152:153] op_sel:[0,1,0] op_sel_hi:[1,1,1]
    v_pk_fma_f32 v[154:155], v[238:239], v[248:249], v[154:155] op_sel:[0,1,0] op_sel_hi:[1,1,1]
    v_pk_fma_f32 v[176:177], v[232:233], v[240:241], v[176:177] op_sel_hi:[1,0,1]
    v_pk_fma_f32 v[178:179], v[234:235], v[240:241], v[178:179] op_sel_hi:[1,0,1]
    v_pk_fma_f32 v[180:181], v[236:237], v[240:241], v[180:181] op_sel_hi:[1,0,1]
    v_pk_fma_f32 v[182:183], v[238:239], v[240:241], v[182:183] op_sel_hi:[1,0,1]
    v_pk_fma_f32 v[204:205], v[232:233], v[240:241], v[204:205] op_sel:[0,1,0] op_sel_hi:[1,1,1]
    v_pk_fma_f32 v[206:207], v[234:235], v[240:241], v[206:207] op_sel:[0,1,0] op_sel_hi:[1,1,1]
    v_pk_fma_f32 v[208:209], v[236:237], v[240:241], v[208:209] op_sel:[0,1,0] op_sel_hi:[1,1,1]
    v_pk_fma_f32 v[210:211], v[238:239], v[240:241], v[210:211] op_sel:[0,1,0] op_sel_hi:[1,1,1]
    ds_read_b128 v[232:235], v242 offset:384
    s_waitcnt lgkmcnt(1)
    s_nop 0
    v_pk_fma_f32 v[16:17], v[224:225], v[244:245], v[16:17] op_sel_hi:[1,0,1]
    v_pk_fma_f32 v[18:19], v[226:227], v[244:245], v[18:19] op_sel_hi:[1,0,1]
    v_pk_fma_f32 v[20:21], v[228:229], v[244:245], v[20:21] op_sel_hi:[1,0,1]
    v_pk_fma_f32 v[22:23], v[230:231], v[244:245], v[22:23] op_sel_hi:[1,0,1]
    v_pk_fma_f32 v[44:45], v[224:225], v[244:245], v[44:45] op_sel:[0,1,0] op_sel_hi:[1,1,1]
    v_pk_fma_f32 v[46:47], v[226:227], v[244:245], v[46:47] op_sel:[0,1,0] op_sel_hi:[1,1,1]
    v_pk_fma_f32 v[48:49], v[228:229], v[244:245], v[48:49] op_sel:[0,1,0] op_sel_hi:[1,1,1]
    v_pk_fma_f32 v[50:51], v[230:231], v[244:245], v[50:51] op_sel:[0,1,0] op_sel_hi:[1,1,1]
    v_pk_fma_f32 v[72:73], v[224:225], v[246:247], v[72:73] op_sel_hi:[1,0,1]
    v_pk_fma_f32 v[74:75], v[226:227], v[246:247], v[74:75] op_sel_hi:[1,0,1]
    v_pk_fma_f32 v[76:77], v[228:229], v[246:247], v[76:77] op_sel_hi:[1,0,1]
    v_pk_fma_f32 v[78:79], v[230:231], v[246:247], v[78:79] op_sel_hi:[1,0,1]
    v_pk_fma_f32 v[100:101], v[224:225], v[246:247], v[100:101] op_sel:[0,1,0] op_sel_hi:[1,1,1]
    v_pk_fma_f32 v[102:103], v[226:227], v[246:247], v[102:103] op_sel:[0,1,0] op_sel_hi:[1,1,1]
    v_pk_fma_f32 v[104:105], v[228:229], v[246:247], v[104:105] op_sel:[0,1,0] op_sel_hi:[1,1,1]
    v_pk_fma_f32 v[106:107], v[230:231], v[246:247], v[106:107] op_sel:[0,1,0] op_sel_hi:[1,1,1]
    v_pk_fma_f32 v[128:129], v[224:225], v[248:249], v[128:129] op_sel_hi:[1,0,1]
    v_pk_fma_f32 v[130:131], v[226:227], v[248:249], v[130:131] op_sel_hi:[1,0,1]
    v_pk_fma_f32 v[132:133], v[228:229], v[248:249], v[132:133] op_sel_hi:[1,0,1]
    v_pk_fma_f32 v[134:135], v[230:231], v[248:249], v[134:135] op_sel_hi:[1,0,1]
    v_pk_fma_f32 v[156:157], v[224:225], v[248:249], v[156:157] op_sel:[0,1,0] op_sel_hi:[1,1,1]
    v_pk_fma_f32 v[158:159], v[226:227], v[248:249], v[158:159] op_sel:[0,1,0] op_sel_hi:[1,1,1]
    v_pk_fma_f32 v[160:161], v[228:229], v[248:249], v[160:161] op_sel:[0,1,0] op_sel_hi:[1,1,1]
    v_pk_fma_f32 v[162:163], v[230:231], v[248:249], v[162:163] op_sel:[0,1,0] op_sel_hi:[1,1,1]
    v_pk_fma_f32 v[184:185], v[224:225], v[240:241], v[184:185] op_sel_hi:[1,0,1]
    v_pk_fma_f32 v[186:187], v[226:227], v[240:241], v[186:187] op_sel_hi:[1,0,1]
    v_pk_fma_f32 v[188:189], v[228:229], v[240:241], v[188:189] op_sel_hi:[1,0,1]
    v_pk_fma_f32 v[190:191], v[230:231], v[240:241], v[190:191] op_sel_hi:[1,0,1]
    v_pk_fma_f32 v[212:213], v[224:225], v[240:241], v[212:213] op_sel:[0,1,0] op_sel_hi:[1,1,1]
    v_pk_fma_f32 v[214:215], v[226:227], v[240:241], v[214:215] op_sel:[0,1,0] op_sel_hi:[1,1,1]
    v_pk_fma_f32 v[216:217], v[228:229], v[240:241], v[216:217] op_sel:[0,1,0] op_sel_hi:[1,1,1]
    v_pk_fma_f32 v[218:219], v[230:231], v[240:241], v[218:219] op_sel:[0,1,0] op_sel_hi:[1,1,1]
    s_waitcnt lgkmcnt(0)
    s_nop 0
    v_pk_fma_f32 v[24:25], v[232:233], v[244:245], v[24:25] op_sel_hi:[1,0,1]
    v_pk_fma_f32 v[26:27], v[234:235], v[244:245], v[26:27] op_sel_hi:[1,0,1]
    v_pk_fma_f32 v[52:53], v[232:233], v[244:245], v[52:53] op_sel:[0,1,0] op_sel_hi:[1,1,1]
    v_pk_fma_f32 v[54:55], v[234:235], v[244:245], v[54:55] op_sel:[0,1,0] op_sel_hi:[1,1,1]
    v_pk_fma_f32 v[80:81], v[232:233], v[246:247], v[80:81] op_sel_hi:[1,0,1]
    v_pk_fma_f32 v[82:83], v[234:235], v[246:247], v[82:83] op_sel_hi:[1,0,1]
    v_pk_fma_f32 v[108:109], v[232:233], v[246:247], v[108:109] op_sel:[0,1,0] op_sel_hi:[1,1,1]
    v_pk_fma_f32 v[110:111], v[234:235], v[246:247], v[110:111] op_sel:[0,1,0] op_sel_hi:[1,1,1]
    v_pk_fma_f32 v[136:137], v[232:233], v[248:249], v[136:137] op_sel_hi:[1,0,1]
    v_pk_fma_f32 v[138:139], v[234:235], v[248:249], v[138:139] op_sel_hi:[1,0,1]
    v_pk_fma_f32 v[164:165], v[232:233], v[248:249], v[164:165] op_sel:[0,1,0] op_sel_hi:[1,1,1]
    v_pk_fma_f32 v[166:167], v[234:235], v[248:249], v[166:167] op_sel:[0,1,0] op_sel_hi:[1,1,1]
    v_pk_fma_f32 v[192:193], v[232:233], v[240:241], v[192:193] op_sel_hi:[1,0,1]
    v_pk_fma_f32 v[194:195], v[234:235], v[240:241], v[194:195] op_sel_hi:[1,0,1]
    v_pk_fma_f32 v[220:221], v[232:233], v[240:241], v[220:221] op_sel:[0,1,0] op_sel_hi:[1,1,1]
    v_pk_fma_f32 v[222:223], v[234:235], v[240:241], v[222:223] op_sel:[0,1,0] op_sel_hi:[1,1,1]
    s_waitcnt vmcnt(0)
    v_cmp_eq_u32 vcc, s95, v251
    s_and_b32 s3, vcc_lo, 0xff
    s_cmp_eq_u32 s3, 0xff
    s_cselect_b32 s85, 1, 0
    s_cbranch_scc0 G1f_late
    s_lshl_b32 s90, s35, 17
    s_lshl_b32 s3, s7, 14
    s_add_u32 s90, s90, s3
    s_lshl_b32 s3, s4, 12
    s_add_u32 s90, s90, s3
    s_lshl_b32 s91, s35, 18
    s_add_u32 s91, s91, 0x400000
    s_lshl_b32 s92, s84, 12
    s_add_u32 s92, s92, s91
    s_sub_u32 s92, s92, 4096
    buffer_load_dwordx4 a[168:171], v254, s[36:39], s90 offen offset:0 sc1
    buffer_load_dwordx4 a[172:175], v254, s[36:39], s90 offen offset:1024 sc1
    buffer_load_dwordx4 a[176:179], v254, s[36:39], s90 offen offset:2048 sc1
    buffer_load_dwordx4 a[180:183], v254, s[36:39], s90 offen offset:3072 sc1
    buffer_load_dwordx4 a[184:187], v254, s[36:39], s92 offen offset:0 sc1
    buffer_load_dwordx4 a[188:191], v254, s[36:39], s92 offen offset:1024 sc1
    s_lshl_b32 s93, s4, 13
    s_add_u32 s91, s91, s93
    s_add_u32 m0, s93, 0
    s_add_u32 s94, s91, 0
    buffer_load_dwordx4 v254, s[36:39], s94 offen offset:0 sc1 lds
    buffer_load_dwordx4 v254, s[36:39], s94 offen offset:1024 sc1 lds
    buffer_load_dwordx4 v254, s[36:39], s94 offen offset:2048 sc1 lds
    buffer_load_dwordx4 v254, s[36:39], s94 offen offset:3072 sc1 lds
    s_add_u32 m0, s93, 4096
    s_add_u32 s94, s91, 4096
    buffer_load_dwordx4 v254, s[36:39], s94 offen offset:0 sc1 lds
    buffer_load_dwordx4 v254, s[36:39], s94 offen offset:1024 sc1 lds
    buffer_load_dwordx4 v254, s[36:39], s94 offen offset:2048 sc1 lds
    buffer_load_dwordx4 v254, s[36:39], s94 offen offset:3072 sc1 lds
G1f_late:
    v_cvt_pk_bf16_f32 v223, v222, v223
    v_cvt_pk_bf16_f32 v222, v220, v221
    v_pk_max_i16 v223, v223, 0
    v_cvt_pk_bf16_f32 v221, v218, v219
    v_pk_max_i16 v222, v222, 0
    v_cvt_pk_bf16_f32 v220, v216, v217
    v_pk_max_i16 v221, v221, 0
    v_cvt_pk_bf16_f32 v219, v214, v215
    v_pk_max_i16 v220, v220, 0
    v_cvt_pk_bf16_f32 v218, v212, v213
    v_pk_max_i16 v219, v219, 0
    v_cvt_pk_bf16_f32 v217, v210, v211
    v_pk_max_i16 v218, v218, 0
    v_cvt_pk_bf16_f32 v216, v208, v209
    v_pk_max_i16 v217, v217, 0
    v_cvt_pk_bf16_f32 v215, v206, v207
    v_pk_max_i16 v216, v216, 0
    v_cvt_pk_bf16_f32 v214, v204, v205
    v_pk_max_i16 v215, v215, 0
    v_cvt_pk_bf16_f32 v213, v202, v203
    v_pk_max_i16 v214, v214, 0
    v_cvt_pk_bf16_f32 v212, v200, v201
    v_pk_max_i16 v213, v213, 0
    v_cvt_pk_bf16_f32 v211, v198, v199
    v_pk_max_i16 v212, v212, 0
    v_cvt_pk_bf16_f32 v210, v196, v197
    v_pk_max_i16 v211, v211, 0
    v_cvt_pk_bf16_f32 v209, v194, v195
    v_pk_max_i16 v210, v210, 0
    v_cvt_pk_bf16_f32 v208, v192, v193
    v_pk_max_i16 v209, v209, 0
    v_cvt_pk_bf16_f32 v207, v190, v191
    v_pk_max_i16 v208, v208, 0
    v_cvt_pk_bf16_f32 v206, v188, v189
    v_pk_max_i16 v207, v207, 0
    v_cvt_pk_bf16_f32 v205, v186, v187
    v_pk_max_i16 v206, v206, 0
    v_cvt_pk_bf16_f32 v204, v184, v185
    v_pk_max_i16 v205, v205, 0
    v_cvt_pk_bf16_f32 v203, v182, v183
    v_pk_max_i16 v204, v204, 0
    v_cvt_pk_bf16_f32 v202, v180, v181
    v_pk_max_i16 v203, v203, 0
    v_cvt_pk_bf16_f32 v201, v178, v179
    v_pk_max_i16 v202, v202, 0
    v_cvt_pk_bf16_f32 v200, v176, v177
    v_pk_max_i16 v201, v201, 0
    v_cvt_pk_bf16_f32 v199, v174, v175
    v_pk_max_i16 v200, v200, 0
    v_cvt_pk_bf16_f32 v198, v172, v173
    v_pk_max_i16 v199, v199, 0
    v_cvt_pk_bf16_f32 v197, v170, v171
    v_pk_max_i16 v198, v198, 0
    v_cvt_pk_bf16_f32 v196, v168, v169
    v_pk_max_i16 v197, v197, 0
    v_cvt_pk_bf16_f32 v195, v166, v167
    v_pk_max_i16 v196, v196, 0
    v_cvt_pk_bf16_f32 v194, v164, v165
    v_pk_max_i16 v195, v195, 0
    v_cvt_pk_bf16_f32 v193, v162, v163
    v_pk_max_i16 v194, v194, 0
    v_cvt_pk_bf16_f32 v192, v160, v161
    v_pk_max_i16 v193, v193, 0
    v_cvt_pk_bf16_f32 v191, v158, v159
    v_pk_max_i16 v192, v192, 0
    v_cvt_pk_bf16_f32 v190, v156, v157
    v_pk_max_i16 v191, v191, 0
    v_cvt_pk_bf16_f32 v189, v154, v155
    v_min_u32 v250, 7, v255
    v_lshlrev_b32 v250, 7, v250
    s_cmp_eq_u32 s85, 1
    s_nop 0
    s_cselect_b32 s3, 0x80000000, s22
    buffer_load_dword v252, v250, s[36:39], s3 offen sc1
    v_pk_max_i16 v190, v190, 0
    v_cvt_pk_bf16_f32 v188, v152, v153
    v_pk_max_i16 v189, v189, 0
    v_cvt_pk_bf16_f32 v187, v150, v151
    v_pk_max_i16 v188, v188, 0
    v_cvt_pk_bf16_f32 v186, v148, v149
    v_pk_max_i16 v187, v187, 0
    v_cvt_pk_bf16_f32 v185, v146, v147
    v_pk_max_i16 v186, v186, 0
    v_cvt_pk_bf16_f32 v184, v144, v145
    v_pk_max_i16 v185, v185, 0
    v_cvt_pk_bf16_f32 v183, v142, v143
    v_pk_max_i16 v184, v184, 0
    v_cvt_pk_bf16_f32 v182, v140, v141
    v_pk_max_i16 v183, v183, 0
    v_cvt_pk_bf16_f32 v181, v138, v139
    v_pk_max_i16 v182, v182, 0
    v_cvt_pk_bf16_f32 v180, v136, v137
    v_pk_max_i16 v181, v181, 0
    v_cvt_pk_bf16_f32 v179, v134, v135
    v_pk_max_i16 v180, v180, 0
    v_cvt_pk_bf16_f32 v178, v132, v133
    v_pk_max_i16 v179, v179, 0
    v_cvt_pk_bf16_f32 v177, v130, v131
    v_pk_max_i16 v178, v178, 0
    v_cvt_pk_bf16_f32 v176, v128, v129
    v_pk_max_i16 v177, v177, 0
    v_cvt_pk_bf16_f32 v175, v126, v127
    v_pk_max_i16 v176, v176, 0
    v_cvt_pk_bf16_f32 v174, v124, v125
    v_pk_max_i16 v175, v175, 0
    v_cvt_pk_bf16_f32 v173, v122, v123
    v_pk_max_i16 v174, v174, 0
    v_cvt_pk_bf16_f32 v172, v120, v121
    v_pk_max_i16 v173, v173, 0
    v_cvt_pk_bf16_f32 v171, v118, v119
    v_pk_max_i16 v172, v172, 0
    v_cvt_pk_bf16_f32 v170, v116, v117
    v_pk_max_i16 v171, v171, 0
    v_cvt_pk_bf16_f32 v169, v114, v115
    v_pk_max_i16 v170, v170, 0
    v_cvt_pk_bf16_f32 v168, v112, v113
    v_pk_max_i16 v169, v169, 0
    v_cvt_pk_bf16_f32 v167, v110, v111
    v_pk_max_i16 v168, v168, 0
    v_cvt_pk_bf16_f32 v166, v108, v109
    v_pk_max_i16 v167, v167, 0
    v_cvt_pk_bf16_f32 v165, v106, v107
    v_pk_max_i16 v166, v166, 0
    v_cvt_pk_bf16_f32 v164, v104, v105
    v_pk_max_i16 v165, v165, 0
    v_cvt_pk_bf16_f32 v163, v102, v103
    v_pk_max_i16 v164, v164, 0
    v_cvt_pk_bf16_f32 v162, v100, v101
    v_pk_max_i16 v163, v163, 0
    v_cvt_pk_bf16_f32 v161, v98, v99
    v_pk_max_i16 v162, v162, 0
    v_cvt_pk_bf16_f32 v160, v96, v97
    v_pk_max_i16 v161, v161, 0
    v_cvt_pk_bf16_f32 v159, v94, v95
    v_pk_max_i16 v160, v160, 0
    v_cvt_pk_bf16_f32 v158, v92, v93
    v_pk_max_i16 v159, v159, 0
    v_cvt_pk_bf16_f32 v157, v90, v91
    v_pk_max_i16 v158, v158, 0
    v_cvt_pk_bf16_f32 v156, v88, v89
    v_pk_max_i16 v157, v157, 0
    v_cvt_pk_bf16_f32 v155, v86, v87
    v_pk_max_i16 v156, v156, 0
    v_cvt_pk_bf16_f32 v154, v84, v85
    v_pk_max_i16 v155, v155, 0
    v_cvt_pk_bf16_f32 v153, v82, v83
    v_pk_max_i16 v154, v154, 0
    v_cvt_pk_bf16_f32 v152, v80, v81
    v_pk_max_i16 v153, v153, 0
    v_cvt_pk_bf16_f32 v151, v78, v79
    v_pk_max_i16 v152, v152, 0
    v_cvt_pk_bf16_f32 v150, v76, v77
    v_pk_max_i16 v151, v151, 0
    v_cvt_pk_bf16_f32 v149, v74, v75
    v_pk_max_i16 v150, v150, 0
    v_cvt_pk_bf16_f32 v148, v72, v73
    v_pk_max_i16 v149, v149, 0
    v_cvt_pk_bf16_f32 v147, v70, v71
    v_pk_max_i16 v148, v148, 0
    v_cvt_pk_bf16_f32 v146, v68, v69
    v_pk_max_i16 v147, v147, 0
    v_cvt_pk_bf16_f32 v145, v66, v67
    v_pk_max_i16 v146, v146, 0
    v_cvt_pk_bf16_f32 v144, v64, v65
    v_pk_max_i16 v145, v145, 0
    v_cvt_pk_bf16_f32 v143, v62, v63
    v_pk_max_i16 v144, v144, 0
    v_cvt_pk_bf16_f32 v142, v60, v61
    v_pk_max_i16 v143, v143, 0
    v_cvt_pk_bf16_f32 v141, v58, v59
    v_pk_max_i16 v142, v142, 0
    v_cvt_pk_bf16_f32 v140, v56, v57
    v_pk_max_i16 v141, v141, 0
    v_cvt_pk_bf16_f32 v139, v54, v55
    v_pk_max_i16 v140, v140, 0
    v_cvt_pk_bf16_f32 v138, v52, v53
    v_pk_max_i16 v139, v139, 0
    v_cvt_pk_bf16_f32 v137, v50, v51
    v_pk_max_i16 v138, v138, 0
    v_cvt_pk_bf16_f32 v136, v48, v49
    v_pk_max_i16 v137, v137, 0
    v_cvt_pk_bf16_f32 v135, v46, v47
    v_pk_max_i16 v136, v136, 0
    v_cvt_pk_bf16_f32 v134, v44, v45
    v_pk_max_i16 v135, v135, 0
    v_cvt_pk_bf16_f32 v133, v42, v43
    v_pk_max_i16 v134, v134, 0
    v_cvt_pk_bf16_f32 v132, v40, v41
    v_pk_max_i16 v133, v133, 0
    v_cvt_pk_bf16_f32 v131, v38, v39
    v_pk_max_i16 v132, v132, 0
    v_cvt_pk_bf16_f32 v130, v36, v37
    v_pk_max_i16 v131, v131, 0
    v_cvt_pk_bf16_f32 v129, v34, v35
    v_pk_max_i16 v130, v130, 0
    v_cvt_pk_bf16_f32 v128, v32, v33
    v_pk_max_i16 v129, v129, 0
    v_cvt_pk_bf16_f32 v127, v30, v31
    v_pk_max_i16 v128, v128, 0
    v_cvt_pk_bf16_f32 v126, v28, v29
    v_pk_max_i16 v127, v127, 0
    v_cvt_pk_bf16_f32 v125, v26, v27
    v_pk_max_i16 v126, v126, 0
    v_cvt_pk_bf16_f32 v124, v24, v25
    v_pk_max_i16 v125, v125, 0
    v_cvt_pk_bf16_f32 v123, v22, v23
    v_pk_max_i16 v124, v124, 0
    v_cvt_pk_bf16_f32 v122, v20, v21
    v_pk_max_i16 v123, v123, 0
    v_cvt_pk_bf16_f32 v121, v18, v19
    v_pk_max_i16 v122, v122, 0
    v_cvt_pk_bf16_f32 v120, v16, v17
    v_pk_max_i16 v121, v121, 0
    v_cvt_pk_bf16_f32 v119, v14, v15
    v_pk_max_i16 v120, v120, 0
    v_cvt_pk_bf16_f32 v118, v12, v13
    v_pk_max_i16 v119, v119, 0
    v_cvt_pk_bf16_f32 v117, v10, v11
    v_pk_max_i16 v118, v118, 0
    v_cvt_pk_bf16_f32 v116, v8, v9
    v_pk_max_i16 v117, v117, 0
    v_cvt_pk_bf16_f32 v115, v6, v7
    v_pk_max_i16 v116, v116, 0
    v_cvt_pk_bf16_f32 v114, v4, v5
    v_pk_max_i16 v115, v115, 0
    v_cvt_pk_bf16_f32 v113, v2, v3
    v_pk_max_i16 v114, v114, 0
    v_cvt_pk_bf16_f32 v112, v0, v1
    v_pk_max_i16 v113, v113, 0
    v_pk_max_i16 v112, v112, 0
AT_start:
    s_cmp_eq_u32 s85, 1
    s_cbranch_scc1 AT_init
    s_waitcnt vmcnt(0)
    v_cmp_eq_u32 vcc, s95, v252
    s_and_b32 s3, vcc_lo, 0xff
    s_cmp_eq_u32 s3, 0xff
    s_cbranch_scc0 AT_init
    s_lshl_b32 s90, s35, 17
    s_lshl_b32 s3, s7, 14
    s_add_u32 s90, s90, s3
    s_lshl_b32 s3, s4, 12
    s_add_u32 s90, s90, s3
    s_lshl_b32 s91, s35, 18
    s_add_u32 s91, s91, 0x400000
    s_lshl_b32 s92, s84, 12
    s_add_u32 s92, s92, s91
    s_nop 0
    s_sub_u32 s92, s92, 4096
    buffer_load_dwordx4 a[168:171], v254, s[36:39], s90 offen offset:0 sc1
    buffer_load_dwordx4 a[172:175], v254, s[36:39], s90 offen offset:1024 sc1
    buffer_load_dwordx4 a[176:179], v254, s[36:39], s90 offen offset:2048 sc1
    buffer_load_dwordx4 a[180:183], v254, s[36:39], s90 offen offset:3072 sc1
    buffer_load_dwordx4 a[184:187], v254, s[36:39], s92 offen offset:0 sc1
    buffer_load_dwordx4 a[188:191], v254, s[36:39], s92 offen offset:1024 sc1
    s_lshl_b32 s93, s4, 13
    s_add_u32 s91, s91, s93
    s_add_u32 m0, s93, 0
    s_add_u32 s94, s91, 0
    buffer_load_dwordx4 v254, s[36:39], s94 offen offset:0 sc1 lds
    buffer_load_dwordx4 v254, s[36:39], s94 offen offset:1024 sc1 lds
    buffer_load_dwordx4 v254, s[36:39], s94 offen offset:2048 sc1 lds
    buffer_load_dwordx4 v254, s[36:39], s94 offen offset:3072 sc1 lds
    s_add_u32 m0, s93, 4096
    s_add_u32 s94, s91, 4096
    buffer_load_dwordx4 v254, s[36:39], s94 offen offset:0 sc1 lds
    buffer_load_dwordx4 v254, s[36:39], s94 offen offset:1024 sc1 lds
    buffer_load_dwordx4 v254, s[36:39], s94 offen offset:2048 sc1 lds
    buffer_load_dwordx4 v254, s[36:39], s94 offen offset:3072 sc1 lds
    s_mov_b32 s85, 1
AT_init:
    v_and_b32 v101, 31, v255
    v_lshlrev_b32 v101, 3, v101
    s_lshl_b32 s65, s7, 11
    s_lshl_b32 s3, s4, 9
    s_add_u32 s65, s65, s3
    s_add_u32 s65, s65, 0x2800004
    s_mov_b32 s44, s20
    s_mov_b32 s45, s21
    s_mov_b32 s46, 0x200000
    s_mov_b32 s47, 0x00020000
    s_lshl_b32 s3, s2, 2
    s_add_u32 s3, s3, s4
    s_mul_i32 s68, s3, 7168
    v_lshlrev_b32 v98, 7, v255
    v_cmp_gt_u32 vcc, 8, v255
    v_mov_b32 v99, 0x80000000
    s_lshl_b32 s9, s3, 11
    v_cndmask_b32 v106, v99, v98, vcc
    v_cmp_gt_u32 vcc, 16, v255
    v_min_u32 v110, 15, v255
    v_lshlrev_b32 v110, 7, v110
    s_lshl_b32 s67, s4, 13
    v_cndmask_b32 v108, v99, v98, vcc
    v_and_b32 v111, 14, v255
    v_cmp_eq_u32 vcc, 0, v111
    v_mov_b32 v99, 0x3f803f80
    v_mov_b32 v102, 0xff800000
    v_cndmask_b32 v99, 0, v99, vcc
    v_mov_b32 v103, 0xff800000
    v_mov_b32 v98, 131008
    v_mov_b32_e64 v100, 0
    s_add_u32 s67, s67, 0x10000
    ds_write_b32 v98, v100
    v_accvgpr_write_b32 a216, v99
    v_accvgpr_write_b32 a217, v99
    v_cmp_eq_u32 vcc, 4, v111
    v_mov_b32 v99, 0x3f803f80
    s_nop 0
    v_cndmask_b32 v99, 0, v99, vcc
    v_accvgpr_write_b32 a218, v99
    v_accvgpr_write_b32 a219, v99
    v_and_b32 v111, 1, v255
    v_mul_u32_u24 v111, 0xaaaa, v111
    v_add_u32 v111, 0x4444, v111
    v_lshl_or_b32 v111, v111, 16, v111
    v_accvgpr_write_b32 a128, 0
    v_accvgpr_write_b32 a129, 0
    v_accvgpr_write_b32 a130, 0
    v_accvgpr_write_b32 a131, 0
    v_accvgpr_write_b32 a132, 0
    v_accvgpr_write_b32 a133, 0
    v_accvgpr_write_b32 a134, 0
    v_accvgpr_write_b32 a135, 0
    v_accvgpr_write_b32 a136, 0
    v_accvgpr_write_b32 a137, 0
    v_accvgpr_write_b32 a138, 0
    v_accvgpr_write_b32 a139, 0
    v_accvgpr_write_b32 a140, 0
    v_accvgpr_write_b32 a141, 0
    v_accvgpr_write_b32 a142, 0
    v_accvgpr_write_b32 a143, 0
    v_accvgpr_write_b32 a160, 0
    v_accvgpr_write_b32 a161, 0
    v_accvgpr_write_b32 a162, 0
    v_accvgpr_write_b32 a163, 0
    v_accvgpr_write_b32 a144, 0
    v_accvgpr_write_b32 a145, 0
    v_accvgpr_write_b32 a146, 0
    v_accvgpr_write_b32 a147, 0
    v_accvgpr_write_b32 a148, 0
    v_accvgpr_write_b32 a149, 0
    v_accvgpr_write_b32 a150, 0
    v_accvgpr_write_b32 a151, 0
    v_accvgpr_write_b32 a152, 0
    v_accvgpr_write_b32 a153, 0
    v_accvgpr_write_b32 a154, 0
    v_accvgpr_write_b32 a155, 0
    v_accvgpr_write_b32 a156, 0
    v_accvgpr_write_b32 a157, 0
    v_accvgpr_write_b32 a158, 0
    v_accvgpr_write_b32 a159, 0
    v_accvgpr_write_b32 a164, 0
    v_accvgpr_write_b32 a165, 0
    v_accvgpr_write_b32 a166, 0
    v_accvgpr_write_b32 a167, 0
    v_mov_b32_e64 v72, 0
    v_accvgpr_write_b32 a208, 0
    v_mov_b32_e64 v73, 0
    v_accvgpr_write_b32 a209, 0
    v_mov_b32_e64 v74, 0
    v_accvgpr_write_b32 a210, 0
    v_mov_b32_e64 v75, 0
    v_accvgpr_write_b32 a211, 0
    v_mov_b32_e64 v76, 0
    v_accvgpr_write_b32 a212, 0
    v_mov_b32_e64 v77, 0
    v_accvgpr_write_b32 a213, 0
    v_mov_b32_e64 v78, 0
    v_accvgpr_write_b32 a214, 0
    v_mov_b32_e64 v79, 0
    v_accvgpr_write_b32 a215, 0
    v_mov_b32_e64 v96, v254
    v_add_u32 v97, 0x8000, v96
    s_mov_b32 s64, s84
    s_add_u32 s10, s87, 131072
    s_add_u32 s11, s87, 262144
    s_cmp_eq_u32 s85, 1
    s_cbranch_scc1 AT_go
    v_min_u32 v253, 7, v255
    v_lshlrev_b32_e64 v253, 7, v253
AT_poll:
    buffer_load_dword v252, v253, s[36:39], s22 offen offset:0 sc1
    s_waitcnt vmcnt(0)
    v_cmp_eq_u32 vcc, s95, v252
    s_and_b32 s3, vcc_lo, 0xff
    s_cmp_eq_u32 s3, 0xff
    s_cbranch_scc1 AT_poll_ok
    s_sleep 1
    s_sub_u32 s12, s12, 1
    s_cmp_gt_i32 s12, 0
    s_cbranch_scc1 AT_poll
AT_poll_ok:
    s_lshl_b32 s90, s35, 17
    s_lshl_b32 s3, s7, 14
    s_add_u32 s90, s90, s3
    s_lshl_b32 s3, s4, 12
    s_add_u32 s90, s90, s3
    s_lshl_b32 s91, s35, 18
    s_add_u32 s91, s91, 0x400000
    s_lshl_b32 s92, s84, 12
    s_add_u32 s92, s92, s91
    s_nop 0
    s_sub_u32 s92, s92, 4096
    buffer_load_dwordx4 a[168:171], v254, s[36:39], s90 offen offset:0 sc1
    buffer_load_dwordx4 a[172:175], v254, s[36:39], s90 offen offset:1024 sc1
    buffer_load_dwordx4 a[176:179], v254, s[36:39], s90 offen offset:2048 sc1
    buffer_load_dwordx4 a[180:183], v254, s[36:39], s90 offen offset:3072 sc1
    buffer_load_dwordx4 a[184:187], v254, s[36:39], s92 offen offset:0 sc1
    buffer_load_dwordx4 a[188:191], v254, s[36:39], s92 offen offset:1024 sc1
    s_lshl_b32 s93, s4, 13
    s_add_u32 s91, s91, s93
    s_add_u32 m0, s93, 0
    s_add_u32 s94, s91, 0
    buffer_load_dwordx4 v254, s[36:39], s94 offen offset:0 sc1 lds
    buffer_load_dwordx4 v254, s[36:39], s94 offen offset:1024 sc1 lds
    buffer_load_dwordx4 v254, s[36:39], s94 offen offset:2048 sc1 lds
    buffer_load_dwordx4 v254, s[36:39], s94 offen offset:3072 sc1 lds
    s_add_u32 m0, s93, 4096
    s_add_u32 s94, s91, 4096
    buffer_load_dwordx4 v254, s[36:39], s94 offen offset:0 sc1 lds
    buffer_load_dwordx4 v254, s[36:39], s94 offen offset:1024 sc1 lds
    buffer_load_dwordx4 v254, s[36:39], s94 offen offset:2048 sc1 lds
    buffer_load_dwordx4 v254, s[36:39], s94 offen offset:3072 sc1 lds
AT_go:
    s_lshr_b32 s69, s4, 1
    s_and_b32 s70, s4, 1
    v_lshrrev_b32 v81, 4, v255
    v_and_b32 v82, 15, v255
    s_lshl_b32 s79, s61, 13
    s_lshl_b32 s3, s70, 12
    s_add_u32 s79, s79, s3
    s_lshl_b32 s73, s69, 15
    s_add_u32 s73, s73, s3
    s_lshl_b32 s3, s69, 17
    s_add_u32 s79, s79, s3
    s_add_u32 s79, s79, 0xc00000
    s_lshl_b32 s80, s69, 16
    s_lshl_b32 s3, s70, 15
    s_add_u32 s80, s80, s3
    s_lshl_b32 s3, s62, 8
    s_add_u32 s80, s80, s3
    s_sub_u32 s80, s80, 0x20000
    s_mul_i32 s3, s60, 9437184
    s_add_u32 s71, s79, s3
    s_add_u32 s71, s71, 4194304
    s_mul_i32 s3, s60, 4718592
    s_add_u32 s72, s80, s3
    s_cmp_eq_u32 s60, 1
    s_cselect_b32 s75, 4, 99
    s_cselect_b32 s76, 3, 99
    s_cselect_b32 s81, 8, 8
    s_lshr_b32 s3, s6, 4
    s_and_b32 s77, s3, s60
    s_add_u32 s75, s75, s77
    s_add_u32 s76, s76, s77
    s_sub_u32 s81, s81, s3
    s_lshl_b32 s3, s77, 1
    s_add_u32 s81, s81, s3
    s_lshl_b32 s3, s77, 20
    s_sub_u32 s71, s71, s3
    s_lshl_b32 s3, s77, 19
    s_sub_u32 s72, s72, s3
    s_cmp_eq_u32 s4, 0
    s_cselect_b32 s82, 1, 99
    v_lshlrev_b32 v80, 1, v81
    v_xor_b32 v80, v80, v82
    v_lshlrev_b32_e64 v80, 4, v80
    v_lshl_add_u32 v240, v81, 11, v80
    v_xor_b32 v241, 128, v240
    v_add_u32 v242, 14336, v240
    v_add_u32 v241, 7168, v241
    v_add_u32 v243, 14336, v241
    v_lshrrev_b32 v80, 2, v255
    v_and_b32 v81, 7, v80
    v_lshlrev_b32 v80, 8, v80
    v_and_b32 v82, 3, v255
    v_lshl_add_u32 v80, v82, 3, v80
    s_lshl_b32 s3, s69, 15
    v_add_u32 v80, s3, v80
    s_lshl_b32 s3, s69, 2
    v_xor_b32 v81, s3, v81
    v_xor_b32_e64 v82, 0, v81
    v_lshl_add_u32 v244, v82, 5, v80
    v_xor_b32_e64 v82, 1, v81
    v_lshl_add_u32 v245, v82, 5, v80
    v_xor_b32_e64 v82, 2, v81
    v_lshl_add_u32 v246, v82, 5, v80
    v_xor_b32_e64 v82, 3, v81
    v_lshl_add_u32 v247, v82, 5, v80
    v_xor_b32_e64 v82, 4, v81
    v_lshl_add_u32 v248, v82, 5, v80
    v_xor_b32_e64 v82, 5, v81
    v_lshl_add_u32 v249, v82, 5, v80
    v_xor_b32_e64 v82, 6, v81
    v_lshl_add_u32 v250, v82, 5, v80
    v_xor_b32_e64 v82, 7, v81
    v_lshl_add_u32 v251, v82, 5, v80
    s_waitcnt vmcnt(8)
    s_branch AT_max1
AT_maxloop:
    s_sub_u32 s92, s92, 4096
    buffer_load_dwordx4 a[184:187], v254, s[36:39], s92 offen offset:0 sc1
    buffer_load_dwordx4 a[188:191], v254, s[36:39], s92 offen offset:1024 sc1
    s_waitcnt vmcnt(0)
AT_max1:
    v_mfma_f32_32x32x16_bf16 v[0:15], a[184:187], a[168:171], 0
    v_mfma_f32_32x32x16_bf16 v[0:15], a[188:191], a[172:175], v[0:15]
    v_mfma_f32_32x32x16_bf16 v[16:31], a[184:187], a[176:179], 0
    v_mfma_f32_32x32x16_bf16 v[16:31], a[188:191], a[180:183], v[16:31]
    s_nop 9
    v_max3_f32 v102, v0, v1, v102
    v_max3_f32 v102, v2, v3, v102
    v_max3_f32 v102, v4, v5, v102
    v_max3_f32 v102, v6, v7, v102
    v_max3_f32 v102, v8, v9, v102
    v_max3_f32 v102, v10, v11, v102
    v_max3_f32 v102, v12, v13, v102
    v_max3_f32 v102, v14, v15, v102
    v_max3_f32 v103, v16, v17, v103
    v_max3_f32 v103, v18, v19, v103
    v_max3_f32 v103, v20, v21, v103
    v_max3_f32 v103, v22, v23, v103
    v_max3_f32 v103, v24, v25, v103
    v_max3_f32 v103, v26, v27, v103
    v_max3_f32 v103, v28, v29, v103
    v_max3_f32 v103, v30, v31, v103
    s_sub_u32 s64, s64, 1
    s_cmp_lg_u32 s64, 0
    s_cbranch_scc1 AT_maxloop
    v_mov_b32 v98, v102
    s_add_u32 m0, s93, 32768
    s_add_u32 s94, s91, 32768
    buffer_load_dwordx4 v254, s[36:39], s94 offen offset:0 sc1 lds
    v_mov_b32 v99, v103
    s_nop 0
    v_permlane32_swap_b32 v98, v102
    v_permlane32_swap_b32 v99, v103
    s_nop 0
    buffer_load_dwordx4 v254, s[36:39], s94 offen offset:1024 sc1 lds
    v_max_f32 v98, v98, v102
    v_max_f32 v99, v99, v103
    v_sub_f32 v32, 0, v98
    v_sub_f32 v33, 0, v98
    v_sub_f32 v34, 0, v98
    buffer_load_dwordx4 v254, s[36:39], s94 offen offset:2048 sc1 lds
    v_sub_f32 v35, 0, v98
    v_sub_f32 v36, 0, v98
    v_sub_f32 v37, 0, v98
    v_sub_f32 v38, 0, v98
    v_sub_f32_e64 v39, 0, v98
    buffer_load_dwordx4 v254, s[36:39], s94 offen offset:3072 sc1 lds
    v_sub_f32 v40, 0, v98
    v_sub_f32 v41, 0, v98
    v_sub_f32 v42, 0, v98
    v_sub_f32 v43, 0, v98
    v_sub_f32 v44, 0, v98
    v_sub_f32 v45, 0, v98
    s_add_u32 m0, s93, 36864
    s_add_u32 s94, s91, 36864
    buffer_load_dwordx4 v254, s[36:39], s94 offen offset:0 sc1 lds
    v_sub_f32 v46, 0, v98
    v_sub_f32 v47, 0, v98
    v_sub_f32 v48, 0, v99
    v_sub_f32 v49, 0, v99
    v_mfma_f32_32x32x16_bf16 v[0:15], a[184:187], a[168:171], v[32:47]
    buffer_load_dwordx4 v254, s[36:39], s94 offen offset:1024 sc1 lds
    v_sub_f32 v50, 0, v99
    v_sub_f32 v51, 0, v99
    v_sub_f32 v52, 0, v99
    v_sub_f32 v53, 0, v99
    v_sub_f32_e64 v54, 0, v99
    buffer_load_dwordx4 v254, s[36:39], s94 offen offset:2048 sc1 lds
    v_sub_f32 v55, 0, v99
    v_sub_f32 v56, 0, v99
    v_mfma_f32_32x32x16_bf16 v[0:15], a[188:191], a[172:175], v[0:15]
    v_sub_f32 v57, 0, v99
    v_sub_f32 v58, 0, v99
    buffer_load_dwordx4 v254, s[36:39], s94 offen offset:3072 sc1 lds
    v_sub_f32 v59, 0, v99
    v_sub_f32 v60, 0, v99
    v_sub_f32 v61, 0, v99
    v_sub_f32 v62, 0, v99
    v_sub_f32 v63, 0, v99
    s_waitcnt vmcnt(8) lgkmcnt(0)
    s_barrier
    s_add_u32 s91, s91, 65536
    buffer_load_dword v104, v101, s[36:39], s65 offen offset:0 sc1
    buffer_load_dword v105, v101, s[36:39], s65 offen offset:256 sc1
    s_mov_b32 s8, 0x66421042
    s_cmp_lg_u32 s86, 0
    s_cbranch_scc1 AT_loop
.p2align 6
AT_hloop:
    v_mfma_f32_32x32x16_bf16 v[16:31], a[184:187], a[176:179], v[48:63]
    s_mov_b32 m0, s67
    v_exp_f32 v0, v0
    v_exp_f32 v1, v1
    v_exp_f32 v2, v2
    v_exp_f32_e64 v3, v3
    v_mfma_f32_32x32x16_bf16 v[16:31], a[188:191], a[180:183], v[16:31]
    ds_read_b128 a[192:195], v96 offset:4096
    v_exp_f32 v4, v4
    v_exp_f32 v5, v5
    v_exp_f32 v6, v6
    v_exp_f32 v7, v7
    v_mfma_f32_32x32x16_bf16 a[144:159], a[208:211], v[72:75], a[144:159]
    ds_read_b128 a[196:199], v96 offset:5120
    v_cvt_pk_bf16_f32 v64, v0, v1
    v_cvt_pk_bf16_f32 v65, v2, v3
    v_exp_f32 v8, v8
    v_exp_f32 v9, v9
    v_cvt_pk_bf16_f32 v66, v4, v5
    v_cvt_pk_bf16_f32 v67, v6, v7
    v_smfmac_f32_16x16x64_bf16 a[164:167], a[216:219], v[72:79], v111
    ds_read_b128 a[200:203], v96 offset:2048
    v_exp_f32 v10, v10
    v_exp_f32 v11, v11
    v_exp_f32 v12, v12
    v_exp_f32 v13, v13
    v_mfma_f32_32x32x16_bf16 a[144:159], a[212:215], v[76:79], a[144:159]
    ds_read_b128 a[204:207], v96 offset:3072
    buffer_load_dwordx4 v254, s[36:39], s91 offen offset:0 sc1 lds
    v_cvt_pk_bf16_f32 v68, v8, v9
    v_cvt_pk_bf16_f32 v69, v10, v11
    v_exp_f32 v14, v14
    v_exp_f32 v15, v15
    v_cvt_pk_bf16_f32 v70, v12, v13
    v_cvt_pk_bf16_f32 v71, v14, v15
    s_waitcnt lgkmcnt(0)
    v_mfma_f32_32x32x16_bf16 v[0:15], a[192:195], a[168:171], v[32:47]
    buffer_load_dwordx4 v254, s[36:39], s91 offen offset:1024 sc1 lds
    v_exp_f32 v16, v16
    v_exp_f32 v17, v17
    v_exp_f32 v18, v18
    v_exp_f32_e64 v19, v19
    v_mfma_f32_32x32x16_bf16 v[0:15], a[196:199], a[172:175], v[0:15]
    s_add_u32 s66, s91, 4096
    v_exp_f32 v20, v20
    v_exp_f32 v21, v21
    v_exp_f32 v22, v22
    v_exp_f32 v23, v23
    v_mfma_f32_32x32x16_bf16 a[128:143], a[200:203], v[64:67], a[128:143]
    buffer_load_dword v107, v106, s[56:59], s68 offen
    v_cvt_pk_bf16_f32 v72, v16, v17
    v_cvt_pk_bf16_f32 v73, v18, v19
    v_exp_f32 v24, v24
    v_exp_f32 v25, v25
    v_cvt_pk_bf16_f32 v74, v20, v21
    v_cvt_pk_bf16_f32 v75, v22, v23
    v_smfmac_f32_16x16x64_bf16 a[160:163], a[216:219], v[64:71], v111
    s_add_u32 s68, s68, 1024
    v_exp_f32 v26, v26
    v_exp_f32 v27, v27
    v_exp_f32 v28, v28
    v_exp_f32 v29, v29
    v_mfma_f32_32x32x16_bf16 a[128:143], a[204:207], v[68:71], a[128:143]
    v_cvt_pk_bf16_f32 v76, v24, v25
    v_cvt_pk_bf16_f32 v77, v26, v27
    v_exp_f32 v30, v30
    v_exp_f32 v31, v31
    v_cvt_pk_bf16_f32 v78, v28, v29
    v_cvt_pk_bf16_f32 v79, v30, v31
    v_mfma_f32_32x32x16_bf16 v[16:31], a[192:195], a[176:179], v[48:63]
    ds_read_b128 a[184:187], v96 offset:8192
    v_exp_f32 v0, v0
    v_exp_f32 v1, v1
    v_exp_f32 v2, v2
    v_exp_f32 v3, v3
    v_mfma_f32_32x32x16_bf16 v[16:31], a[196:199], a[180:183], v[16:31]
    ds_read_b128 a[188:191], v96 offset:9216
    v_exp_f32 v4, v4
    v_exp_f32 v5, v5
    v_exp_f32 v6, v6
    v_exp_f32 v7, v7
    v_mfma_f32_32x32x16_bf16 a[144:159], a[200:203], v[72:75], a[144:159]
    ds_read_b128 a[208:211], v96 offset:6144
    v_cvt_pk_bf16_f32 v64, v0, v1
    v_cvt_pk_bf16_f32 v65, v2, v3
    v_exp_f32 v8, v8
    v_exp_f32 v9, v9
    v_cvt_pk_bf16_f32 v66, v4, v5
    v_cvt_pk_bf16_f32 v67, v6, v7
    v_smfmac_f32_16x16x64_bf16 a[164:167], a[216:219], v[72:79], v111
    ds_read_b128 a[212:215], v96 offset:7168
    v_exp_f32 v10, v10
    v_exp_f32 v11, v11
    v_exp_f32 v12, v12
    v_exp_f32 v13, v13
    v_mfma_f32_32x32x16_bf16 a[144:159], a[204:207], v[76:79], a[144:159]
    buffer_load_dwordx4 v254, s[36:39], s91 offen offset:2048 sc1 lds
    v_cvt_pk_bf16_f32 v68, v8, v9
    v_cvt_pk_bf16_f32 v69, v10, v11
    v_exp_f32 v14, v14
    v_exp_f32 v15, v15
    v_cvt_pk_bf16_f32 v70, v12, v13
    v_cvt_pk_bf16_f32 v71, v14, v15
    s_waitcnt lgkmcnt(0)
    v_mfma_f32_32x32x16_bf16 v[0:15], a[184:187], a[168:171], v[32:47]
    buffer_load_dwordx4 v254, s[36:39], s91 offen offset:3072 sc1 lds
    v_exp_f32 v16, v16
    v_exp_f32 v17, v17
    v_exp_f32 v18, v18
    v_exp_f32_e64 v19, v19
    v_mfma_f32_32x32x16_bf16 v[0:15], a[188:191], a[172:175], v[0:15]
    v_exp_f32 v20, v20
    v_exp_f32 v21, v21
    v_exp_f32 v22, v22
    v_exp_f32 v23, v23
    v_mfma_f32_32x32x16_bf16 a[128:143], a[208:211], v[64:67], a[128:143]
    v_cvt_pk_bf16_f32 v72, v16, v17
    v_cvt_pk_bf16_f32 v73, v18, v19
    v_exp_f32 v24, v24
    v_exp_f32 v25, v25
    v_cvt_pk_bf16_f32 v74, v20, v21
    v_cvt_pk_bf16_f32 v75, v22, v23
    v_smfmac_f32_16x16x64_bf16 a[160:163], a[216:219], v[64:71], v111
    v_exp_f32 v26, v26
    v_exp_f32 v27, v27
    v_exp_f32 v28, v28
    v_exp_f32 v29, v29
    v_mfma_f32_32x32x16_bf16 a[128:143], a[212:215], v[68:71], a[128:143]
    v_cvt_pk_bf16_f32 v76, v24, v25
    v_cvt_pk_bf16_f32 v77, v26, v27
    v_exp_f32 v30, v30
    v_exp_f32 v31, v31
    v_cvt_pk_bf16_f32 v78, v28, v29
    v_cvt_pk_bf16_f32 v79, v30, v31
    s_set_gpr_idx_on s86, gpr_idx(SRC0)
    v_mov_b32 v80, v112
    v_mov_b32 v81, v113
    v_mov_b32 v82, v114
    v_mov_b32 v83, v115
    v_mov_b32 v84, v116
    v_mov_b32 v85, v117
    v_mov_b32 v86, v118
    v_mov_b32 v87, v119
    v_mov_b32 v88, v120
    v_mov_b32 v89, v121
    v_mov_b32 v90, v122
    v_mov_b32 v91, v123
    v_mov_b32 v92, v124
    v_mov_b32 v93, v125
    s_set_gpr_idx_off
    s_add_u32 s86, s86, 14
    v_mfma_f32_32x32x16_bf16 v[16:31], a[184:187], a[176:179], v[48:63]
    s_add_u32 m0, s67, 4096
    v_exp_f32 v0, v0
    v_exp_f32 v1, v1
    v_exp_f32 v2, v2
    v_exp_f32_e64 v3, v3
    v_mfma_f32_32x32x16_bf16 v[16:31], a[188:191], a[180:183], v[16:31]
    ds_read_b128 a[192:195], v96 offset:12288
    v_exp_f32 v4, v4
    v_exp_f32 v5, v5
    v_exp_f32 v6, v6
    v_exp_f32 v7, v7
    v_mfma_f32_32x32x16_bf16 a[144:159], a[208:211], v[72:75], a[144:159]
    ds_read_b128 a[196:199], v96 offset:13312
    v_cvt_pk_bf16_f32 v64, v0, v1
    v_cvt_pk_bf16_f32 v65, v2, v3
    v_exp_f32 v8, v8
    v_exp_f32 v9, v9
    v_cvt_pk_bf16_f32 v66, v4, v5
    v_cvt_pk_bf16_f32 v67, v6, v7
    v_smfmac_f32_16x16x64_bf16 a[164:167], a[216:219], v[72:79], v111
    ds_read_b128 a[200:203], v96 offset:10240
    v_exp_f32 v10, v10
    v_exp_f32 v11, v11
    v_exp_f32 v12, v12
    v_exp_f32 v13, v13
    v_mfma_f32_32x32x16_bf16 a[144:159], a[212:215], v[76:79], a[144:159]
    ds_read_b128 a[204:207], v96 offset:11264
    buffer_load_dwordx4 v254, s[36:39], s66 offen offset:0 sc1 lds
    v_cvt_pk_bf16_f32 v68, v8, v9
    v_cvt_pk_bf16_f32 v69, v10, v11
    v_exp_f32 v14, v14
    v_exp_f32 v15, v15
    v_cvt_pk_bf16_f32 v70, v12, v13
    v_cvt_pk_bf16_f32 v71, v14, v15
    s_waitcnt lgkmcnt(0)
    v_mfma_f32_32x32x16_bf16 v[0:15], a[192:195], a[168:171], v[32:47]
    buffer_load_dwordx4 v254, s[36:39], s66 offen offset:1024 sc1 lds
    v_exp_f32 v16, v16
    v_exp_f32 v17, v17
    v_exp_f32 v18, v18
    v_exp_f32_e64 v19, v19
    v_mfma_f32_32x32x16_bf16 v[0:15], a[196:199], a[172:175], v[0:15]
    buffer_store_dwordx4 v[80:83], v254, s[36:39], s87 offen offset:0 sc1
    v_exp_f32 v20, v20
    v_exp_f32 v21, v21
    v_exp_f32 v22, v22
    v_exp_f32 v23, v23
    v_mfma_f32_32x32x16_bf16 a[128:143], a[200:203], v[64:67], a[128:143]
    v_cvt_pk_bf16_f32 v72, v16, v17
    v_cvt_pk_bf16_f32 v73, v18, v19
    v_exp_f32 v24, v24
    v_exp_f32 v25, v25
    v_cvt_pk_bf16_f32 v74, v20, v21
    v_cvt_pk_bf16_f32 v75, v22, v23
    v_smfmac_f32_16x16x64_bf16 a[160:163], a[216:219], v[64:71], v111
    v_exp_f32 v26, v26
    v_exp_f32 v27, v27
    v_exp_f32 v28, v28
    v_exp_f32 v29, v29
    v_mfma_f32_32x32x16_bf16 a[128:143], a[204:207], v[68:71], a[128:143]
    v_cvt_pk_bf16_f32 v76, v24, v25
    v_cvt_pk_bf16_f32 v77, v26, v27
    v_exp_f32 v30, v30
    v_exp_f32 v31, v31
    v_cvt_pk_bf16_f32 v78, v28, v29
    v_cvt_pk_bf16_f32 v79, v30, v31
    v_mfma_f32_32x32x16_bf16 v[16:31], a[192:195], a[176:179], v[48:63]
    ds_read_b128 a[184:187], v96 offset:16384
    v_exp_f32 v0, v0
    v_exp_f32 v1, v1
    v_exp_f32 v2, v2
    v_exp_f32 v3, v3
    v_mfma_f32_32x32x16_bf16 v[16:31], a[196:199], a[180:183], v[16:31]
    ds_read_b128 a[188:191], v96 offset:17408
    v_exp_f32 v4, v4
    v_exp_f32 v5, v5
    v_exp_f32 v6, v6
    v_exp_f32 v7, v7
    v_mfma_f32_32x32x16_bf16 a[144:159], a[200:203], v[72:75], a[144:159]
    ds_read_b128 a[208:211], v96 offset:14336
    v_cvt_pk_bf16_f32 v64, v0, v1
    v_cvt_pk_bf16_f32 v65, v2, v3
    v_exp_f32 v8, v8
    v_exp_f32 v9, v9
    v_cvt_pk_bf16_f32 v66, v4, v5
    v_cvt_pk_bf16_f32 v67, v6, v7
    v_smfmac_f32_16x16x64_bf16 a[164:167], a[216:219], v[72:79], v111
    ds_read_b128 a[212:215], v96 offset:15360
    v_exp_f32 v10, v10
    v_exp_f32 v11, v11
    v_exp_f32 v12, v12
    v_exp_f32 v13, v13
    v_mfma_f32_32x32x16_bf16 a[144:159], a[204:207], v[76:79], a[144:159]
    buffer_load_dwordx4 v254, s[36:39], s66 offen offset:2048 sc1 lds
    v_cvt_pk_bf16_f32 v68, v8, v9
    v_cvt_pk_bf16_f32 v69, v10, v11
    v_exp_f32 v14, v14
    v_exp_f32 v15, v15
    v_cvt_pk_bf16_f32 v70, v12, v13
    v_cvt_pk_bf16_f32 v71, v14, v15
    s_waitcnt lgkmcnt(0)
    v_mfma_f32_32x32x16_bf16 v[0:15], a[184:187], a[168:171], v[32:47]
    buffer_load_dwordx4 v254, s[36:39], s66 offen offset:3072 sc1 lds
    v_exp_f32 v16, v16
    v_exp_f32 v17, v17
    v_exp_f32 v18, v18
    v_exp_f32_e64 v19, v19
    v_mfma_f32_32x32x16_bf16 v[0:15], a[188:191], a[172:175], v[0:15]
    buffer_store_dwordx4 v[84:87], v254, s[36:39], s10 offen offset:0 sc1
    v_exp_f32 v20, v20
    v_exp_f32 v21, v21
    v_exp_f32 v22, v22
    v_exp_f32 v23, v23
    v_mfma_f32_32x32x16_bf16 a[128:143], a[208:211], v[64:67], a[128:143]
    v_cvt_pk_bf16_f32 v72, v16, v17
    v_cvt_pk_bf16_f32 v73, v18, v19
    v_exp_f32 v24, v24
    v_exp_f32 v25, v25
    v_cvt_pk_bf16_f32 v74, v20, v21
    v_cvt_pk_bf16_f32 v75, v22, v23
    v_smfmac_f32_16x16x64_bf16 a[160:163], a[216:219], v[64:71], v111
    v_exp_f32 v26, v26
    v_exp_f32 v27, v27
    v_exp_f32 v28, v28
    v_exp_f32 v29, v29
    v_mfma_f32_32x32x16_bf16 a[128:143], a[212:215], v[68:71], a[128:143]
    v_cvt_pk_bf16_f32 v76, v24, v25
    v_cvt_pk_bf16_f32 v77, v26, v27
    v_exp_f32 v30, v30
    v_exp_f32 v31, v31
    v_cvt_pk_bf16_f32 v78, v28, v29
    v_cvt_pk_bf16_f32 v79, v30, v31
    v_mfma_f32_32x32x16_bf16 v[16:31], a[184:187], a[176:179], v[48:63]
    ds_read_b128 a[192:195], v96 offset:20480
    v_exp_f32 v0, v0
    v_exp_f32 v1, v1
    v_exp_f32 v2, v2
    v_exp_f32 v3, v3
    v_mfma_f32_32x32x16_bf16 v[16:31], a[188:191], a[180:183], v[16:31]
    ds_read_b128 a[196:199], v96 offset:21504
    v_exp_f32 v4, v4
    v_exp_f32 v5, v5
    v_exp_f32 v6, v6
    v_exp_f32 v7, v7
    v_mfma_f32_32x32x16_bf16 a[144:159], a[208:211], v[72:75], a[144:159]
    ds_read_b128 a[200:203], v96 offset:18432
    v_cvt_pk_bf16_f32 v64, v0, v1
    v_cvt_pk_bf16_f32 v65, v2, v3
    v_exp_f32 v8, v8
    v_exp_f32 v9, v9
    v_cvt_pk_bf16_f32 v66, v4, v5
    v_cvt_pk_bf16_f32 v67, v6, v7
    v_smfmac_f32_16x16x64_bf16 a[164:167], a[216:219], v[72:79], v111
    ds_read_b128 a[204:207], v96 offset:19456
    v_exp_f32 v10, v10
    v_exp_f32 v11, v11
    v_exp_f32 v12, v12
    v_exp_f32 v13, v13
    v_mfma_f32_32x32x16_bf16 a[144:159], a[212:215], v[76:79], a[144:159]
    buffer_store_dwordx4 v[88:91], v254, s[36:39], s11 offen offset:0 sc1
    buffer_store_dwordx2 v[92:93], v254, s[36:39], s88 offen offset:0 sc1
    v_cvt_pk_bf16_f32 v68, v8, v9
    v_cvt_pk_bf16_f32 v69, v10, v11
    v_exp_f32 v14, v14
    v_exp_f32 v15, v15
    v_cvt_pk_bf16_f32 v70, v12, v13
    v_cvt_pk_bf16_f32 v71, v14, v15
    s_waitcnt lgkmcnt(0)
    v_mfma_f32_32x32x16_bf16 v[0:15], a[192:195], a[168:171], v[32:47]
    s_sub_u32 s94, s67, s93
    v_exp_f32 v16, v16
    v_exp_f32 v17, v17
    v_exp_f32 v18, v18
    v_exp_f32 v19, v19
    v_mfma_f32_32x32x16_bf16 v[0:15], a[196:199], a[172:175], v[0:15]
    s_add_u32 s91, s91, 0x8000
    v_exp_f32 v20, v20
    v_exp_f32 v21, v21
    v_exp_f32 v22, v22
    v_exp_f32 v23, v23
    v_mfma_f32_32x32x16_bf16 a[128:143], a[200:203], v[64:67], a[128:143]
    s_lshr_b32 s8, s8, 4
    v_cvt_pk_bf16_f32 v72, v16, v17
    v_cvt_pk_bf16_f32 v73, v18, v19
    v_exp_f32 v24, v24
    v_exp_f32_e64 v25, v25
    v_cvt_pk_bf16_f32 v74, v20, v21
    v_cvt_pk_bf16_f32 v75, v22, v23
    v_smfmac_f32_16x16x64_bf16 a[160:163], a[216:219], v[64:71], v111
    s_and_b32 s3, s8, 15
    v_exp_f32 v26, v26
    v_exp_f32 v27, v27
    v_exp_f32 v28, v28
    v_exp_f32_e64 v29, v29
    v_mfma_f32_32x32x16_bf16 a[128:143], a[204:207], v[68:71], a[128:143]
    s_lshl_b32 s3, s3, 15
    s_add_u32 s67, s3, s93
    v_cvt_pk_bf16_f32 v76, v24, v25
    v_cvt_pk_bf16_f32 v77, v26, v27
    v_exp_f32 v30, v30
    v_exp_f32 v31, v31
    v_cvt_pk_bf16_f32 v78, v28, v29
    v_cvt_pk_bf16_f32 v79, v30, v31
    s_set_gpr_idx_on s86, gpr_idx(SRC0)
    v_mov_b32 v80, v112
    v_mov_b32 v81, v113
    v_mov_b32 v82, v114
    v_mov_b32 v83, v115
    v_mov_b32 v84, v116
    v_mov_b32 v85, v117
    v_mov_b32 v86, v118
    v_mov_b32 v87, v119
    v_mov_b32 v88, v120
    v_mov_b32 v89, v121
    v_mov_b32 v90, v122
    v_mov_b32 v91, v123
    v_mov_b32 v92, v124
    v_mov_b32 v93, v125
    s_set_gpr_idx_off
    s_add_u32 s86, s86, 14
    v_mfma_f32_32x32x16_bf16 v[16:31], a[192:195], a[176:179], v[48:63]
    ds_read_b128 a[184:187], v96 offset:24576
    v_exp_f32 v0, v0
    v_exp_f32 v1, v1
    v_exp_f32 v2, v2
    v_exp_f32_e64 v3, v3
    v_mfma_f32_32x32x16_bf16 v[16:31], a[196:199], a[180:183], v[16:31]
    ds_read_b128 a[188:191], v96 offset:25600
    v_exp_f32 v4, v4
    v_exp_f32 v5, v5
    v_exp_f32 v6, v6
    v_exp_f32 v7, v7
    v_mfma_f32_32x32x16_bf16 a[144:159], a[200:203], v[72:75], a[144:159]
    ds_read_b128 a[208:211], v96 offset:22528
    v_cvt_pk_bf16_f32 v64, v0, v1
    v_cvt_pk_bf16_f32 v65, v2, v3
    v_exp_f32 v8, v8
    v_exp_f32 v9, v9
    v_cvt_pk_bf16_f32 v66, v4, v5
    v_cvt_pk_bf16_f32 v67, v6, v7
    v_smfmac_f32_16x16x64_bf16 a[164:167], a[216:219], v[72:79], v111
    ds_read_b128 a[212:215], v96 offset:23552
    v_exp_f32 v10, v10
    v_exp_f32 v11, v11
    v_exp_f32 v12, v12
    v_exp_f32 v13, v13
    v_mfma_f32_32x32x16_bf16 a[144:159], a[204:207], v[76:79], a[144:159]
    buffer_store_dwordx4 v[80:83], v254, s[36:39], s87 offen offset:1024 sc1
    v_cvt_pk_bf16_f32 v68, v8, v9
    v_cvt_pk_bf16_f32 v69, v10, v11
    v_exp_f32 v14, v14
    v_exp_f32 v15, v15
    v_cvt_pk_bf16_f32 v70, v12, v13
    v_cvt_pk_bf16_f32 v71, v14, v15
    s_waitcnt lgkmcnt(0)
    v_mfma_f32_32x32x16_bf16 v[0:15], a[184:187], a[168:171], v[32:47]
    buffer_store_dwordx4 v[84:87], v254, s[36:39], s10 offen offset:1024 sc1
    v_exp_f32 v16, v16
    v_exp_f32 v17, v17
    v_exp_f32 v18, v18
    v_exp_f32_e64 v19, v19
    v_mfma_f32_32x32x16_bf16 v[0:15], a[188:191], a[172:175], v[0:15]
    v_exp_f32 v20, v20
    v_exp_f32 v21, v21
    v_exp_f32 v22, v22
    v_exp_f32 v23, v23
    v_mfma_f32_32x32x16_bf16 a[128:143], a[208:211], v[64:67], a[128:143]
    v_cvt_pk_bf16_f32 v72, v16, v17
    v_cvt_pk_bf16_f32 v73, v18, v19
    v_exp_f32 v24, v24
    v_exp_f32 v25, v25
    v_cvt_pk_bf16_f32 v74, v20, v21
    v_cvt_pk_bf16_f32 v75, v22, v23
    v_smfmac_f32_16x16x64_bf16 a[160:163], a[216:219], v[64:71], v111
    v_exp_f32 v26, v26
    v_exp_f32 v27, v27
    v_exp_f32 v28, v28
    v_exp_f32 v29, v29
    v_mfma_f32_32x32x16_bf16 a[128:143], a[212:215], v[68:71], a[128:143]
    v_cvt_pk_bf16_f32 v76, v24, v25
    v_cvt_pk_bf16_f32 v77, v26, v27
    v_exp_f32 v30, v30
    v_exp_f32 v31, v31
    v_cvt_pk_bf16_f32 v78, v28, v29
    v_cvt_pk_bf16_f32 v79, v30, v31
    v_mfma_f32_32x32x16_bf16 v[16:31], a[184:187], a[176:179], v[48:63]
    ds_read_b128 a[192:195], v96 offset:28672
    v_exp_f32 v0, v0
    v_exp_f32 v1, v1
    v_exp_f32 v2, v2
    v_exp_f32 v3, v3
    v_mfma_f32_32x32x16_bf16 v[16:31], a[188:191], a[180:183], v[16:31]
    ds_read_b128 a[196:199], v96 offset:29696
    v_exp_f32 v4, v4
    v_exp_f32 v5, v5
    v_exp_f32 v6, v6
    v_exp_f32 v7, v7
    v_mfma_f32_32x32x16_bf16 a[144:159], a[208:211], v[72:75], a[144:159]
    ds_read_b128 a[200:203], v96 offset:26624
    v_cvt_pk_bf16_f32 v64, v0, v1
    v_cvt_pk_bf16_f32 v65, v2, v3
    v_exp_f32 v8, v8
    v_exp_f32 v9, v9
    v_cvt_pk_bf16_f32 v66, v4, v5
    v_cvt_pk_bf16_f32 v67, v6, v7
    v_smfmac_f32_16x16x64_bf16 a[164:167], a[216:219], v[72:79], v111
    ds_read_b128 a[204:207], v96 offset:27648
    v_exp_f32 v10, v10
    v_exp_f32 v11, v11
    v_exp_f32 v12, v12
    v_exp_f32 v13, v13
    v_mfma_f32_32x32x16_bf16 a[144:159], a[212:215], v[76:79], a[144:159]
    buffer_store_dwordx4 v[88:91], v254, s[36:39], s11 offen offset:1024 sc1
    v_cvt_pk_bf16_f32 v68, v8, v9
    v_cvt_pk_bf16_f32 v69, v10, v11
    v_exp_f32 v14, v14
    v_exp_f32 v15, v15
    v_cvt_pk_bf16_f32 v70, v12, v13
    v_cvt_pk_bf16_f32 v71, v14, v15
    s_waitcnt lgkmcnt(0)
    v_mfma_f32_32x32x16_bf16 v[0:15], a[192:195], a[168:171], v[32:47]
    buffer_store_dwordx2 v[92:93], v254, s[36:39], s88 offen offset:1024 sc1
    v_exp_f32 v16, v16
    v_exp_f32 v17, v17
    v_exp_f32 v18, v18
    v_exp_f32_e64 v19, v19
    v_mfma_f32_32x32x16_bf16 v[0:15], a[196:199], a[172:175], v[0:15]
    v_exp_f32 v20, v20
    v_exp_f32 v21, v21
    v_exp_f32 v22, v22
    v_exp_f32 v23, v23
    v_mfma_f32_32x32x16_bf16 a[128:143], a[200:203], v[64:67], a[128:143]
    v_cvt_pk_bf16_f32 v72, v16, v17
    v_cvt_pk_bf16_f32 v73, v18, v19
    v_exp_f32 v24, v24
    v_exp_f32 v25, v25
    v_cvt_pk_bf16_f32 v74, v20, v21
    v_cvt_pk_bf16_f32 v75, v22, v23
    v_smfmac_f32_16x16x64_bf16 a[160:163], a[216:219], v[64:71], v111
    v_exp_f32 v26, v26
    v_exp_f32 v27, v27
    v_exp_f32 v28, v28
    v_exp_f32 v29, v29
    v_mfma_f32_32x32x16_bf16 a[128:143], a[204:207], v[68:71], a[128:143]
    v_cvt_pk_bf16_f32 v76, v24, v25
    v_cvt_pk_bf16_f32 v77, v26, v27
    v_exp_f32 v30, v30
    v_exp_f32 v31, v31
    v_cvt_pk_bf16_f32 v78, v28, v29
    v_cvt_pk_bf16_f32 v79, v30, v31
    s_waitcnt vmcnt(17)
    s_barrier
    v_mfma_f32_32x32x16_bf16 v[16:31], a[192:195], a[176:179], v[48:63]
    ds_read_b128 a[184:187], v97 offset:0
    v_exp_f32 v0, v0
    v_exp_f32 v1, v1
    v_exp_f32 v2, v2
    v_exp_f32 v3, v3
    v_mfma_f32_32x32x16_bf16 v[16:31], a[196:199], a[180:183], v[16:31]
    ds_read_b128 a[188:191], v97 offset:1024
    v_exp_f32 v4, v4
    v_exp_f32 v5, v5
    v_exp_f32 v6, v6
    v_exp_f32 v7, v7
    v_mfma_f32_32x32x16_bf16 a[144:159], a[200:203], v[72:75], a[144:159]
    ds_read_b128 a[208:211], v96 offset:30720
    v_cvt_pk_bf16_f32 v64, v0, v1
    v_cvt_pk_bf16_f32 v65, v2, v3
    v_exp_f32 v8, v8
    v_exp_f32 v9, v9
    v_cvt_pk_bf16_f32 v66, v4, v5
    v_cvt_pk_bf16_f32 v67, v6, v7
    v_smfmac_f32_16x16x64_bf16 a[164:167], a[216:219], v[72:79], v111
    ds_read_b128 a[212:215], v96 offset:31744
    v_exp_f32 v10, v10
    v_exp_f32 v11, v11
    v_exp_f32 v12, v12
    v_exp_f32 v13, v13
    v_mfma_f32_32x32x16_bf16 a[144:159], a[204:207], v[76:79], a[144:159]
    s_add_u32 s87, s87, 2048
    s_add_u32 s10, s10, 2048
    v_cvt_pk_bf16_f32 v68, v8, v9
    v_cvt_pk_bf16_f32 v69, v10, v11
    v_exp_f32 v14, v14
    v_exp_f32 v15, v15
    v_cvt_pk_bf16_f32 v70, v12, v13
    v_cvt_pk_bf16_f32 v71, v14, v15
    s_waitcnt lgkmcnt(0)
    v_mfma_f32_32x32x16_bf16 v[0:15], a[184:187], a[168:171], v[32:47]
    v_mov_b32 v96, v97
    v_exp_f32 v16, v16
    v_exp_f32 v17, v17
    v_exp_f32 v18, v18
    v_exp_f32 v19, v19
    v_mfma_f32_32x32x16_bf16 v[0:15], a[188:191], a[172:175], v[0:15]
    v_add_u32 v97, s94, v254
    v_exp_f32 v20, v20
    v_exp_f32 v21, v21
    v_exp_f32 v22, v22
    v_exp_f32_e64 v23, v23
    v_mfma_f32_32x32x16_bf16 a[128:143], a[208:211], v[64:67], a[128:143]
    s_add_u32 s11, s11, 2048
    v_cvt_pk_bf16_f32 v72, v16, v17
    v_cvt_pk_bf16_f32 v73, v18, v19
    v_exp_f32 v24, v24
    v_exp_f32 v25, v25
    v_cvt_pk_bf16_f32 v74, v20, v21
    v_cvt_pk_bf16_f32 v75, v22, v23
    v_smfmac_f32_16x16x64_bf16 a[160:163], a[216:219], v[64:71], v111
    s_add_u32 s88, s88, 2048
    v_exp_f32 v26, v26
    v_exp_f32 v27, v27
    v_exp_f32 v28, v28
    v_exp_f32 v29, v29
    v_mfma_f32_32x32x16_bf16 a[128:143], a[212:215], v[68:71], a[128:143]
    s_add_u32 s64, s64, 1
    s_cmp_lt_u32 s64, 4
    v_cvt_pk_bf16_f32 v76, v24, v25
    v_cvt_pk_bf16_f32 v77, v26, v27
    v_exp_f32 v30, v30
    v_exp_f32 v31, v31
    v_cvt_pk_bf16_f32 v78, v28, v29
    v_cvt_pk_bf16_f32 v79, v30, v31
    s_cbranch_scc1 AT_hloop
.p2align 6
AT_loop:
    v_mfma_f32_32x32x16_bf16 v[16:31], a[184:187], a[176:179], v[48:63]
    s_mov_b32 m0, s67
    v_exp_f32 v0, v0
    v_exp_f32 v1, v1
    v_exp_f32 v2, v2
    v_exp_f32_e64 v3, v3
    v_mfma_f32_32x32x16_bf16 v[16:31], a[188:191], a[180:183], v[16:31]
    ds_read_b128 a[192:195], v96 offset:4096
    v_exp_f32 v4, v4
    v_exp_f32 v5, v5
    v_exp_f32 v6, v6
    v_exp_f32 v7, v7
    v_mfma_f32_32x32x16_bf16 a[144:159], a[208:211], v[72:75], a[144:159]
    ds_read_b128 a[196:199], v96 offset:5120
    v_cvt_pk_bf16_f32 v64, v0, v1
    v_cvt_pk_bf16_f32 v65, v2, v3
    v_exp_f32 v8, v8
    v_exp_f32 v9, v9
    v_cvt_pk_bf16_f32 v66, v4, v5
    v_cvt_pk_bf16_f32 v67, v6, v7
    v_smfmac_f32_16x16x64_bf16 a[164:167], a[216:219], v[72:79], v111
    ds_read_b128 a[200:203], v96 offset:2048
    v_exp_f32 v10, v10
    v_exp_f32 v11, v11
    v_exp_f32 v12, v12
    v_exp_f32 v13, v13
    v_mfma_f32_32x32x16_bf16 a[144:159], a[212:215], v[76:79], a[144:159]
    ds_read_b128 a[204:207], v96 offset:3072
    buffer_load_dwordx4 v254, s[36:39], s91 offen offset:0 sc1 lds
    v_cvt_pk_bf16_f32 v68, v8, v9
    v_cvt_pk_bf16_f32 v69, v10, v11
    v_exp_f32 v14, v14
    v_exp_f32 v15, v15
    v_cvt_pk_bf16_f32 v70, v12, v13
    v_cvt_pk_bf16_f32 v71, v14, v15
    s_waitcnt lgkmcnt(0)
    v_mfma_f32_32x32x16_bf16 v[0:15], a[192:195], a[168:171], v[32:47]
    buffer_load_dwordx4 v254, s[36:39], s91 offen offset:1024 sc1 lds
    v_exp_f32 v16, v16
    v_exp_f32 v17, v17
    v_exp_f32 v18, v18
    v_exp_f32_e64 v19, v19
    v_mfma_f32_32x32x16_bf16 v[0:15], a[196:199], a[172:175], v[0:15]
    s_add_u32 s66, s91, 4096
    v_exp_f32 v20, v20
    v_exp_f32 v21, v21
    v_exp_f32 v22, v22
    v_exp_f32 v23, v23
    v_mfma_f32_32x32x16_bf16 a[128:143], a[200:203], v[64:67], a[128:143]
    buffer_load_dword v107, v106, s[56:59], s68 offen
    v_cvt_pk_bf16_f32 v72, v16, v17
    v_cvt_pk_bf16_f32 v73, v18, v19
    v_exp_f32 v24, v24
    v_exp_f32 v25, v25
    v_cvt_pk_bf16_f32 v74, v20, v21
    v_cvt_pk_bf16_f32 v75, v22, v23
    v_smfmac_f32_16x16x64_bf16 a[160:163], a[216:219], v[64:71], v111
    s_add_u32 s68, s68, 1024
    v_exp_f32 v26, v26
    v_exp_f32 v27, v27
    v_exp_f32 v28, v28
    v_exp_f32 v29, v29
    v_mfma_f32_32x32x16_bf16 a[128:143], a[204:207], v[68:71], a[128:143]
    v_cvt_pk_bf16_f32 v76, v24, v25
    v_cvt_pk_bf16_f32 v77, v26, v27
    v_exp_f32 v30, v30
    v_exp_f32 v31, v31
    v_cvt_pk_bf16_f32 v78, v28, v29
    v_cvt_pk_bf16_f32 v79, v30, v31
    v_mfma_f32_32x32x16_bf16 v[16:31], a[192:195], a[176:179], v[48:63]
    ds_read_b128 a[184:187], v96 offset:8192
    v_exp_f32 v0, v0
    v_exp_f32 v1, v1
    v_exp_f32 v2, v2
    v_exp_f32 v3, v3
    v_mfma_f32_32x32x16_bf16 v[16:31], a[196:199], a[180:183], v[16:31]
    ds_read_b128 a[188:191], v96 offset:9216
    v_exp_f32 v4, v4
    v_exp_f32 v5, v5
    v_exp_f32 v6, v6
    v_exp_f32 v7, v7
    v_mfma_f32_32x32x16_bf16 a[144:159], a[200:203], v[72:75], a[144:159]
    ds_read_b128 a[208:211], v96 offset:6144
    v_cvt_pk_bf16_f32 v64, v0, v1
    v_cvt_pk_bf16_f32 v65, v2, v3
    v_exp_f32 v8, v8
    v_exp_f32 v9, v9
    v_cvt_pk_bf16_f32 v66, v4, v5
    v_cvt_pk_bf16_f32 v67, v6, v7
    v_smfmac_f32_16x16x64_bf16 a[164:167], a[216:219], v[72:79], v111
    ds_read_b128 a[212:215], v96 offset:7168
    v_exp_f32 v10, v10
    v_exp_f32 v11, v11
    v_exp_f32 v12, v12
    v_exp_f32 v13, v13
    v_mfma_f32_32x32x16_bf16 a[144:159], a[204:207], v[76:79], a[144:159]
    buffer_load_dwordx4 v254, s[36:39], s91 offen offset:2048 sc1 lds
    v_cvt_pk_bf16_f32 v68, v8, v9
    v_cvt_pk_bf16_f32 v69, v10, v11
    v_exp_f32 v14, v14
    v_exp_f32 v15, v15
    v_cvt_pk_bf16_f32 v70, v12, v13
    v_cvt_pk_bf16_f32 v71, v14, v15
    s_waitcnt lgkmcnt(0)
    v_mfma_f32_32x32x16_bf16 v[0:15], a[184:187], a[168:171], v[32:47]
    buffer_load_dwordx4 v254, s[36:39], s91 offen offset:3072 sc1 lds
    v_exp_f32 v16, v16
    v_exp_f32 v17, v17
    v_exp_f32 v18, v18
    v_exp_f32_e64 v19, v19
    v_mfma_f32_32x32x16_bf16 v[0:15], a[188:191], a[172:175], v[0:15]
    v_exp_f32 v20, v20
    v_exp_f32 v21, v21
    v_exp_f32 v22, v22
    v_exp_f32 v23, v23
    v_mfma_f32_32x32x16_bf16 a[128:143], a[208:211], v[64:67], a[128:143]
    v_cvt_pk_bf16_f32 v72, v16, v17
    v_cvt_pk_bf16_f32 v73, v18, v19
    v_exp_f32 v24, v24
    v_exp_f32 v25, v25
    v_cvt_pk_bf16_f32 v74, v20, v21
    v_cvt_pk_bf16_f32 v75, v22, v23
    v_smfmac_f32_16x16x64_bf16 a[160:163], a[216:219], v[64:71], v111
    v_exp_f32 v26, v26
    v_exp_f32 v27, v27
    v_exp_f32 v28, v28
    v_exp_f32 v29, v29
    v_mfma_f32_32x32x16_bf16 a[128:143], a[212:215], v[68:71], a[128:143]
    v_cvt_pk_bf16_f32 v76, v24, v25
    v_cvt_pk_bf16_f32 v77, v26, v27
    v_exp_f32 v30, v30
    v_exp_f32 v31, v31
    v_cvt_pk_bf16_f32 v78, v28, v29
    v_cvt_pk_bf16_f32 v79, v30, v31
    v_mfma_f32_32x32x16_bf16 v[16:31], a[184:187], a[176:179], v[48:63]
    s_add_u32 m0, s67, 4096
    v_exp_f32 v0, v0
    v_exp_f32 v1, v1
    v_exp_f32 v2, v2
    v_exp_f32 v3, v3
    v_mfma_f32_32x32x16_bf16 v[16:31], a[188:191], a[180:183], v[16:31]
    ds_read_b128 a[192:195], v96 offset:12288
    v_exp_f32 v4, v4
    v_exp_f32 v5, v5
    v_exp_f32 v6, v6
    v_exp_f32 v7, v7
    v_mfma_f32_32x32x16_bf16 a[144:159], a[208:211], v[72:75], a[144:159]
    ds_read_b128 a[196:199], v96 offset:13312
    v_cvt_pk_bf16_f32 v64, v0, v1
    v_cvt_pk_bf16_f32 v65, v2, v3
    v_exp_f32 v8, v8
    v_exp_f32 v9, v9
    v_cvt_pk_bf16_f32 v66, v4, v5
    v_cvt_pk_bf16_f32 v67, v6, v7
    v_smfmac_f32_16x16x64_bf16 a[164:167], a[216:219], v[72:79], v111
    ds_read_b128 a[200:203], v96 offset:10240
    v_exp_f32 v10, v10
    v_exp_f32 v11, v11
    v_exp_f32 v12, v12
    v_exp_f32 v13, v13
    v_mfma_f32_32x32x16_bf16 a[144:159], a[212:215], v[76:79], a[144:159]
    ds_read_b128 a[204:207], v96 offset:11264
    buffer_load_dwordx4 v254, s[36:39], s66 offen offset:0 sc1 lds
    v_cvt_pk_bf16_f32 v68, v8, v9
    v_cvt_pk_bf16_f32 v69, v10, v11
    v_exp_f32 v14, v14
    v_exp_f32 v15, v15
    v_cvt_pk_bf16_f32 v70, v12, v13
    v_cvt_pk_bf16_f32 v71, v14, v15
    s_waitcnt lgkmcnt(0)
    v_mfma_f32_32x32x16_bf16 v[0:15], a[192:195], a[168:171], v[32:47]
    buffer_load_dwordx4 v254, s[36:39], s66 offen offset:1024 sc1 lds
    v_exp_f32 v16, v16
    v_exp_f32 v17, v17
    v_exp_f32 v18, v18
    v_exp_f32_e64 v19, v19
    v_mfma_f32_32x32x16_bf16 v[0:15], a[196:199], a[172:175], v[0:15]
    v_exp_f32 v20, v20
    v_exp_f32 v21, v21
    v_exp_f32 v22, v22
    v_exp_f32 v23, v23
    v_mfma_f32_32x32x16_bf16 a[128:143], a[200:203], v[64:67], a[128:143]
    v_cvt_pk_bf16_f32 v72, v16, v17
    v_cvt_pk_bf16_f32 v73, v18, v19
    v_exp_f32 v24, v24
    v_exp_f32 v25, v25
    v_cvt_pk_bf16_f32 v74, v20, v21
    v_cvt_pk_bf16_f32 v75, v22, v23
    v_smfmac_f32_16x16x64_bf16 a[160:163], a[216:219], v[64:71], v111
    v_exp_f32 v26, v26
    v_exp_f32 v27, v27
    v_exp_f32 v28, v28
    v_exp_f32 v29, v29
    v_mfma_f32_32x32x16_bf16 a[128:143], a[204:207], v[68:71], a[128:143]
    v_cvt_pk_bf16_f32 v76, v24, v25
    v_cvt_pk_bf16_f32 v77, v26, v27
    v_exp_f32 v30, v30
    v_exp_f32 v31, v31
    v_cvt_pk_bf16_f32 v78, v28, v29
    v_cvt_pk_bf16_f32 v79, v30, v31
    v_mfma_f32_32x32x16_bf16 v[16:31], a[192:195], a[176:179], v[48:63]
    ds_read_b128 a[184:187], v96 offset:16384
    v_exp_f32 v0, v0
    v_exp_f32 v1, v1
    v_exp_f32 v2, v2
    v_exp_f32 v3, v3
    v_mfma_f32_32x32x16_bf16 v[16:31], a[196:199], a[180:183], v[16:31]
    ds_read_b128 a[188:191], v96 offset:17408
    v_exp_f32 v4, v4
    v_exp_f32 v5, v5
    v_exp_f32 v6, v6
    v_exp_f32 v7, v7
    v_mfma_f32_32x32x16_bf16 a[144:159], a[200:203], v[72:75], a[144:159]
    ds_read_b128 a[208:211], v96 offset:14336
    v_cvt_pk_bf16_f32 v64, v0, v1
    v_cvt_pk_bf16_f32 v65, v2, v3
    v_exp_f32 v8, v8
    v_exp_f32 v9, v9
    v_cvt_pk_bf16_f32 v66, v4, v5
    v_cvt_pk_bf16_f32 v67, v6, v7
    v_smfmac_f32_16x16x64_bf16 a[164:167], a[216:219], v[72:79], v111
    ds_read_b128 a[212:215], v96 offset:15360
    v_exp_f32 v10, v10
    v_exp_f32 v11, v11
    v_exp_f32 v12, v12
    v_exp_f32 v13, v13
    v_mfma_f32_32x32x16_bf16 a[144:159], a[204:207], v[76:79], a[144:159]
    buffer_load_dwordx4 v254, s[36:39], s66 offen offset:2048 sc1 lds
    v_cvt_pk_bf16_f32 v68, v8, v9
    v_cvt_pk_bf16_f32 v69, v10, v11
    v_exp_f32 v14, v14
    v_exp_f32 v15, v15
    v_cvt_pk_bf16_f32 v70, v12, v13
    v_cvt_pk_bf16_f32 v71, v14, v15
    s_waitcnt lgkmcnt(0)
    v_mfma_f32_32x32x16_bf16 v[0:15], a[184:187], a[168:171], v[32:47]
    buffer_load_dwordx4 v254, s[36:39], s66 offen offset:3072 sc1 lds
    v_exp_f32 v16, v16
    v_exp_f32 v17, v17
    v_exp_f32 v18, v18
    v_exp_f32_e64 v19, v19
    v_mfma_f32_32x32x16_bf16 v[0:15], a[188:191], a[172:175], v[0:15]
    v_exp_f32 v20, v20
    v_exp_f32 v21, v21
    v_exp_f32 v22, v22
    v_exp_f32 v23, v23
    v_mfma_f32_32x32x16_bf16 a[128:143], a[208:211], v[64:67], a[128:143]
    v_cvt_pk_bf16_f32 v72, v16, v17
    v_cvt_pk_bf16_f32 v73, v18, v19
    v_exp_f32 v24, v24
    v_exp_f32 v25, v25
    v_cvt_pk_bf16_f32 v74, v20, v21
    v_cvt_pk_bf16_f32 v75, v22, v23
    v_smfmac_f32_16x16x64_bf16 a[160:163], a[216:219], v[64:71], v111
    v_exp_f32 v26, v26
    v_exp_f32 v27, v27
    v_exp_f32 v28, v28
    v_exp_f32 v29, v29
    v_mfma_f32_32x32x16_bf16 a[128:143], a[212:215], v[68:71], a[128:143]
    v_cvt_pk_bf16_f32 v76, v24, v25
    v_cvt_pk_bf16_f32 v77, v26, v27
    v_exp_f32 v30, v30
    v_exp_f32 v31, v31
    v_cvt_pk_bf16_f32 v78, v28, v29
    v_cvt_pk_bf16_f32 v79, v30, v31
    v_mfma_f32_32x32x16_bf16 v[16:31], a[184:187], a[176:179], v[48:63]
    ds_read_b128 a[192:195], v96 offset:20480
    v_exp_f32 v0, v0
    v_exp_f32 v1, v1
    v_exp_f32 v2, v2
    v_exp_f32 v3, v3
    v_mfma_f32_32x32x16_bf16 v[16:31], a[188:191], a[180:183], v[16:31]
    ds_read_b128 a[196:199], v96 offset:21504
    v_exp_f32 v4, v4
    v_exp_f32 v5, v5
    v_exp_f32 v6, v6
    v_exp_f32 v7, v7
    v_mfma_f32_32x32x16_bf16 a[144:159], a[208:211], v[72:75], a[144:159]
    ds_read_b128 a[200:203], v96 offset:18432
    v_cvt_pk_bf16_f32 v64, v0, v1
    v_cvt_pk_bf16_f32 v65, v2, v3
    v_exp_f32 v8, v8
    v_exp_f32 v9, v9
    v_cvt_pk_bf16_f32 v66, v4, v5
    v_cvt_pk_bf16_f32 v67, v6, v7
    v_smfmac_f32_16x16x64_bf16 a[164:167], a[216:219], v[72:79], v111
    ds_read_b128 a[204:207], v96 offset:19456
    v_exp_f32 v10, v10
    v_exp_f32 v11, v11
    v_exp_f32 v12, v12
    v_exp_f32 v13, v13
    v_mfma_f32_32x32x16_bf16 a[144:159], a[212:215], v[76:79], a[144:159]
    v_cvt_pk_bf16_f32 v68, v8, v9
    v_cvt_pk_bf16_f32 v69, v10, v11
    v_exp_f32 v14, v14
    v_exp_f32 v15, v15
    v_cvt_pk_bf16_f32 v70, v12, v13
    v_cvt_pk_bf16_f32 v71, v14, v15
    s_waitcnt lgkmcnt(0)
    v_mfma_f32_32x32x16_bf16 v[0:15], a[192:195], a[168:171], v[32:47]
    s_sub_u32 s94, s67, s93
    v_exp_f32 v16, v16
    v_exp_f32 v17, v17
    v_exp_f32 v18, v18
    v_exp_f32 v19, v19
    v_mfma_f32_32x32x16_bf16 v[0:15], a[196:199], a[172:175], v[0:15]
    s_add_u32 s91, s91, 0x8000
    v_exp_f32 v20, v20
    v_exp_f32 v21, v21
    v_exp_f32 v22, v22
    v_exp_f32 v23, v23
    v_mfma_f32_32x32x16_bf16 a[128:143], a[200:203], v[64:67], a[128:143]
    s_lshr_b32 s8, s8, 4
    v_cvt_pk_bf16_f32 v72, v16, v17
    v_cvt_pk_bf16_f32 v73, v18, v19
    v_exp_f32 v24, v24
    v_exp_f32_e64 v25, v25
    v_cvt_pk_bf16_f32 v74, v20, v21
    v_cvt_pk_bf16_f32 v75, v22, v23
    v_smfmac_f32_16x16x64_bf16 a[160:163], a[216:219], v[64:71], v111
    s_and_b32 s3, s8, 15
    v_exp_f32 v26, v26
    v_exp_f32 v27, v27
    v_exp_f32 v28, v28
    v_exp_f32_e64 v29, v29
    v_mfma_f32_32x32x16_bf16 a[128:143], a[204:207], v[68:71], a[128:143]
    s_lshl_b32 s3, s3, 15
    s_add_u32 s67, s3, s93
    v_cvt_pk_bf16_f32 v76, v24, v25
    v_cvt_pk_bf16_f32 v77, v26, v27
    v_exp_f32 v30, v30
    v_exp_f32 v31, v31
    v_cvt_pk_bf16_f32 v78, v28, v29
    v_cvt_pk_bf16_f32 v79, v30, v31
    v_mfma_f32_32x32x16_bf16 v[16:31], a[192:195], a[176:179], v[48:63]
    ds_read_b128 a[184:187], v96 offset:24576
    v_exp_f32 v0, v0
    v_exp_f32 v1, v1
    v_exp_f32 v2, v2
    v_exp_f32 v3, v3
    v_mfma_f32_32x32x16_bf16 v[16:31], a[196:199], a[180:183], v[16:31]
    ds_read_b128 a[188:191], v96 offset:25600
    v_exp_f32 v4, v4
    v_exp_f32 v5, v5
    v_exp_f32 v6, v6
    v_exp_f32 v7, v7
    v_mfma_f32_32x32x16_bf16 a[144:159], a[200:203], v[72:75], a[144:159]
    ds_read_b128 a[208:211], v96 offset:22528
    v_cvt_pk_bf16_f32 v64, v0, v1
    v_cvt_pk_bf16_f32 v65, v2, v3
    v_exp_f32 v8, v8
    v_exp_f32 v9, v9
    v_cvt_pk_bf16_f32 v66, v4, v5
    v_cvt_pk_bf16_f32 v67, v6, v7
    v_smfmac_f32_16x16x64_bf16 a[164:167], a[216:219], v[72:79], v111
    ds_read_b128 a[212:215], v96 offset:23552
    v_exp_f32 v10, v10
    v_exp_f32 v11, v11
    v_exp_f32 v12, v12
    v_exp_f32 v13, v13
    v_mfma_f32_32x32x16_bf16 a[144:159], a[204:207], v[76:79], a[144:159]
    v_cvt_pk_bf16_f32 v68, v8, v9
    v_cvt_pk_bf16_f32 v69, v10, v11
    v_exp_f32 v14, v14
    v_exp_f32 v15, v15
    v_cvt_pk_bf16_f32 v70, v12, v13
    v_cvt_pk_bf16_f32 v71, v14, v15
    s_waitcnt lgkmcnt(0)
    v_mfma_f32_32x32x16_bf16 v[0:15], a[184:187], a[168:171], v[32:47]
    v_exp_f32 v16, v16
    v_exp_f32 v17, v17
    v_exp_f32 v18, v18
    v_exp_f32_e64 v19, v19
    v_mfma_f32_32x32x16_bf16 v[0:15], a[188:191], a[172:175], v[0:15]
    v_exp_f32 v20, v20
    v_exp_f32 v21, v21
    v_exp_f32 v22, v22
    v_exp_f32 v23, v23
    v_mfma_f32_32x32x16_bf16 a[128:143], a[208:211], v[64:67], a[128:143]
    v_cvt_pk_bf16_f32 v72, v16, v17
    v_cvt_pk_bf16_f32 v73, v18, v19
    v_exp_f32 v24, v24
    v_exp_f32 v25, v25
    v_cvt_pk_bf16_f32 v74, v20, v21
    v_cvt_pk_bf16_f32 v75, v22, v23
    v_smfmac_f32_16x16x64_bf16 a[160:163], a[216:219], v[64:71], v111
    v_exp_f32 v26, v26
    v_exp_f32 v27, v27
    v_exp_f32 v28, v28
    v_exp_f32 v29, v29
    v_mfma_f32_32x32x16_bf16 a[128:143], a[212:215], v[68:71], a[128:143]
    v_cvt_pk_bf16_f32 v76, v24, v25
    v_cvt_pk_bf16_f32 v77, v26, v27
    v_exp_f32 v30, v30
    v_exp_f32 v31, v31
    v_cvt_pk_bf16_f32 v78, v28, v29
    v_cvt_pk_bf16_f32 v79, v30, v31
    v_mfma_f32_32x32x16_bf16 v[16:31], a[184:187], a[176:179], v[48:63]
    ds_read_b128 a[192:195], v96 offset:28672
    v_exp_f32 v0, v0
    v_exp_f32 v1, v1
    v_exp_f32 v2, v2
    v_exp_f32 v3, v3
    v_mfma_f32_32x32x16_bf16 v[16:31], a[188:191], a[180:183], v[16:31]
    ds_read_b128 a[196:199], v96 offset:29696
    v_exp_f32 v4, v4
    v_exp_f32 v5, v5
    v_exp_f32 v6, v6
    v_exp_f32 v7, v7
    v_mfma_f32_32x32x16_bf16 a[144:159], a[208:211], v[72:75], a[144:159]
    ds_read_b128 a[200:203], v96 offset:26624
    v_cvt_pk_bf16_f32 v64, v0, v1
    v_cvt_pk_bf16_f32 v65, v2, v3
    v_exp_f32 v8, v8
    v_exp_f32 v9, v9
    v_cvt_pk_bf16_f32 v66, v4, v5
    v_cvt_pk_bf16_f32 v67, v6, v7
    v_smfmac_f32_16x16x64_bf16 a[164:167], a[216:219], v[72:79], v111
    ds_read_b128 a[204:207], v96 offset:27648
    v_exp_f32 v10, v10
    v_exp_f32 v11, v11
    v_exp_f32 v12, v12
    v_exp_f32 v13, v13
    v_mfma_f32_32x32x16_bf16 a[144:159], a[212:215], v[76:79], a[144:159]
    v_cvt_pk_bf16_f32 v68, v8, v9
    v_cvt_pk_bf16_f32 v69, v10, v11
    v_exp_f32 v14, v14
    v_exp_f32 v15, v15
    v_cvt_pk_bf16_f32 v70, v12, v13
    v_cvt_pk_bf16_f32 v71, v14, v15
    s_waitcnt lgkmcnt(0)
    v_mfma_f32_32x32x16_bf16 v[0:15], a[192:195], a[168:171], v[32:47]
    v_exp_f32 v16, v16
    v_exp_f32 v17, v17
    v_exp_f32 v18, v18
    v_exp_f32_e64 v19, v19
    v_mfma_f32_32x32x16_bf16 v[0:15], a[196:199], a[172:175], v[0:15]
    v_exp_f32 v20, v20
    v_exp_f32 v21, v21
    v_exp_f32 v22, v22
    v_exp_f32 v23, v23
    v_mfma_f32_32x32x16_bf16 a[128:143], a[200:203], v[64:67], a[128:143]
    v_cvt_pk_bf16_f32 v72, v16, v17
    v_cvt_pk_bf16_f32 v73, v18, v19
    v_exp_f32 v24, v24
    v_exp_f32 v25, v25
    v_cvt_pk_bf16_f32 v74, v20, v21
    v_cvt_pk_bf16_f32 v75, v22, v23
    v_smfmac_f32_16x16x64_bf16 a[160:163], a[216:219], v[64:71], v111
    v_exp_f32 v26, v26
    v_exp_f32 v27, v27
    v_exp_f32 v28, v28
    v_exp_f32 v29, v29
    v_mfma_f32_32x32x16_bf16 a[128:143], a[204:207], v[68:71], a[128:143]
    v_cvt_pk_bf16_f32 v76, v24, v25
    v_cvt_pk_bf16_f32 v77, v26, v27
    v_exp_f32 v30, v30
    v_exp_f32 v31, v31
    v_cvt_pk_bf16_f32 v78, v28, v29
    v_cvt_pk_bf16_f32 v79, v30, v31
    s_waitcnt vmcnt(9)
    s_barrier
    v_mfma_f32_32x32x16_bf16 v[16:31], a[192:195], a[176:179], v[48:63]
    ds_read_b128 a[184:187], v97 offset:0
    v_exp_f32 v0, v0
    v_exp_f32 v1, v1
    v_exp_f32 v2, v2
    v_exp_f32 v3, v3
    v_mfma_f32_32x32x16_bf16 v[16:31], a[196:199], a[180:183], v[16:31]
    ds_read_b128 a[188:191], v97 offset:1024
    v_exp_f32 v4, v4
    v_exp_f32 v5, v5
    v_exp_f32 v6, v6
    v_exp_f32 v7, v7
    v_mfma_f32_32x32x16_bf16 a[144:159], a[200:203], v[72:75], a[144:159]
    ds_read_b128 a[208:211], v96 offset:30720
    v_cvt_pk_bf16_f32 v64, v0, v1
    v_cvt_pk_bf16_f32 v65, v2, v3
    v_exp_f32 v8, v8
    v_exp_f32 v9, v9
    v_cvt_pk_bf16_f32 v66, v4, v5
    v_cvt_pk_bf16_f32 v67, v6, v7
    v_smfmac_f32_16x16x64_bf16 a[164:167], a[216:219], v[72:79], v111
    ds_read_b128 a[212:215], v96 offset:31744
    v_exp_f32 v10, v10
    v_exp_f32 v11, v11
    v_exp_f32 v12, v12
    v_exp_f32 v13, v13
    v_mfma_f32_32x32x16_bf16 a[144:159], a[204:207], v[76:79], a[144:159]
    v_cvt_pk_bf16_f32 v68, v8, v9
    v_cvt_pk_bf16_f32 v69, v10, v11
    v_exp_f32 v14, v14
    v_exp_f32 v15, v15
    v_cvt_pk_bf16_f32 v70, v12, v13
    v_cvt_pk_bf16_f32 v71, v14, v15
    s_waitcnt lgkmcnt(0)
    v_mfma_f32_32x32x16_bf16 v[0:15], a[184:187], a[168:171], v[32:47]
    v_mov_b32 v96, v97
    v_exp_f32 v16, v16
    v_exp_f32 v17, v17
    v_exp_f32 v18, v18
    v_exp_f32 v19, v19
    v_mfma_f32_32x32x16_bf16 v[0:15], a[188:191], a[172:175], v[0:15]
    v_add_u32 v97, s94, v254
    v_exp_f32 v20, v20
    v_exp_f32 v21, v21
    v_exp_f32 v22, v22
    v_exp_f32_e64 v23, v23
    v_mfma_f32_32x32x16_bf16 a[128:143], a[208:211], v[64:67], a[128:143]
    s_add_u32 s64, s64, 1
    v_cvt_pk_bf16_f32 v72, v16, v17
    v_cvt_pk_bf16_f32 v73, v18, v19
    v_exp_f32 v24, v24
    v_exp_f32_e64 v25, v25
    v_cvt_pk_bf16_f32 v74, v20, v21
    v_cvt_pk_bf16_f32 v75, v22, v23
    v_smfmac_f32_16x16x64_bf16 a[160:163], a[216:219], v[64:71], v111
    s_cmp_lt_u32 s64, 5
    v_exp_f32 v26, v26
    v_exp_f32 v27, v27
    v_exp_f32 v28, v28
    v_exp_f32_e64 v29, v29
    v_mfma_f32_32x32x16_bf16 a[128:143], a[212:215], v[68:71], a[128:143]
    v_cvt_pk_bf16_f32 v76, v24, v25
    v_cvt_pk_bf16_f32 v77, v26, v27
    v_exp_f32 v30, v30
    v_exp_f32 v31, v31
    v_cvt_pk_bf16_f32 v78, v28, v29
    v_cvt_pk_bf16_f32 v79, v30, v31
    s_cbranch_scc1 AT_loop
    s_cmp_lg_u32 s64, 5
    s_cbranch_scc1 AT_late2
    buffer_load_dword v107, v108, s[44:47], s9 offen
    s_cmp_lg_u32 s89, 5
    s_cbranch_scc1 AT_loop
    v_cmp_eq_u32 vcc, 0, v255
    v_mov_b32 v253, 0x80000000
    v_mov_b32_e64 v252, s95
    v_cndmask_b32 v253, v253, 0, vcc
    buffer_store_dword v252, v253, s[36:39], s14 offen sc1
    s_mov_b32 s89, 99
    s_branch AT_loop
AT_late2:
    s_cmp_eq_u32 s64, 7
    s_cbranch_scc1 AT_last
    s_mov_b32 s91, 0x80000000
    s_lshl_b32 s3, s4, 13
    s_add_u32 s3, s3, AT_last-parallel_sum__softmax_full_mha__dense_activation_relu__prompt_kernel
    v_lshlrev_b32_e64 v98, 7, v255
    buffer_load_dword v107, v98, s[48:51], s3 offen
    s_branch AT_loop
AT_last:
    buffer_load_dword v109, v110, s[36:39], s23 offen sc1
    v_mfma_f32_32x32x16_bf16 v[16:31], a[184:187], a[176:179], v[48:63]
    ds_read_b128 a[192:195], v96 offset:4096
    v_exp_f32 v0, v0
    v_exp_f32 v1, v1
    v_exp_f32 v2, v2
    v_exp_f32_e64 v3, v3
    v_mfma_f32_32x32x16_bf16 v[16:31], a[188:191], a[180:183], v[16:31]
    ds_read_b128 a[196:199], v96 offset:5120
    v_exp_f32 v4, v4
    v_exp_f32 v5, v5
    v_exp_f32 v6, v6
    v_exp_f32 v7, v7
    v_mfma_f32_32x32x16_bf16 a[144:159], a[208:211], v[72:75], a[144:159]
    ds_read_b128 a[200:203], v96 offset:2048
    v_cvt_pk_bf16_f32 v64, v0, v1
    v_cvt_pk_bf16_f32 v65, v2, v3
    v_exp_f32 v8, v8
    v_exp_f32 v9, v9
    v_cvt_pk_bf16_f32 v66, v4, v5
    v_cvt_pk_bf16_f32 v67, v6, v7
    v_smfmac_f32_16x16x64_bf16 a[164:167], a[216:219], v[72:79], v111
    ds_read_b128 a[204:207], v96 offset:3072
    v_exp_f32 v10, v10
    v_exp_f32 v11, v11
    v_exp_f32 v12, v12
    v_exp_f32 v13, v13
    v_mfma_f32_32x32x16_bf16 a[144:159], a[212:215], v[76:79], a[144:159]
    v_cvt_pk_bf16_f32 v68, v8, v9
    v_cvt_pk_bf16_f32 v69, v10, v11
    v_exp_f32 v14, v14
    v_exp_f32 v15, v15
    v_cvt_pk_bf16_f32 v70, v12, v13
    v_cvt_pk_bf16_f32 v71, v14, v15
    s_waitcnt lgkmcnt(0)
    v_mfma_f32_32x32x16_bf16 v[0:15], a[192:195], a[168:171], v[32:47]
    s_mov_b32 s44, s26
    s_mov_b32 s45, s27
    v_exp_f32 v16, v16
    v_exp_f32 v17, v17
    v_exp_f32 v18, v18
    v_exp_f32_e64 v19, v19
    v_mfma_f32_32x32x16_bf16 v[0:15], a[196:199], a[172:175], v[0:15]
    s_mov_b32 s46, 0x700000
    s_mov_b32 s47, 0x00020000
    v_exp_f32 v20, v20
    v_exp_f32 v21, v21
    v_exp_f32 v22, v22
    v_exp_f32 v23, v23
    v_mfma_f32_32x32x16_bf16 a[128:143], a[200:203], v[64:67], a[128:143]
    s_add_u32 m0, s73, 0
    s_add_u32 s72, s72, 0x20000
    v_cvt_pk_bf16_f32 v72, v16, v17
    v_cvt_pk_bf16_f32 v73, v18, v19
    v_exp_f32 v24, v24
    v_exp_f32_e64 v25, v25
    v_cvt_pk_bf16_f32 v74, v20, v21
    v_cvt_pk_bf16_f32 v75, v22, v23
    v_smfmac_f32_16x16x64_bf16 a[160:163], a[216:219], v[64:71], v111
    buffer_load_dwordx4 v240, s[44:47], s72 offen offset:0 lds
    v_exp_f32 v26, v26
    v_exp_f32 v27, v27
    v_exp_f32 v28, v28
    v_exp_f32 v29, v29
    v_mfma_f32_32x32x16_bf16 a[128:143], a[204:207], v[68:71], a[128:143]
    v_cvt_pk_bf16_f32 v76, v24, v25
    v_cvt_pk_bf16_f32 v77, v26, v27
    v_exp_f32 v30, v30
    v_exp_f32 v31, v31
    v_cvt_pk_bf16_f32 v78, v28, v29
    v_cvt_pk_bf16_f32 v79, v30, v31
    v_mfma_f32_32x32x16_bf16 v[16:31], a[192:195], a[176:179], v[48:63]
    ds_read_b128 a[184:187], v96 offset:8192
    v_exp_f32 v0, v0
    v_exp_f32 v1, v1
    v_exp_f32 v2, v2
    v_exp_f32 v3, v3
    v_mfma_f32_32x32x16_bf16 v[16:31], a[196:199], a[180:183], v[16:31]
    ds_read_b128 a[188:191], v96 offset:9216
    v_exp_f32 v4, v4
    v_exp_f32 v5, v5
    v_exp_f32 v6, v6
    v_exp_f32 v7, v7
    v_mfma_f32_32x32x16_bf16 a[144:159], a[200:203], v[72:75], a[144:159]
    ds_read_b128 a[208:211], v96 offset:6144
    v_cvt_pk_bf16_f32 v64, v0, v1
    v_cvt_pk_bf16_f32 v65, v2, v3
    v_exp_f32 v8, v8
    v_exp_f32 v9, v9
    v_cvt_pk_bf16_f32 v66, v4, v5
    v_cvt_pk_bf16_f32 v67, v6, v7
    v_smfmac_f32_16x16x64_bf16 a[164:167], a[216:219], v[72:79], v111
    ds_read_b128 a[212:215], v96 offset:7168
    v_exp_f32 v10, v10
    v_exp_f32 v11, v11
    v_exp_f32 v12, v12
    v_exp_f32 v13, v13
    v_mfma_f32_32x32x16_bf16 a[144:159], a[204:207], v[76:79], a[144:159]
    buffer_load_dwordx4 v241, s[44:47], s72 offen offset:1024 lds
    v_cvt_pk_bf16_f32 v68, v8, v9
    v_cvt_pk_bf16_f32 v69, v10, v11
    v_exp_f32 v14, v14
    v_exp_f32 v15, v15
    v_cvt_pk_bf16_f32 v70, v12, v13
    v_cvt_pk_bf16_f32 v71, v14, v15
    s_waitcnt lgkmcnt(0)
    v_mfma_f32_32x32x16_bf16 v[0:15], a[184:187], a[168:171], v[32:47]
    buffer_load_dwordx4 v242, s[44:47], s72 offen offset:2048 lds
    v_exp_f32 v16, v16
    v_exp_f32 v17, v17
    v_exp_f32 v18, v18
    v_exp_f32_e64 v19, v19
    v_mfma_f32_32x32x16_bf16 v[0:15], a[188:191], a[172:175], v[0:15]
    buffer_load_dwordx4 v243, s[44:47], s72 offen offset:3072 lds
    v_exp_f32 v20, v20
    v_exp_f32 v21, v21
    v_exp_f32 v22, v22
    v_exp_f32 v23, v23
    v_mfma_f32_32x32x16_bf16 a[128:143], a[208:211], v[64:67], a[128:143]
    s_add_u32 m0, s73, 8192
    v_cvt_pk_bf16_f32 v72, v16, v17
    v_cvt_pk_bf16_f32 v73, v18, v19
    v_exp_f32 v24, v24
    v_exp_f32 v25, v25
    v_cvt_pk_bf16_f32 v74, v20, v21
    v_cvt_pk_bf16_f32 v75, v22, v23
    v_smfmac_f32_16x16x64_bf16 a[160:163], a[216:219], v[64:71], v111
    s_add_u32 s72, s72, 0x20000
    v_exp_f32 v26, v26
    v_exp_f32 v27, v27
    v_exp_f32 v28, v28
    v_exp_f32 v29, v29
    v_mfma_f32_32x32x16_bf16 a[128:143], a[212:215], v[68:71], a[128:143]
    buffer_load_dwordx4 v240, s[44:47], s72 offen offset:0 lds
    v_cvt_pk_bf16_f32 v76, v24, v25
    v_cvt_pk_bf16_f32 v77, v26, v27
    v_exp_f32 v30, v30
    v_exp_f32 v31, v31
    v_cvt_pk_bf16_f32 v78, v28, v29
    v_cvt_pk_bf16_f32 v79, v30, v31
    v_mfma_f32_32x32x16_bf16 v[16:31], a[184:187], a[176:179], v[48:63]
    ds_read_b128 a[192:195], v96 offset:12288
    v_exp_f32 v0, v0
    v_exp_f32 v1, v1
    v_exp_f32 v2, v2
    v_exp_f32 v3, v3
    v_mfma_f32_32x32x16_bf16 v[16:31], a[188:191], a[180:183], v[16:31]
    ds_read_b128 a[196:199], v96 offset:13312
    v_exp_f32 v4, v4
    v_exp_f32 v5, v5
    v_exp_f32 v6, v6
    v_exp_f32 v7, v7
    v_mfma_f32_32x32x16_bf16 a[144:159], a[208:211], v[72:75], a[144:159]
    ds_read_b128 a[200:203], v96 offset:10240
    v_cvt_pk_bf16_f32 v64, v0, v1
    v_cvt_pk_bf16_f32 v65, v2, v3
    v_exp_f32 v8, v8
    v_exp_f32 v9, v9
    v_cvt_pk_bf16_f32 v66, v4, v5
    v_cvt_pk_bf16_f32 v67, v6, v7
    v_smfmac_f32_16x16x64_bf16 a[164:167], a[216:219], v[72:79], v111
    ds_read_b128 a[204:207], v96 offset:11264
    v_exp_f32 v10, v10
    v_exp_f32 v11, v11
    v_exp_f32 v12, v12
    v_exp_f32 v13, v13
    v_mfma_f32_32x32x16_bf16 a[144:159], a[212:215], v[76:79], a[144:159]
    buffer_load_dwordx4 v241, s[44:47], s72 offen offset:1024 lds
    v_cvt_pk_bf16_f32 v68, v8, v9
    v_cvt_pk_bf16_f32 v69, v10, v11
    v_exp_f32 v14, v14
    v_exp_f32 v15, v15
    v_cvt_pk_bf16_f32 v70, v12, v13
    v_cvt_pk_bf16_f32 v71, v14, v15
    s_waitcnt lgkmcnt(0)
    v_mfma_f32_32x32x16_bf16 v[0:15], a[192:195], a[168:171], v[32:47]
    buffer_load_dwordx4 v242, s[44:47], s72 offen offset:2048 lds
    v_exp_f32 v16, v16
    v_exp_f32 v17, v17
    v_exp_f32 v18, v18
    v_exp_f32_e64 v19, v19
    v_mfma_f32_32x32x16_bf16 v[0:15], a[196:199], a[172:175], v[0:15]
    buffer_load_dwordx4 v243, s[44:47], s72 offen offset:3072 lds
    v_exp_f32 v20, v20
    v_exp_f32 v21, v21
    v_exp_f32 v22, v22
    v_exp_f32 v23, v23
    v_mfma_f32_32x32x16_bf16 a[128:143], a[200:203], v[64:67], a[128:143]
    v_cvt_pk_bf16_f32 v72, v16, v17
    v_cvt_pk_bf16_f32 v73, v18, v19
    v_exp_f32 v24, v24
    v_exp_f32 v25, v25
    v_cvt_pk_bf16_f32 v74, v20, v21
    v_cvt_pk_bf16_f32 v75, v22, v23
    v_smfmac_f32_16x16x64_bf16 a[160:163], a[216:219], v[64:71], v111
    v_exp_f32 v26, v26
    v_exp_f32 v27, v27
    v_exp_f32 v28, v28
    v_exp_f32 v29, v29
    v_mfma_f32_32x32x16_bf16 a[128:143], a[204:207], v[68:71], a[128:143]
    v_cvt_pk_bf16_f32 v76, v24, v25
    v_cvt_pk_bf16_f32 v77, v26, v27
    v_exp_f32 v30, v30
    v_exp_f32 v31, v31
    v_cvt_pk_bf16_f32 v78, v28, v29
    v_cvt_pk_bf16_f32 v79, v30, v31
    s_waitcnt vmcnt(8)
    v_cmp_eq_u32 vcc, s95, v109
    s_and_b32 s3, vcc_lo, 0xffff
    s_cmp_eq_u32 s3, 0xffff
    s_cbranch_scc0 AT_hpoll_far
AT_hpoll_back:
    v_mfma_f32_32x32x16_bf16 v[16:31], a[192:195], a[176:179], v[48:63]
    ds_read_b128 a[184:187], v96 offset:16384
    v_exp_f32 v0, v0
    v_exp_f32 v1, v1
    v_exp_f32 v2, v2
    v_exp_f32_e64 v3, v3
    v_mfma_f32_32x32x16_bf16 v[16:31], a[196:199], a[180:183], v[16:31]
    ds_read_b128 a[188:191], v96 offset:17408
    v_exp_f32 v4, v4
    v_exp_f32 v5, v5
    v_exp_f32 v6, v6
    v_exp_f32 v7, v7
    v_mfma_f32_32x32x16_bf16 a[144:159], a[200:203], v[72:75], a[144:159]
    ds_read_b128 a[208:211], v96 offset:14336
    v_cvt_pk_bf16_f32 v64, v0, v1
    v_cvt_pk_bf16_f32 v65, v2, v3
    v_exp_f32 v8, v8
    v_exp_f32 v9, v9
    v_cvt_pk_bf16_f32 v66, v4, v5
    v_cvt_pk_bf16_f32 v67, v6, v7
    v_smfmac_f32_16x16x64_bf16 a[164:167], a[216:219], v[72:79], v111
    ds_read_b128 a[212:215], v96 offset:15360
    v_exp_f32 v10, v10
    v_exp_f32 v11, v11
    v_exp_f32 v12, v12
    v_exp_f32 v13, v13
    v_mfma_f32_32x32x16_bf16 a[144:159], a[204:207], v[76:79], a[144:159]
    buffer_load_dwordx4 a[0:3], v254, s[36:39], s71 offen offset:0 sc1
    buffer_load_dwordx4 a[4:7], v254, s[36:39], s71 offen offset:1024 sc1
    v_cvt_pk_bf16_f32 v68, v8, v9
    v_cvt_pk_bf16_f32 v69, v10, v11
    v_exp_f32 v14, v14
    v_exp_f32 v15, v15
    v_cvt_pk_bf16_f32 v70, v12, v13
    v_cvt_pk_bf16_f32 v71, v14, v15
    s_waitcnt lgkmcnt(0)
    v_mfma_f32_32x32x16_bf16 v[0:15], a[184:187], a[168:171], v[32:47]
    buffer_load_dwordx4 a[8:11], v254, s[36:39], s71 offen offset:2048 sc1
    v_exp_f32 v16, v16
    v_exp_f32 v17, v17
    v_exp_f32 v18, v18
    v_exp_f32_e64 v19, v19
    v_mfma_f32_32x32x16_bf16 v[0:15], a[188:191], a[172:175], v[0:15]
    buffer_load_dwordx4 a[12:15], v254, s[36:39], s71 offen offset:3072 sc1
    v_exp_f32 v20, v20
    v_exp_f32 v21, v21
    v_exp_f32 v22, v22
    v_exp_f32 v23, v23
    v_mfma_f32_32x32x16_bf16 a[128:143], a[208:211], v[64:67], a[128:143]
    s_add_u32 s71, s71, 0x40000
    v_cvt_pk_bf16_f32 v72, v16, v17
    v_cvt_pk_bf16_f32 v73, v18, v19
    v_exp_f32 v24, v24
    v_exp_f32 v25, v25
    v_cvt_pk_bf16_f32 v74, v20, v21
    v_cvt_pk_bf16_f32 v75, v22, v23
    v_smfmac_f32_16x16x64_bf16 a[160:163], a[216:219], v[64:71], v111
    s_add_u32 m0, s73, 16384
    v_exp_f32 v26, v26
    v_exp_f32 v27, v27
    v_exp_f32 v28, v28
    v_exp_f32 v29, v29
    v_mfma_f32_32x32x16_bf16 a[128:143], a[212:215], v[68:71], a[128:143]
    s_add_u32 s72, s72, 0x20000
    buffer_load_dwordx4 v240, s[44:47], s72 offen offset:0 lds
    v_cvt_pk_bf16_f32 v76, v24, v25
    v_cvt_pk_bf16_f32 v77, v26, v27
    v_exp_f32 v30, v30
    v_exp_f32 v31, v31
    v_cvt_pk_bf16_f32 v78, v28, v29
    v_cvt_pk_bf16_f32 v79, v30, v31
    v_mfma_f32_32x32x16_bf16 v[16:31], a[184:187], a[176:179], v[48:63]
    ds_read_b128 a[192:195], v96 offset:20480
    v_exp_f32 v0, v0
    v_exp_f32 v1, v1
    v_exp_f32 v2, v2
    v_exp_f32 v3, v3
    v_mfma_f32_32x32x16_bf16 v[16:31], a[188:191], a[180:183], v[16:31]
    ds_read_b128 a[196:199], v96 offset:21504
    v_exp_f32 v4, v4
    v_exp_f32 v5, v5
    v_exp_f32 v6, v6
    v_exp_f32 v7, v7
    v_mfma_f32_32x32x16_bf16 a[144:159], a[208:211], v[72:75], a[144:159]
    ds_read_b128 a[200:203], v96 offset:18432
    v_cvt_pk_bf16_f32 v64, v0, v1
    v_cvt_pk_bf16_f32 v65, v2, v3
    v_exp_f32 v8, v8
    v_exp_f32 v9, v9
    v_cvt_pk_bf16_f32 v66, v4, v5
    v_cvt_pk_bf16_f32 v67, v6, v7
    v_smfmac_f32_16x16x64_bf16 a[164:167], a[216:219], v[72:79], v111
    ds_read_b128 a[204:207], v96 offset:19456
    v_exp_f32 v10, v10
    v_exp_f32 v11, v11
    v_exp_f32 v12, v12
    v_exp_f32 v13, v13
    v_mfma_f32_32x32x16_bf16 a[144:159], a[212:215], v[76:79], a[144:159]
    buffer_load_dwordx4 v241, s[44:47], s72 offen offset:1024 lds
    buffer_load_dwordx4 v242, s[44:47], s72 offen offset:2048 lds
    v_cvt_pk_bf16_f32 v68, v8, v9
    v_cvt_pk_bf16_f32 v69, v10, v11
    v_exp_f32 v14, v14
    v_exp_f32 v15, v15
    v_cvt_pk_bf16_f32 v70, v12, v13
    v_cvt_pk_bf16_f32 v71, v14, v15
    s_waitcnt lgkmcnt(0)
    v_mfma_f32_32x32x16_bf16 v[0:15], a[192:195], a[168:171], v[32:47]
    buffer_load_dwordx4 v243, s[44:47], s72 offen offset:3072 lds
    v_exp_f32 v16, v16
    v_exp_f32 v17, v17
    v_exp_f32 v18, v18
    v_exp_f32_e64 v19, v19
    v_mfma_f32_32x32x16_bf16 v[0:15], a[196:199], a[172:175], v[0:15]
    buffer_load_dwordx4 a[16:19], v254, s[36:39], s71 offen offset:0 sc1
    v_exp_f32 v20, v20
    v_exp_f32 v21, v21
    v_exp_f32 v22, v22
    v_exp_f32 v23, v23
    v_mfma_f32_32x32x16_bf16 a[128:143], a[200:203], v[64:67], a[128:143]
    buffer_load_dwordx4 a[20:23], v254, s[36:39], s71 offen offset:1024 sc1
    v_cvt_pk_bf16_f32 v72, v16, v17
    v_cvt_pk_bf16_f32 v73, v18, v19
    v_exp_f32 v24, v24
    v_exp_f32 v25, v25
    v_cvt_pk_bf16_f32 v74, v20, v21
    v_cvt_pk_bf16_f32 v75, v22, v23
    v_smfmac_f32_16x16x64_bf16 a[160:163], a[216:219], v[64:71], v111
    v_exp_f32 v26, v26
    v_exp_f32 v27, v27
    v_exp_f32 v28, v28
    v_exp_f32 v29, v29
    v_mfma_f32_32x32x16_bf16 a[128:143], a[204:207], v[68:71], a[128:143]
    v_cvt_pk_bf16_f32 v76, v24, v25
    v_cvt_pk_bf16_f32 v77, v26, v27
    v_exp_f32 v30, v30
    v_exp_f32 v31, v31
    v_cvt_pk_bf16_f32 v78, v28, v29
    v_cvt_pk_bf16_f32 v79, v30, v31
    v_mfma_f32_32x32x16_bf16 v[16:31], a[192:195], a[176:179], v[48:63]
    ds_read_b128 a[184:187], v96 offset:24576
    ds_read_b128 a[188:191], v96 offset:25600
    v_exp_f32 v0, v0
    v_exp_f32 v1, v1
    v_exp_f32 v2, v2
    v_exp_f32 v3, v3
    v_mfma_f32_32x32x16_bf16 v[16:31], a[196:199], a[180:183], v[16:31]
    ds_read_b128 a[208:211], v96 offset:22528
    ds_read_b128 a[212:215], v96 offset:23552
    v_exp_f32 v4, v4
    v_exp_f32 v5, v5
    v_exp_f32 v6, v6
    v_exp_f32 v7, v7
    v_mfma_f32_32x32x16_bf16 a[144:159], a[200:203], v[72:75], a[144:159]
    buffer_load_dwordx4 a[24:27], v254, s[36:39], s71 offen offset:2048 sc1
    buffer_load_dwordx4 a[28:31], v254, s[36:39], s71 offen offset:3072 sc1
    v_cvt_pk_bf16_f32 v64, v0, v1
    v_cvt_pk_bf16_f32 v65, v2, v3
    v_exp_f32 v8, v8
    v_exp_f32 v9, v9
    v_cvt_pk_bf16_f32 v66, v4, v5
    v_cvt_pk_bf16_f32 v67, v6, v7
    v_smfmac_f32_16x16x64_bf16 a[164:167], a[216:219], v[72:79], v111
    s_add_u32 s71, s71, 0x40000
    v_exp_f32 v10, v10
    v_exp_f32 v11, v11
    v_exp_f32 v12, v12
    v_exp_f32 v13, v13
    v_mfma_f32_32x32x16_bf16 a[144:159], a[204:207], v[76:79], a[144:159]
    v_cvt_pk_bf16_f32 v68, v8, v9
    v_cvt_pk_bf16_f32 v69, v10, v11
    v_exp_f32 v14, v14
    v_exp_f32 v15, v15
    v_cvt_pk_bf16_f32 v70, v12, v13
    v_cvt_pk_bf16_f32 v71, v14, v15
    s_waitcnt lgkmcnt(0)
    v_mfma_f32_32x32x16_bf16 v[0:15], a[184:187], a[168:171], v[32:47]
    s_add_u32 m0, s73, 24576
    v_exp_f32 v16, v16
    v_exp_f32 v17, v17
    v_exp_f32 v18, v18
    v_exp_f32_e64 v19, v19
    v_mfma_f32_32x32x16_bf16 v[0:15], a[188:191], a[172:175], v[0:15]
    s_add_u32 s72, s72, 0x20000
    v_exp_f32 v20, v20
    v_exp_f32 v21, v21
    v_exp_f32 v22, v22
    v_exp_f32 v23, v23
    v_mfma_f32_32x32x16_bf16 a[128:143], a[208:211], v[64:67], a[128:143]
    buffer_load_dwordx4 v240, s[44:47], s72 offen offset:0 lds
    v_cvt_pk_bf16_f32 v72, v16, v17
    v_cvt_pk_bf16_f32 v73, v18, v19
    v_exp_f32 v24, v24
    v_exp_f32 v25, v25
    v_cvt_pk_bf16_f32 v74, v20, v21
    v_cvt_pk_bf16_f32 v75, v22, v23
    v_smfmac_f32_16x16x64_bf16 a[160:163], a[216:219], v[64:71], v111
    buffer_load_dwordx4 v241, s[44:47], s72 offen offset:1024 lds
    v_exp_f32 v26, v26
    v_exp_f32 v27, v27
    v_exp_f32 v28, v28
    v_exp_f32 v29, v29
    v_mfma_f32_32x32x16_bf16 a[128:143], a[212:215], v[68:71], a[128:143]
    buffer_load_dwordx4 v242, s[44:47], s72 offen offset:2048 lds
    v_cvt_pk_bf16_f32 v76, v24, v25
    v_cvt_pk_bf16_f32 v77, v26, v27
    v_exp_f32 v30, v30
    v_exp_f32 v31, v31
    v_cvt_pk_bf16_f32 v78, v28, v29
    v_cvt_pk_bf16_f32 v79, v30, v31
    v_mfma_f32_32x32x16_bf16 v[16:31], a[184:187], a[176:179], v[48:63]
    ds_read_b128 a[192:195], v96 offset:28672
    v_exp_f32 v0, v0
    v_exp_f32 v1, v1
    v_exp_f32 v2, v2
    v_exp_f32 v3, v3
    v_mfma_f32_32x32x16_bf16 v[16:31], a[188:191], a[180:183], v[16:31]
    ds_read_b128 a[196:199], v96 offset:29696
    v_exp_f32 v4, v4
    v_exp_f32 v5, v5
    v_exp_f32 v6, v6
    v_exp_f32 v7, v7
    v_mfma_f32_32x32x16_bf16 a[144:159], a[208:211], v[72:75], a[144:159]
    ds_read_b128 a[200:203], v96 offset:26624
    v_cvt_pk_bf16_f32 v64, v0, v1
    v_cvt_pk_bf16_f32 v65, v2, v3
    v_exp_f32 v8, v8
    v_exp_f32 v9, v9
    v_cvt_pk_bf16_f32 v66, v4, v5
    v_cvt_pk_bf16_f32 v67, v6, v7
    v_smfmac_f32_16x16x64_bf16 a[164:167], a[216:219], v[72:79], v111
    ds_read_b128 a[204:207], v96 offset:27648
    v_exp_f32 v10, v10
    v_exp_f32 v11, v11
    v_exp_f32 v12, v12
    v_exp_f32 v13, v13
    v_mfma_f32_32x32x16_bf16 a[144:159], a[212:215], v[76:79], a[144:159]
    buffer_load_dwordx4 v243, s[44:47], s72 offen offset:3072 lds
    buffer_load_dwordx4 a[32:35], v254, s[36:39], s71 offen offset:0 sc1
    v_cvt_pk_bf16_f32 v68, v8, v9
    v_cvt_pk_bf16_f32 v69, v10, v11
    v_exp_f32 v14, v14
    v_exp_f32 v15, v15
    v_cvt_pk_bf16_f32 v70, v12, v13
    v_cvt_pk_bf16_f32 v71, v14, v15
    s_waitcnt lgkmcnt(0)
    v_mfma_f32_32x32x16_bf16 v[0:15], a[192:195], a[168:171], v[32:47]
    buffer_load_dwordx4 a[36:39], v254, s[36:39], s71 offen offset:1024 sc1
    v_exp_f32 v16, v16
    v_exp_f32 v17, v17
    v_exp_f32 v18, v18
    v_exp_f32_e64 v19, v19
    v_mfma_f32_32x32x16_bf16 v[0:15], a[196:199], a[172:175], v[0:15]
    buffer_load_dwordx4 a[40:43], v254, s[36:39], s71 offen offset:2048 sc1
    v_exp_f32 v20, v20
    v_exp_f32 v21, v21
    v_exp_f32 v22, v22
    v_exp_f32 v23, v23
    v_mfma_f32_32x32x16_bf16 a[128:143], a[200:203], v[64:67], a[128:143]
    buffer_load_dwordx4 a[44:47], v254, s[36:39], s71 offen offset:3072 sc1
    v_cvt_pk_bf16_f32 v72, v16, v17
    v_cvt_pk_bf16_f32 v73, v18, v19
    v_exp_f32 v24, v24
    v_exp_f32 v25, v25
    v_cvt_pk_bf16_f32 v74, v20, v21
    v_cvt_pk_bf16_f32 v75, v22, v23
    v_smfmac_f32_16x16x64_bf16 a[160:163], a[216:219], v[64:71], v111
    s_add_u32 s71, s71, 0x40000
    v_exp_f32 v26, v26
    v_exp_f32 v27, v27
    v_exp_f32 v28, v28
    v_exp_f32 v29, v29
    v_mfma_f32_32x32x16_bf16 a[128:143], a[204:207], v[68:71], a[128:143]
    v_cvt_pk_bf16_f32 v76, v24, v25
    v_cvt_pk_bf16_f32 v77, v26, v27
    v_exp_f32 v30, v30
    v_exp_f32 v31, v31
    v_cvt_pk_bf16_f32 v78, v28, v29
    v_cvt_pk_bf16_f32 v79, v30, v31
    s_barrier
    v_mfma_f32_32x32x16_bf16 v[16:31], a[192:195], a[176:179], v[48:63]
    ds_read_b128 a[208:211], v96 offset:30720
    ds_read_b128 a[212:215], v96 offset:31744
    v_exp_f32 v0, v0
    v_exp_f32 v1, v1
    v_exp_f32 v2, v2
    v_exp_f32_e64 v3, v3
    v_mfma_f32_32x32x16_bf16 v[16:31], a[196:199], a[180:183], v[16:31]
    s_add_u32 m0, s73, 65536
    s_add_u32 s72, s72, 0x20000
    v_exp_f32 v4, v4
    v_exp_f32 v5, v5
    v_exp_f32 v6, v6
    v_exp_f32 v7, v7
    v_mfma_f32_32x32x16_bf16 a[144:159], a[200:203], v[72:75], a[144:159]
    buffer_load_dwordx4 v240, s[44:47], s72 offen offset:0 lds
    buffer_load_dwordx4 v241, s[44:47], s72 offen offset:1024 lds
    v_cvt_pk_bf16_f32 v64, v0, v1
    v_cvt_pk_bf16_f32 v65, v2, v3
    v_exp_f32 v8, v8
    v_exp_f32 v9, v9
    v_cvt_pk_bf16_f32 v66, v4, v5
    v_cvt_pk_bf16_f32 v67, v6, v7
    v_smfmac_f32_16x16x64_bf16 a[164:167], a[216:219], v[72:79], v111
    buffer_load_dwordx4 v242, s[44:47], s72 offen offset:2048 lds
    buffer_load_dwordx4 v243, s[44:47], s72 offen offset:3072 lds
    v_exp_f32 v10, v10
    v_exp_f32 v11, v11
    v_exp_f32 v12, v12
    v_exp_f32 v13, v13
    v_mfma_f32_32x32x16_bf16 a[144:159], a[204:207], v[76:79], a[144:159]
    v_cvt_pk_bf16_f32 v68, v8, v9
    v_cvt_pk_bf16_f32 v69, v10, v11
    v_exp_f32 v14, v14
    v_exp_f32 v15, v15
    v_cvt_pk_bf16_f32 v70, v12, v13
    v_cvt_pk_bf16_f32 v71, v14, v15
    s_waitcnt lgkmcnt(0)
    buffer_load_dwordx4 a[48:51], v254, s[36:39], s71 offen offset:0 sc1
    v_exp_f32 v16, v16
    v_exp_f32 v17, v17
    v_exp_f32 v18, v18
    v_exp_f32_e64 v19, v19
    buffer_load_dwordx4 a[52:55], v254, s[36:39], s71 offen offset:1024 sc1
    v_exp_f32 v20, v20
    v_exp_f32 v21, v21
    v_exp_f32 v22, v22
    v_exp_f32 v23, v23
    v_mfma_f32_32x32x16_bf16 a[128:143], a[208:211], v[64:67], a[128:143]
    buffer_load_dwordx4 a[56:59], v254, s[36:39], s71 offen offset:2048 sc1
    v_cvt_pk_bf16_f32 v72, v16, v17
    v_cvt_pk_bf16_f32 v73, v18, v19
    v_exp_f32 v24, v24
    v_exp_f32 v25, v25
    v_cvt_pk_bf16_f32 v74, v20, v21
    v_cvt_pk_bf16_f32 v75, v22, v23
    v_smfmac_f32_16x16x64_bf16 a[160:163], a[216:219], v[64:71], v111
    buffer_load_dwordx4 a[60:63], v254, s[36:39], s71 offen offset:3072 sc1
    v_exp_f32 v26, v26
    v_exp_f32 v27, v27
    v_exp_f32 v28, v28
    v_exp_f32 v29, v29
    v_mfma_f32_32x32x16_bf16 a[128:143], a[212:215], v[68:71], a[128:143]
    s_add_u32 s71, s71, 0x40000
    s_xor_b32 s73, s73, 0x10000
    v_cvt_pk_bf16_f32 v76, v24, v25
    v_cvt_pk_bf16_f32 v77, v26, v27
    v_exp_f32 v30, v30
    v_exp_f32 v31, v31
    v_cvt_pk_bf16_f32 v78, v28, v29
    v_cvt_pk_bf16_f32 v79, v30, v31
    s_nop 0
    v_mfma_f32_32x32x16_bf16 a[144:159], a[208:211], v[72:75], a[144:159]
    v_mfma_f32_32x32x16_bf16 a[144:159], a[212:215], v[76:79], a[144:159]
    v_smfmac_f32_16x16x64_bf16 a[164:167], a[216:219], v[72:79], v111
    s_nop 0
    v_mov_b32 v100, 0x5f800000
    v_mov_b32 v98, 131008
    v_accvgpr_read_b32 v102, a160
    v_accvgpr_read_b32 v97, a161
    v_bfe_u32 v96, v255, 4, 1
    v_lshlrev_b32 v96, 10, v96
    v_lshrrev_b32 v99, 5, v255
    v_lshl_add_u32 v96, v99, 8, v96
    v_and_b32_e64 v99, 15, v255
    v_lshl_add_u32 v101, v99, 4, v96
    v_add_f32 v102, v102, v97
    s_nop 1
    v_accvgpr_read_b32 v103, a164
    v_accvgpr_read_b32 v97, a165
    s_nop 0
    v_add_f32 v103, v103, v97
    v_mov_b32 v96, v102
    v_mov_b32 v97, v103
    s_nop 0
    v_permlane32_swap_b32 v102, v96
    v_permlane32_swap_b32 v103, v97
    s_mov_b32 s85, 0
    v_add_f32 v99, v102, v103
    v_cmp_nle_f32 vcc, v99, v100
    s_cmp_eq_u64 vcc, 0
    s_cbranch_scc1 AT_ok
    v_mov_b32_e64 v99, 1
    ds_write_b32 v98, v99
AT_ok:
    s_waitcnt vmcnt(32) lgkmcnt(0)
    s_barrier
    ds_read_b32 v100, v98
    ds_read_b64_tr_b16 a[64:65], v244 offset:0
    ds_read_b64_tr_b16 a[66:67], v244 offset:4096
    ds_read_b64_tr_b16 a[68:69], v245 offset:0
    ds_read_b64_tr_b16 a[70:71], v245 offset:4096
    ds_read_b64_tr_b16 a[72:73], v246 offset:0
    ds_read_b64_tr_b16 a[74:75], v246 offset:4096
    ds_read_b64_tr_b16 a[76:77], v247 offset:0
    ds_read_b64_tr_b16 a[78:79], v247 offset:4096
    ds_read_b64_tr_b16 a[80:81], v248 offset:0
    ds_read_b64_tr_b16 a[82:83], v248 offset:4096
    ds_read_b64_tr_b16 a[84:85], v249 offset:0
    ds_read_b64_tr_b16 a[86:87], v249 offset:4096
    ds_read_b64_tr_b16 a[88:89], v250 offset:0
    ds_read_b64_tr_b16 a[90:91], v250 offset:4096
    ds_read_b64_tr_b16 a[92:93], v251 offset:0
    ds_read_b64_tr_b16 a[94:95], v251 offset:4096
    s_add_u32 s90, s90, 0xc00000
    v_mul_f32 v102, v102, v104
    v_rcp_f32 v102, v102
    v_mul_f32 v103, v103, v105
    v_rcp_f32 v103, v103
    s_waitcnt lgkmcnt(15)
    v_readfirstlane_b32 s3, v100
    s_cmp_eq_u32 s84, 1
    s_cselect_b32 s3, s3, 0
    s_cmp_eq_u32 s3, 0
    s_cbranch_scc1 G2_start
    s_mov_b32 s84, 64
    s_waitcnt vmcnt(0) lgkmcnt(0)
    s_barrier
    s_branch AT_init
AT_hpoll_far:
    v_min_u32 v253, 15, v255
    v_lshlrev_b32 v253, 7, v253
AT_hpoll:
    buffer_load_dword v252, v253, s[36:39], s23 offen offset:0 sc1
    s_waitcnt vmcnt(0)
    v_cmp_eq_u32 vcc, s95, v252
    s_and_b32 s3, vcc_lo, 0xffff
    s_cmp_eq_u32 s3, 0xffff
    s_cbranch_scc1 AT_hpoll_ok
    s_sleep 1
    s_sub_u32 s12, s12, 1
    s_cmp_gt_i32 s12, 0
    s_cbranch_scc1 AT_hpoll
AT_hpoll_ok:
    s_branch AT_hpoll_back
G2_start:
    s_waitcnt vmcnt(24) lgkmcnt(0)
    s_barrier
    v_mfma_f32_16x16x32_bf16 v[112:115], a[64:67], a[0:3], 0
    ds_read_b64_tr_b16 a[96:97], v244 offset:8192
    ds_read_b64_tr_b16 a[98:99], v244 offset:12288
    v_mfma_f32_16x16x32_bf16 v[116:119], a[68:71], a[0:3], 0
    ds_read_b64_tr_b16 a[100:101], v245 offset:8192
    s_add_u32 m0, s73, 8192
    v_mfma_f32_16x16x32_bf16 v[120:123], a[72:75], a[0:3], 0
    v_accvgpr_read_b32 v32, a128
    v_accvgpr_read_b32 v33, a129
    v_mfma_f32_16x16x32_bf16 v[124:127], a[76:79], a[0:3], 0
    v_accvgpr_read_b32 v34, a130
    v_mfma_f32_16x16x32_bf16 v[176:179], a[80:83], a[0:3], 0
    v_accvgpr_read_b32 v35, a131
    ds_read_b64_tr_b16 a[102:103], v245 offset:12288
    v_mfma_f32_16x16x32_bf16 v[180:183], a[84:87], a[0:3], 0
    ds_read_b64_tr_b16 a[104:105], v246 offset:8192
    ds_read_b64_tr_b16 a[106:107], v246 offset:12288
    v_mfma_f32_16x16x32_bf16 v[184:187], a[88:91], a[0:3], 0
    s_add_u32 s72, s72, 0x20000
    v_accvgpr_read_b32 v40, a136
    v_mfma_f32_16x16x32_bf16 v[188:191], a[92:95], a[0:3], 0
    v_accvgpr_read_b32 v41, a137
    v_mfma_f32_16x16x32_bf16 v[204:207], a[92:95], a[4:7], 0
    v_accvgpr_read_b32 v42, a138
    v_accvgpr_read_b32 v43, a139
    v_mfma_f32_16x16x32_bf16 v[200:203], a[88:91], a[4:7], 0
    ds_read_b64_tr_b16 a[108:109], v247 offset:8192
    ds_read_b64_tr_b16 a[110:111], v247 offset:12288
    v_mfma_f32_16x16x32_bf16 v[196:199], a[84:87], a[4:7], 0
    ds_read_b64_tr_b16 a[112:113], v248 offset:8192
    v_mfma_f32_16x16x32_bf16 v[192:195], a[80:83], a[4:7], 0
    buffer_load_dwordx4 v240, s[44:47], s72 offen offset:0 lds
    v_accvgpr_read_b32 v36, a132
    v_mfma_f32_16x16x32_bf16 v[140:143], a[76:79], a[4:7], 0
    v_accvgpr_read_b32 v37, a133
    v_accvgpr_read_b32 v38, a134
    v_mfma_f32_16x16x32_bf16 v[136:139], a[72:75], a[4:7], 0
    v_accvgpr_read_b32 v39, a135
    ds_read_b64_tr_b16 a[114:115], v248 offset:12288
    v_mfma_f32_16x16x32_bf16 v[132:135], a[68:71], a[4:7], 0
    ds_read_b64_tr_b16 a[116:117], v249 offset:8192
    v_mfma_f32_16x16x32_bf16 v[128:131], a[64:67], a[4:7], 0
    ds_read_b64_tr_b16 a[118:119], v249 offset:12288
    buffer_load_dwordx4 v241, s[44:47], s72 offen offset:1024 lds
    v_mfma_f32_16x16x32_bf16 v[144:147], a[64:67], a[8:11], 0
    v_accvgpr_read_b32 v44, a140
    v_accvgpr_read_b32 v45, a141
    v_mfma_f32_16x16x32_bf16 v[148:151], a[68:71], a[8:11], 0
    v_accvgpr_read_b32 v46, a142
    v_mfma_f32_16x16x32_bf16 v[152:155], a[72:75], a[8:11], 0
    v_accvgpr_read_b32 v47, a143
    ds_read_b64_tr_b16 a[120:121], v250 offset:8192
    v_mfma_f32_16x16x32_bf16 v[156:159], a[76:79], a[8:11], 0
    ds_read_b64_tr_b16 a[122:123], v250 offset:12288
    ds_read_b64_tr_b16 a[124:125], v251 offset:8192
    v_mfma_f32_16x16x32_bf16 v[208:211], a[80:83], a[8:11], 0
    buffer_load_dwordx4 v242, s[44:47], s72 offen offset:2048 lds
    v_mul_f32_e64 v32, v32, v102
    v_mfma_f32_16x16x32_bf16 v[212:215], a[84:87], a[8:11], 0
    v_mul_f32_e64 v33, v33, v102
    v_mfma_f32_16x16x32_bf16 v[216:219], a[88:91], a[8:11], 0
    v_mul_f32 v34, v34, v102
    v_mul_f32 v35, v35, v102
    v_mfma_f32_16x16x32_bf16 v[220:223], a[92:95], a[8:11], 0
    ds_read_b64_tr_b16 a[126:127], v251 offset:12288
    buffer_load_dwordx4 v243, s[44:47], s72 offen offset:3072 lds
    v_mfma_f32_16x16x32_bf16 v[236:239], a[92:95], a[12:15], 0
    v_mul_f32_e64 v40, v40, v102
    v_mfma_f32_16x16x32_bf16 v[232:235], a[88:91], a[12:15], 0
    buffer_load_dwordx4 a[0:3], v254, s[36:39], s71 offen offset:0 sc1
    v_mfma_f32_16x16x32_bf16 v[228:231], a[84:87], a[12:15], 0
    v_mfma_f32_16x16x32_bf16 v[224:227], a[80:83], a[12:15], 0
    buffer_load_dwordx4 a[4:7], v254, s[36:39], s71 offen offset:1024 sc1
    v_mfma_f32_16x16x32_bf16 v[172:175], a[76:79], a[12:15], 0
    v_mfma_f32_16x16x32_bf16 v[168:171], a[72:75], a[12:15], 0
    buffer_load_dwordx4 a[8:11], v254, s[36:39], s71 offen offset:2048 sc1
    v_mfma_f32_16x16x32_bf16 v[164:167], a[68:71], a[12:15], 0
    v_mfma_f32_16x16x32_bf16 v[160:163], a[64:67], a[12:15], 0
    buffer_load_dwordx4 a[12:15], v254, s[36:39], s71 offen offset:3072 sc1
    s_add_u32 s71, s71, 0x40000
    s_waitcnt vmcnt(24) lgkmcnt(0)
    s_barrier
    v_mfma_f32_16x16x32_bf16 v[112:115], a[96:99], a[16:19], v[112:115]
    ds_read_b64_tr_b16 a[64:65], v244 offset:16384
    ds_read_b64_tr_b16 a[66:67], v244 offset:20480
    v_mfma_f32_16x16x32_bf16 v[116:119], a[100:103], a[16:19], v[116:119]
    ds_read_b64_tr_b16 a[68:69], v245 offset:16384
    s_add_u32 m0, s73, 16384
    v_mfma_f32_16x16x32_bf16 v[120:123], a[104:107], a[16:19], v[120:123]
    v_mul_f32 v41, v41, v102
    v_mul_f32 v42, v42, v102
    v_mfma_f32_16x16x32_bf16 v[124:127], a[108:111], a[16:19], v[124:127]
    v_mul_f32_e64 v43, v43, v102
    v_mfma_f32_16x16x32_bf16 v[176:179], a[112:115], a[16:19], v[176:179]
    v_mul_f32_e64 v36, v36, v102
    ds_read_b64_tr_b16 a[70:71], v245 offset:20480
    v_mfma_f32_16x16x32_bf16 v[180:183], a[116:119], a[16:19], v[180:183]
    ds_read_b64_tr_b16 a[72:73], v246 offset:16384
    ds_read_b64_tr_b16 a[74:75], v246 offset:20480
    v_mfma_f32_16x16x32_bf16 v[184:187], a[120:123], a[16:19], v[184:187]
    s_add_u32 s72, s72, 0x20000
    v_mul_f32_e64 v37, v37, v102
    v_mfma_f32_16x16x32_bf16 v[188:191], a[124:127], a[16:19], v[188:191]
    v_mul_f32_e64 v38, v38, v102
    v_mfma_f32_16x16x32_bf16 v[204:207], a[124:127], a[20:23], v[204:207]
    v_mul_f32 v39, v39, v102
    v_mul_f32 v44, v44, v102
    v_mfma_f32_16x16x32_bf16 v[200:203], a[120:123], a[20:23], v[200:203]
    ds_read_b64_tr_b16 a[76:77], v247 offset:16384
    ds_read_b64_tr_b16 a[78:79], v247 offset:20480
    v_mfma_f32_16x16x32_bf16 v[196:199], a[116:119], a[20:23], v[196:199]
    ds_read_b64_tr_b16 a[80:81], v248 offset:16384
    v_mfma_f32_16x16x32_bf16 v[192:195], a[112:115], a[20:23], v[192:195]
    buffer_load_dwordx4 v240, s[44:47], s72 offen offset:0 lds
    v_mul_f32_e64 v45, v45, v102
    v_mfma_f32_16x16x32_bf16 v[140:143], a[108:111], a[20:23], v[140:143]
    v_mul_f32 v46, v46, v102
    v_mul_f32 v47, v47, v102
    v_mfma_f32_16x16x32_bf16 v[136:139], a[104:107], a[20:23], v[136:139]
    v_cvt_pk_bf16_f32 v80, v32, v33
    ds_read_b64_tr_b16 a[82:83], v248 offset:20480
    v_mfma_f32_16x16x32_bf16 v[132:135], a[100:103], a[20:23], v[132:135]
    ds_read_b64_tr_b16 a[84:85], v249 offset:16384
    v_mfma_f32_16x16x32_bf16 v[128:131], a[96:99], a[20:23], v[128:131]
    ds_read_b64_tr_b16 a[86:87], v249 offset:20480
    buffer_load_dwordx4 v241, s[44:47], s72 offen offset:1024 lds
    v_mfma_f32_16x16x32_bf16 v[144:147], a[96:99], a[24:27], v[144:147]
    v_cvt_pk_bf16_f32 v81, v34, v35
    v_cvt_pk_bf16_f32 v82, v40, v41
    v_mfma_f32_16x16x32_bf16 v[148:151], a[100:103], a[24:27], v[148:151]
    v_cvt_pk_bf16_f32 v83, v42, v43
    v_mfma_f32_16x16x32_bf16 v[152:155], a[104:107], a[24:27], v[152:155]
    buffer_store_dwordx4 v[80:83], v101, s[36:39], s90 offen offset:0 sc1
    ds_read_b64_tr_b16 a[88:89], v250 offset:16384
    v_mfma_f32_16x16x32_bf16 v[156:159], a[108:111], a[24:27], v[156:159]
    ds_read_b64_tr_b16 a[90:91], v250 offset:20480
    ds_read_b64_tr_b16 a[92:93], v251 offset:16384
    v_mfma_f32_16x16x32_bf16 v[208:211], a[112:115], a[24:27], v[208:211]
    buffer_load_dwordx4 v242, s[44:47], s72 offen offset:2048 lds
    v_cvt_pk_bf16_f32 v84, v36, v37
    v_mfma_f32_16x16x32_bf16 v[212:215], a[116:119], a[24:27], v[212:215]
    v_cvt_pk_bf16_f32 v85, v38, v39
    v_mfma_f32_16x16x32_bf16 v[216:219], a[120:123], a[24:27], v[216:219]
    v_cvt_pk_bf16_f32 v86, v44, v45
    v_cvt_pk_bf16_f32 v87, v46, v47
    v_mfma_f32_16x16x32_bf16 v[220:223], a[124:127], a[24:27], v[220:223]
    ds_read_b64_tr_b16 a[94:95], v251 offset:20480
    buffer_load_dwordx4 v243, s[44:47], s72 offen offset:3072 lds
    v_mfma_f32_16x16x32_bf16 v[236:239], a[124:127], a[28:31], v[236:239]
    buffer_store_dwordx4 v[84:87], v101, s[36:39], s90 offen offset:512 sc1
    v_mfma_f32_16x16x32_bf16 v[232:235], a[120:123], a[28:31], v[232:235]
    buffer_load_dwordx4 a[16:19], v254, s[36:39], s71 offen offset:0 sc1
    v_mfma_f32_16x16x32_bf16 v[228:231], a[116:119], a[28:31], v[228:231]
    v_mfma_f32_16x16x32_bf16 v[224:227], a[112:115], a[28:31], v[224:227]
    buffer_load_dwordx4 a[20:23], v254, s[36:39], s71 offen offset:1024 sc1
    v_mfma_f32_16x16x32_bf16 v[172:175], a[108:111], a[28:31], v[172:175]
    v_mfma_f32_16x16x32_bf16 v[168:171], a[104:107], a[28:31], v[168:171]
    buffer_load_dwordx4 a[24:27], v254, s[36:39], s71 offen offset:2048 sc1
    v_mfma_f32_16x16x32_bf16 v[164:167], a[100:103], a[28:31], v[164:167]
    v_mfma_f32_16x16x32_bf16 v[160:163], a[96:99], a[28:31], v[160:163]
    buffer_load_dwordx4 a[28:31], v254, s[36:39], s71 offen offset:3072 sc1
    s_add_u32 s71, s71, 0x40000
    s_waitcnt vmcnt(24) lgkmcnt(0)
    s_barrier
    v_mfma_f32_16x16x32_bf16 v[112:115], a[64:67], a[32:35], v[112:115]
    ds_read_b64_tr_b16 a[96:97], v244 offset:24576
    ds_read_b64_tr_b16 a[98:99], v244 offset:28672
    ds_read_b64_tr_b16 a[100:101], v245 offset:24576
    v_mfma_f32_16x16x32_bf16 v[116:119], a[68:71], a[32:35], v[116:119]
    s_add_u32 m0, s73, 24576
    v_accvgpr_read_b32 v48, a144
    v_mfma_f32_16x16x32_bf16 v[120:123], a[72:75], a[32:35], v[120:123]
    v_accvgpr_read_b32 v49, a145
    v_accvgpr_read_b32 v50, a146
    v_mfma_f32_16x16x32_bf16 v[124:127], a[76:79], a[32:35], v[124:127]
    v_accvgpr_read_b32 v51, a147
    ds_read_b64_tr_b16 a[102:103], v245 offset:28672
    v_mfma_f32_16x16x32_bf16 v[176:179], a[80:83], a[32:35], v[176:179]
    ds_read_b64_tr_b16 a[104:105], v246 offset:24576
    ds_read_b64_tr_b16 a[106:107], v246 offset:28672
    v_mfma_f32_16x16x32_bf16 v[180:183], a[84:87], a[32:35], v[180:183]
    s_add_u32 s72, s72, 0x20000
    v_accvgpr_read_b32 v56, a152
    v_mfma_f32_16x16x32_bf16 v[184:187], a[88:91], a[32:35], v[184:187]
    v_accvgpr_read_b32 v57, a153
    v_accvgpr_read_b32 v58, a154
    v_mfma_f32_16x16x32_bf16 v[188:191], a[92:95], a[32:35], v[188:191]
    v_accvgpr_read_b32 v59, a155
    ds_read_b64_tr_b16 a[108:109], v247 offset:24576
    v_mfma_f32_16x16x32_bf16 v[204:207], a[92:95], a[36:39], v[204:207]
    ds_read_b64_tr_b16 a[110:111], v247 offset:28672
    ds_read_b64_tr_b16 a[112:113], v248 offset:24576
    v_mfma_f32_16x16x32_bf16 v[200:203], a[88:91], a[36:39], v[200:203]
    buffer_load_dwordx4 v240, s[44:47], s72 offen offset:0 lds
    v_accvgpr_read_b32 v52, a148
    v_mfma_f32_16x16x32_bf16 v[196:199], a[84:87], a[36:39], v[196:199]
    v_accvgpr_read_b32 v53, a149
    v_accvgpr_read_b32 v54, a150
    v_mfma_f32_16x16x32_bf16 v[192:195], a[80:83], a[36:39], v[192:195]
    v_accvgpr_read_b32 v55, a151
    ds_read_b64_tr_b16 a[114:115], v248 offset:28672
    v_mfma_f32_16x16x32_bf16 v[140:143], a[76:79], a[36:39], v[140:143]
    ds_read_b64_tr_b16 a[116:117], v249 offset:24576
    ds_read_b64_tr_b16 a[118:119], v249 offset:28672
    v_mfma_f32_16x16x32_bf16 v[136:139], a[72:75], a[36:39], v[136:139]
    buffer_load_dwordx4 v241, s[44:47], s72 offen offset:1024 lds
    v_accvgpr_read_b32 v60, a156
    v_mfma_f32_16x16x32_bf16 v[132:135], a[68:71], a[36:39], v[132:135]
    v_accvgpr_read_b32 v61, a157
    v_accvgpr_read_b32 v62, a158
    v_mfma_f32_16x16x32_bf16 v[128:131], a[64:67], a[36:39], v[128:131]
    v_accvgpr_read_b32 v63, a159
    ds_read_b64_tr_b16 a[120:121], v250 offset:24576
    v_mfma_f32_16x16x32_bf16 v[144:147], a[64:67], a[40:43], v[144:147]
    ds_read_b64_tr_b16 a[122:123], v250 offset:28672
    ds_read_b64_tr_b16 a[124:125], v251 offset:24576
    v_mfma_f32_16x16x32_bf16 v[148:151], a[68:71], a[40:43], v[148:151]
    buffer_load_dwordx4 v242, s[44:47], s72 offen offset:2048 lds
    v_mul_f32_e64 v48, v48, v103
    v_mfma_f32_16x16x32_bf16 v[152:155], a[72:75], a[40:43], v[152:155]
    v_mul_f32 v49, v49, v103
    v_mul_f32 v50, v50, v103
    v_mfma_f32_16x16x32_bf16 v[156:159], a[76:79], a[40:43], v[156:159]
    v_mul_f32_e64 v51, v51, v103
    ds_read_b64_tr_b16 a[126:127], v251 offset:28672
    v_mfma_f32_16x16x32_bf16 v[208:211], a[80:83], a[40:43], v[208:211]
    buffer_load_dwordx4 v243, s[44:47], s72 offen offset:3072 lds
    v_mul_f32_e64 v56, v56, v103
    v_mfma_f32_16x16x32_bf16 v[212:215], a[84:87], a[40:43], v[212:215]
    v_xor_b32 v244, 0x10000, v244
    v_xor_b32 v245, 0x10000, v245
    v_mfma_f32_16x16x32_bf16 v[216:219], a[88:91], a[40:43], v[216:219]
    v_xor_b32 v246, 0x10000, v246
    v_xor_b32 v247, 0x10000, v247
    v_mfma_f32_16x16x32_bf16 v[220:223], a[92:95], a[40:43], v[220:223]
    v_xor_b32 v248, 0x10000, v248
    v_xor_b32 v249, 0x10000, v249
    v_mfma_f32_16x16x32_bf16 v[236:239], a[92:95], a[44:47], v[236:239]
    v_xor_b32 v250, 0x10000, v250
    v_xor_b32 v251, 0x10000, v251
    v_mfma_f32_16x16x32_bf16 v[232:235], a[88:91], a[44:47], v[232:235]
    buffer_load_dwordx4 a[32:35], v254, s[36:39], s71 offen offset:0 sc1
    v_mfma_f32_16x16x32_bf16 v[228:231], a[84:87], a[44:47], v[228:231]
    v_mfma_f32_16x16x32_bf16 v[224:227], a[80:83], a[44:47], v[224:227]
    buffer_load_dwordx4 a[36:39], v254, s[36:39], s71 offen offset:1024 sc1
    v_mfma_f32_16x16x32_bf16 v[172:175], a[76:79], a[44:47], v[172:175]
    v_mfma_f32_16x16x32_bf16 v[168:171], a[72:75], a[44:47], v[168:171]
    buffer_load_dwordx4 a[40:43], v254, s[36:39], s71 offen offset:2048 sc1
    v_mfma_f32_16x16x32_bf16 v[164:167], a[68:71], a[44:47], v[164:167]
    v_mfma_f32_16x16x32_bf16 v[160:163], a[64:67], a[44:47], v[160:163]
    buffer_load_dwordx4 a[44:47], v254, s[36:39], s71 offen offset:3072 sc1
    s_add_u32 s71, s71, 0x40000
    s_waitcnt vmcnt(24) lgkmcnt(0)
    s_barrier
    v_mfma_f32_16x16x32_bf16 v[112:115], a[96:99], a[48:51], v[112:115]
    s_xor_b32 s73, s73, 0x10000
    ds_read_b64_tr_b16 a[64:65], v244 offset:0
    v_mfma_f32_16x16x32_bf16 v[116:119], a[100:103], a[48:51], v[116:119]
    ds_read_b64_tr_b16 a[66:67], v244 offset:4096
    ds_read_b64_tr_b16 a[68:69], v245 offset:0
    v_mfma_f32_16x16x32_bf16 v[120:123], a[104:107], a[48:51], v[120:123]
    s_add_u32 m0, s73, 0
    v_mul_f32 v57, v57, v103
    v_mfma_f32_16x16x32_bf16 v[124:127], a[108:111], a[48:51], v[124:127]
    v_mul_f32 v58, v58, v103
    v_mul_f32 v59, v59, v103
    v_mfma_f32_16x16x32_bf16 v[176:179], a[112:115], a[48:51], v[176:179]
    v_mul_f32_e64 v52, v52, v103
    ds_read_b64_tr_b16 a[70:71], v245 offset:4096
    v_mfma_f32_16x16x32_bf16 v[180:183], a[116:119], a[48:51], v[180:183]
    ds_read_b64_tr_b16 a[72:73], v246 offset:0
    ds_read_b64_tr_b16 a[74:75], v246 offset:4096
    v_mfma_f32_16x16x32_bf16 v[184:187], a[120:123], a[48:51], v[184:187]
    s_add_u32 s72, s72, 0x20000
    v_mul_f32_e64 v53, v53, v103
    v_mfma_f32_16x16x32_bf16 v[188:191], a[124:127], a[48:51], v[188:191]
    v_mul_f32 v54, v54, v103
    v_mul_f32 v55, v55, v103
    v_mfma_f32_16x16x32_bf16 v[204:207], a[124:127], a[52:55], v[204:207]
    v_mul_f32_e64 v60, v60, v103
    ds_read_b64_tr_b16 a[76:77], v247 offset:0
    v_mfma_f32_16x16x32_bf16 v[200:203], a[120:123], a[52:55], v[200:203]
    ds_read_b64_tr_b16 a[78:79], v247 offset:4096
    ds_read_b64_tr_b16 a[80:81], v248 offset:0
    v_mfma_f32_16x16x32_bf16 v[196:199], a[116:119], a[52:55], v[196:199]
    buffer_load_dwordx4 v240, s[44:47], s72 offen offset:0 lds
    v_mul_f32_e64 v61, v61, v103
    v_mfma_f32_16x16x32_bf16 v[192:195], a[112:115], a[52:55], v[192:195]
    v_mul_f32 v62, v62, v103
    v_mul_f32 v63, v63, v103
    v_mfma_f32_16x16x32_bf16 v[140:143], a[108:111], a[52:55], v[140:143]
    v_cvt_pk_bf16_f32 v88, v48, v49
    ds_read_b64_tr_b16 a[82:83], v248 offset:4096
    v_mfma_f32_16x16x32_bf16 v[136:139], a[104:107], a[52:55], v[136:139]
    ds_read_b64_tr_b16 a[84:85], v249 offset:0
    ds_read_b64_tr_b16 a[86:87], v249 offset:4096
    v_mfma_f32_16x16x32_bf16 v[132:135], a[100:103], a[52:55], v[132:135]
    buffer_load_dwordx4 v241, s[44:47], s72 offen offset:1024 lds
    v_cvt_pk_bf16_f32 v89, v50, v51
    v_mfma_f32_16x16x32_bf16 v[128:131], a[96:99], a[52:55], v[128:131]
    v_cvt_pk_bf16_f32 v90, v56, v57
    v_cvt_pk_bf16_f32 v91, v58, v59
    v_mfma_f32_16x16x32_bf16 v[144:147], a[96:99], a[56:59], v[144:147]
    buffer_store_dwordx4 v[88:91], v101, s[36:39], s90 offen offset:2048 sc1
    ds_read_b64_tr_b16 a[88:89], v250 offset:0
    v_mfma_f32_16x16x32_bf16 v[148:151], a[100:103], a[56:59], v[148:151]
    ds_read_b64_tr_b16 a[90:91], v250 offset:4096
    ds_read_b64_tr_b16 a[92:93], v251 offset:0
    v_mfma_f32_16x16x32_bf16 v[152:155], a[104:107], a[56:59], v[152:155]
    buffer_load_dwordx4 v242, s[44:47], s72 offen offset:2048 lds
    v_cvt_pk_bf16_f32 v92, v52, v53
    v_mfma_f32_16x16x32_bf16 v[156:159], a[108:111], a[56:59], v[156:159]
    v_cvt_pk_bf16_f32 v93, v54, v55
    v_cvt_pk_bf16_f32 v94, v60, v61
    v_mfma_f32_16x16x32_bf16 v[208:211], a[112:115], a[56:59], v[208:211]
    v_cvt_pk_bf16_f32 v95, v62, v63
    ds_read_b64_tr_b16 a[94:95], v251 offset:4096
    v_mfma_f32_16x16x32_bf16 v[212:215], a[116:119], a[56:59], v[212:215]
    buffer_load_dwordx4 v243, s[44:47], s72 offen offset:3072 lds
    buffer_store_dwordx4 v[92:95], v101, s[36:39], s90 offen offset:2560 sc1
    v_mfma_f32_16x16x32_bf16 v[216:219], a[120:123], a[56:59], v[216:219]
    v_min_u32 v71, 31, v255
    v_lshlrev_b32 v71, 7, v71
    v_mfma_f32_16x16x32_bf16 v[220:223], a[124:127], a[56:59], v[220:223]
    v_lshrrev_b32 v67, 4, v255
    v_and_b32 v68, 15, v255
    v_mfma_f32_16x16x32_bf16 v[236:239], a[124:127], a[60:63], v[236:239]
    s_mov_b32 s74, 1
    v_mfma_f32_16x16x32_bf16 v[232:235], a[120:123], a[60:63], v[232:235]
    buffer_load_dwordx4 a[48:51], v254, s[36:39], s71 offen offset:0 sc1
    v_mfma_f32_16x16x32_bf16 v[228:231], a[116:119], a[60:63], v[228:231]
    v_mfma_f32_16x16x32_bf16 v[224:227], a[112:115], a[60:63], v[224:227]
    buffer_load_dwordx4 a[52:55], v254, s[36:39], s71 offen offset:1024 sc1
    v_mfma_f32_16x16x32_bf16 v[172:175], a[108:111], a[60:63], v[172:175]
    v_mfma_f32_16x16x32_bf16 v[168:171], a[104:107], a[60:63], v[168:171]
    buffer_load_dwordx4 a[56:59], v254, s[36:39], s71 offen offset:2048 sc1
    v_mfma_f32_16x16x32_bf16 v[164:167], a[100:103], a[60:63], v[164:167]
    v_mfma_f32_16x16x32_bf16 v[160:163], a[96:99], a[60:63], v[160:163]
    buffer_load_dwordx4 a[60:63], v254, s[36:39], s71 offen offset:3072 sc1
    s_add_u32 s71, s71, 0x40000
.p2align 6
G2_loop:
    s_cmp_eq_u32 s74, s75
    s_cbranch_scc1 G2_swA
G2_swA_back:
    s_waitcnt vmcnt(24) lgkmcnt(0)
    s_barrier
    v_mfma_f32_16x16x32_bf16 v[112:115], a[64:67], a[0:3], v[112:115]
    ds_read_b64_tr_b16 a[96:97], v244 offset:8192
    v_mfma_f32_16x16x32_bf16 v[116:119], a[68:71], a[0:3], v[116:119]
    ds_read_b64_tr_b16 a[98:99], v244 offset:12288
    v_mfma_f32_16x16x32_bf16 v[120:123], a[72:75], a[0:3], v[120:123]
    ds_read_b64_tr_b16 a[100:101], v245 offset:8192
    v_mfma_f32_16x16x32_bf16 v[124:127], a[76:79], a[0:3], v[124:127]
    s_add_u32 m0, s73, 8192
    v_mfma_f32_16x16x32_bf16 v[176:179], a[80:83], a[0:3], v[176:179]
    ds_read_b64_tr_b16 a[102:103], v245 offset:12288
    v_mfma_f32_16x16x32_bf16 v[180:183], a[84:87], a[0:3], v[180:183]
    ds_read_b64_tr_b16 a[104:105], v246 offset:8192
    v_mfma_f32_16x16x32_bf16 v[184:187], a[88:91], a[0:3], v[184:187]
    ds_read_b64_tr_b16 a[106:107], v246 offset:12288
    v_mfma_f32_16x16x32_bf16 v[188:191], a[92:95], a[0:3], v[188:191]
    s_add_u32 s72, s72, 0x20000
    v_mfma_f32_16x16x32_bf16 v[204:207], a[92:95], a[4:7], v[204:207]
    v_mfma_f32_16x16x32_bf16 v[200:203], a[88:91], a[4:7], v[200:203]
    ds_read_b64_tr_b16 a[108:109], v247 offset:8192
    v_mfma_f32_16x16x32_bf16 v[196:199], a[84:87], a[4:7], v[196:199]
    ds_read_b64_tr_b16 a[110:111], v247 offset:12288
    v_mfma_f32_16x16x32_bf16 v[192:195], a[80:83], a[4:7], v[192:195]
    ds_read_b64_tr_b16 a[112:113], v248 offset:8192
    v_mfma_f32_16x16x32_bf16 v[140:143], a[76:79], a[4:7], v[140:143]
    buffer_load_dwordx4 v240, s[44:47], s72 offen offset:0 lds
    v_mfma_f32_16x16x32_bf16 v[136:139], a[72:75], a[4:7], v[136:139]
    ds_read_b64_tr_b16 a[114:115], v248 offset:12288
    v_mfma_f32_16x16x32_bf16 v[132:135], a[68:71], a[4:7], v[132:135]
    ds_read_b64_tr_b16 a[116:117], v249 offset:8192
    v_mfma_f32_16x16x32_bf16 v[128:131], a[64:67], a[4:7], v[128:131]
    ds_read_b64_tr_b16 a[118:119], v249 offset:12288
    v_mfma_f32_16x16x32_bf16 v[144:147], a[64:67], a[8:11], v[144:147]
    v_mfma_f32_16x16x32_bf16 v[148:151], a[68:71], a[8:11], v[148:151]
    buffer_load_dwordx4 v241, s[44:47], s72 offen offset:1024 lds
    v_mfma_f32_16x16x32_bf16 v[152:155], a[72:75], a[8:11], v[152:155]
    ds_read_b64_tr_b16 a[120:121], v250 offset:8192
    v_mfma_f32_16x16x32_bf16 v[156:159], a[76:79], a[8:11], v[156:159]
    ds_read_b64_tr_b16 a[122:123], v250 offset:12288
    v_mfma_f32_16x16x32_bf16 v[208:211], a[80:83], a[8:11], v[208:211]
    ds_read_b64_tr_b16 a[124:125], v251 offset:8192
    v_mfma_f32_16x16x32_bf16 v[212:215], a[84:87], a[8:11], v[212:215]
    buffer_load_dwordx4 v242, s[44:47], s72 offen offset:2048 lds
    v_mfma_f32_16x16x32_bf16 v[216:219], a[88:91], a[8:11], v[216:219]
    ds_read_b64_tr_b16 a[126:127], v251 offset:12288
    v_mfma_f32_16x16x32_bf16 v[220:223], a[92:95], a[8:11], v[220:223]
    buffer_load_dwordx4 v243, s[44:47], s72 offen offset:3072 lds
    v_mfma_f32_16x16x32_bf16 v[236:239], a[92:95], a[12:15], v[236:239]
    v_mfma_f32_16x16x32_bf16 v[232:235], a[88:91], a[12:15], v[232:235]
    buffer_load_dwordx4 a[0:3], v254, s[36:39], s71 offen offset:0 sc1
    v_mfma_f32_16x16x32_bf16 v[228:231], a[84:87], a[12:15], v[228:231]
    v_mfma_f32_16x16x32_bf16 v[224:227], a[80:83], a[12:15], v[224:227]
    buffer_load_dwordx4 a[4:7], v254, s[36:39], s71 offen offset:1024 sc1
    v_mfma_f32_16x16x32_bf16 v[172:175], a[76:79], a[12:15], v[172:175]
    v_mfma_f32_16x16x32_bf16 v[168:171], a[72:75], a[12:15], v[168:171]
    buffer_load_dwordx4 a[8:11], v254, s[36:39], s71 offen offset:2048 sc1
    v_mfma_f32_16x16x32_bf16 v[164:167], a[68:71], a[12:15], v[164:167]
    v_mfma_f32_16x16x32_bf16 v[160:163], a[64:67], a[12:15], v[160:163]
    buffer_load_dwordx4 a[12:15], v254, s[36:39], s71 offen offset:3072 sc1
    s_add_u32 s71, s71, 0x40000
    s_waitcnt vmcnt(24) lgkmcnt(0)
    s_barrier
    s_cmp_eq_u32 s74, s76
    s_cbranch_scc1 G2_samp
G2_samp_back:
    v_mfma_f32_16x16x32_bf16 v[112:115], a[96:99], a[16:19], v[112:115]
    ds_read_b64_tr_b16 a[64:65], v244 offset:16384
    v_mfma_f32_16x16x32_bf16 v[116:119], a[100:103], a[16:19], v[116:119]
    ds_read_b64_tr_b16 a[66:67], v244 offset:20480
    v_mfma_f32_16x16x32_bf16 v[120:123], a[104:107], a[16:19], v[120:123]
    ds_read_b64_tr_b16 a[68:69], v245 offset:16384
    v_mfma_f32_16x16x32_bf16 v[124:127], a[108:111], a[16:19], v[124:127]
    s_add_u32 m0, s73, 16384
    v_mfma_f32_16x16x32_bf16 v[176:179], a[112:115], a[16:19], v[176:179]
    ds_read_b64_tr_b16 a[70:71], v245 offset:20480
    v_mfma_f32_16x16x32_bf16 v[180:183], a[116:119], a[16:19], v[180:183]
    ds_read_b64_tr_b16 a[72:73], v246 offset:16384
    v_mfma_f32_16x16x32_bf16 v[184:187], a[120:123], a[16:19], v[184:187]
    ds_read_b64_tr_b16 a[74:75], v246 offset:20480
    v_mfma_f32_16x16x32_bf16 v[188:191], a[124:127], a[16:19], v[188:191]
    s_add_u32 s72, s72, 0x20000
    v_mfma_f32_16x16x32_bf16 v[204:207], a[124:127], a[20:23], v[204:207]
    v_mfma_f32_16x16x32_bf16 v[200:203], a[120:123], a[20:23], v[200:203]
    ds_read_b64_tr_b16 a[76:77], v247 offset:16384
    v_mfma_f32_16x16x32_bf16 v[196:199], a[116:119], a[20:23], v[196:199]
    ds_read_b64_tr_b16 a[78:79], v247 offset:20480
    v_mfma_f32_16x16x32_bf16 v[192:195], a[112:115], a[20:23], v[192:195]
    ds_read_b64_tr_b16 a[80:81], v248 offset:16384
    v_mfma_f32_16x16x32_bf16 v[140:143], a[108:111], a[20:23], v[140:143]
    buffer_load_dwordx4 v240, s[44:47], s72 offen offset:0 lds
    v_mfma_f32_16x16x32_bf16 v[136:139], a[104:107], a[20:23], v[136:139]
    ds_read_b64_tr_b16 a[82:83], v248 offset:20480
    v_mfma_f32_16x16x32_bf16 v[132:135], a[100:103], a[20:23], v[132:135]
    ds_read_b64_tr_b16 a[84:85], v249 offset:16384
    v_mfma_f32_16x16x32_bf16 v[128:131], a[96:99], a[20:23], v[128:131]
    ds_read_b64_tr_b16 a[86:87], v249 offset:20480
    v_mfma_f32_16x16x32_bf16 v[144:147], a[96:99], a[24:27], v[144:147]
    v_mfma_f32_16x16x32_bf16 v[148:151], a[100:103], a[24:27], v[148:151]
    buffer_load_dwordx4 v241, s[44:47], s72 offen offset:1024 lds
    v_mfma_f32_16x16x32_bf16 v[152:155], a[104:107], a[24:27], v[152:155]
    ds_read_b64_tr_b16 a[88:89], v250 offset:16384
    v_mfma_f32_16x16x32_bf16 v[156:159], a[108:111], a[24:27], v[156:159]
    ds_read_b64_tr_b16 a[90:91], v250 offset:20480
    v_mfma_f32_16x16x32_bf16 v[208:211], a[112:115], a[24:27], v[208:211]
    ds_read_b64_tr_b16 a[92:93], v251 offset:16384
    v_mfma_f32_16x16x32_bf16 v[212:215], a[116:119], a[24:27], v[212:215]
    buffer_load_dwordx4 v242, s[44:47], s72 offen offset:2048 lds
    v_mfma_f32_16x16x32_bf16 v[216:219], a[120:123], a[24:27], v[216:219]
    ds_read_b64_tr_b16 a[94:95], v251 offset:20480
    v_mfma_f32_16x16x32_bf16 v[220:223], a[124:127], a[24:27], v[220:223]
    buffer_load_dwordx4 v243, s[44:47], s72 offen offset:3072 lds
    v_mfma_f32_16x16x32_bf16 v[236:239], a[124:127], a[28:31], v[236:239]
    v_mfma_f32_16x16x32_bf16 v[232:235], a[120:123], a[28:31], v[232:235]
    buffer_load_dwordx4 a[16:19], v254, s[36:39], s71 offen offset:0 sc1
    v_mfma_f32_16x16x32_bf16 v[228:231], a[116:119], a[28:31], v[228:231]
    v_mfma_f32_16x16x32_bf16 v[224:227], a[112:115], a[28:31], v[224:227]
    buffer_load_dwordx4 a[20:23], v254, s[36:39], s71 offen offset:1024 sc1
    v_mfma_f32_16x16x32_bf16 v[172:175], a[108:111], a[28:31], v[172:175]
    v_mfma_f32_16x16x32_bf16 v[168:171], a[104:107], a[28:31], v[168:171]
    buffer_load_dwordx4 a[24:27], v254, s[36:39], s71 offen offset:2048 sc1
    v_mfma_f32_16x16x32_bf16 v[164:167], a[100:103], a[28:31], v[164:167]
    v_mfma_f32_16x16x32_bf16 v[160:163], a[96:99], a[28:31], v[160:163]
    buffer_load_dwordx4 a[28:31], v254, s[36:39], s71 offen offset:3072 sc1
    s_add_u32 s71, s71, 0x40000
    s_waitcnt vmcnt(24) lgkmcnt(0)
    s_barrier
    v_mfma_f32_16x16x32_bf16 v[112:115], a[64:67], a[32:35], v[112:115]
    ds_read_b64_tr_b16 a[96:97], v244 offset:24576
    ds_read_b64_tr_b16 a[98:99], v244 offset:28672
    v_mfma_f32_16x16x32_bf16 v[116:119], a[68:71], a[32:35], v[116:119]
    ds_read_b64_tr_b16 a[100:101], v245 offset:24576
    v_mfma_f32_16x16x32_bf16 v[120:123], a[72:75], a[32:35], v[120:123]
    s_add_u32 m0, s73, 24576
    v_mfma_f32_16x16x32_bf16 v[124:127], a[76:79], a[32:35], v[124:127]
    ds_read_b64_tr_b16 a[102:103], v245 offset:28672
    v_mfma_f32_16x16x32_bf16 v[176:179], a[80:83], a[32:35], v[176:179]
    ds_read_b64_tr_b16 a[104:105], v246 offset:24576
    v_mfma_f32_16x16x32_bf16 v[180:183], a[84:87], a[32:35], v[180:183]
    ds_read_b64_tr_b16 a[106:107], v246 offset:28672
    s_add_u32 s72, s72, 0x20000
    v_mfma_f32_16x16x32_bf16 v[184:187], a[88:91], a[32:35], v[184:187]
    ds_read_b64_tr_b16 a[108:109], v247 offset:24576
    v_mfma_f32_16x16x32_bf16 v[188:191], a[92:95], a[32:35], v[188:191]
    ds_read_b64_tr_b16 a[110:111], v247 offset:28672
    v_mfma_f32_16x16x32_bf16 v[204:207], a[92:95], a[36:39], v[204:207]
    ds_read_b64_tr_b16 a[112:113], v248 offset:24576
    v_mfma_f32_16x16x32_bf16 v[200:203], a[88:91], a[36:39], v[200:203]
    buffer_load_dwordx4 v240, s[44:47], s72 offen offset:0 lds
    v_mfma_f32_16x16x32_bf16 v[196:199], a[84:87], a[36:39], v[196:199]
    ds_read_b64_tr_b16 a[114:115], v248 offset:28672
    ds_read_b64_tr_b16 a[116:117], v249 offset:24576
    v_mfma_f32_16x16x32_bf16 v[192:195], a[80:83], a[36:39], v[192:195]
    ds_read_b64_tr_b16 a[118:119], v249 offset:28672
    v_mfma_f32_16x16x32_bf16 v[140:143], a[76:79], a[36:39], v[140:143]
    buffer_load_dwordx4 v241, s[44:47], s72 offen offset:1024 lds
    v_mfma_f32_16x16x32_bf16 v[136:139], a[72:75], a[36:39], v[136:139]
    ds_read_b64_tr_b16 a[120:121], v250 offset:24576
    v_mfma_f32_16x16x32_bf16 v[132:135], a[68:71], a[36:39], v[132:135]
    ds_read_b64_tr_b16 a[122:123], v250 offset:28672
    v_mfma_f32_16x16x32_bf16 v[128:131], a[64:67], a[36:39], v[128:131]
    ds_read_b64_tr_b16 a[124:125], v251 offset:24576
    buffer_load_dwordx4 v242, s[44:47], s72 offen offset:2048 lds
    v_mfma_f32_16x16x32_bf16 v[144:147], a[64:67], a[40:43], v[144:147]
    ds_read_b64_tr_b16 a[126:127], v251 offset:28672
    v_mfma_f32_16x16x32_bf16 v[148:151], a[68:71], a[40:43], v[148:151]
    buffer_load_dwordx4 v243, s[44:47], s72 offen offset:3072 lds
    v_mfma_f32_16x16x32_bf16 v[152:155], a[72:75], a[40:43], v[152:155]
    v_xor_b32 v244, 0x10000, v244
    v_mfma_f32_16x16x32_bf16 v[156:159], a[76:79], a[40:43], v[156:159]
    v_xor_b32 v245, 0x10000, v245
    v_mfma_f32_16x16x32_bf16 v[208:211], a[80:83], a[40:43], v[208:211]
    v_xor_b32 v246, 0x10000, v246
    v_xor_b32 v247, 0x10000, v247
    v_mfma_f32_16x16x32_bf16 v[212:215], a[84:87], a[40:43], v[212:215]
    v_xor_b32 v248, 0x10000, v248
    v_mfma_f32_16x16x32_bf16 v[216:219], a[88:91], a[40:43], v[216:219]
    v_xor_b32 v249, 0x10000, v249
    v_mfma_f32_16x16x32_bf16 v[220:223], a[92:95], a[40:43], v[220:223]
    v_xor_b32 v250, 0x10000, v250
    v_mfma_f32_16x16x32_bf16 v[236:239], a[92:95], a[44:47], v[236:239]
    v_xor_b32 v251, 0x10000, v251
    v_mfma_f32_16x16x32_bf16 v[232:235], a[88:91], a[44:47], v[232:235]
    buffer_load_dwordx4 a[32:35], v254, s[36:39], s71 offen offset:0 sc1
    v_mfma_f32_16x16x32_bf16 v[228:231], a[84:87], a[44:47], v[228:231]
    v_mfma_f32_16x16x32_bf16 v[224:227], a[80:83], a[44:47], v[224:227]
    buffer_load_dwordx4 a[36:39], v254, s[36:39], s71 offen offset:1024 sc1
    v_mfma_f32_16x16x32_bf16 v[172:175], a[76:79], a[44:47], v[172:175]
    v_mfma_f32_16x16x32_bf16 v[168:171], a[72:75], a[44:47], v[168:171]
    buffer_load_dwordx4 a[40:43], v254, s[36:39], s71 offen offset:2048 sc1
    v_mfma_f32_16x16x32_bf16 v[164:167], a[68:71], a[44:47], v[164:167]
    v_mfma_f32_16x16x32_bf16 v[160:163], a[64:67], a[44:47], v[160:163]
    buffer_load_dwordx4 a[44:47], v254, s[36:39], s71 offen offset:3072 sc1
    s_add_u32 s71, s71, 0x40000
    s_waitcnt vmcnt(24) lgkmcnt(0)
    s_barrier
    s_cmp_eq_u32 s74, s82
    s_cbranch_scc1 G2_oflag
G2_oflag_back:
    v_mfma_f32_16x16x32_bf16 v[112:115], a[96:99], a[48:51], v[112:115]
    s_cmp_eq_u32 s74, s76
    s_cselect_b32 s44, s20, s44
    v_mfma_f32_16x16x32_bf16 v[116:119], a[100:103], a[48:51], v[116:119]
    s_cselect_b32 s45, s21, s45
    v_mfma_f32_16x16x32_bf16 v[120:123], a[104:107], a[48:51], v[120:123]
    s_cselect_b32 s46, 0x200000, s46
    v_mfma_f32_16x16x32_bf16 v[124:127], a[108:111], a[48:51], v[124:127]
    s_cselect_b32 s72, s80, s72
    v_mfma_f32_16x16x32_bf16 v[176:179], a[112:115], a[48:51], v[176:179]
    s_add_u32 s74, s74, 1
    v_mfma_f32_16x16x32_bf16 v[180:183], a[116:119], a[48:51], v[180:183]
    s_xor_b32 s73, s73, 0x10000
    v_mfma_f32_16x16x32_bf16 v[184:187], a[120:123], a[48:51], v[184:187]
    ds_read_b64_tr_b16 a[64:65], v244 offset:0
    ds_read_b64_tr_b16 a[66:67], v244 offset:4096
    v_mfma_f32_16x16x32_bf16 v[188:191], a[124:127], a[48:51], v[188:191]
    ds_read_b64_tr_b16 a[68:69], v245 offset:0
    v_mfma_f32_16x16x32_bf16 v[204:207], a[124:127], a[52:55], v[204:207]
    s_add_u32 m0, s73, 0
    v_mfma_f32_16x16x32_bf16 v[200:203], a[120:123], a[52:55], v[200:203]
    ds_read_b64_tr_b16 a[70:71], v245 offset:4096
    v_mfma_f32_16x16x32_bf16 v[196:199], a[116:119], a[52:55], v[196:199]
    ds_read_b64_tr_b16 a[72:73], v246 offset:0
    v_mfma_f32_16x16x32_bf16 v[192:195], a[112:115], a[52:55], v[192:195]
    ds_read_b64_tr_b16 a[74:75], v246 offset:4096
    v_mfma_f32_16x16x32_bf16 v[140:143], a[108:111], a[52:55], v[140:143]
    s_add_u32 s72, s72, 0x20000
    ds_read_b64_tr_b16 a[76:77], v247 offset:0
    v_mfma_f32_16x16x32_bf16 v[136:139], a[104:107], a[52:55], v[136:139]
    ds_read_b64_tr_b16 a[78:79], v247 offset:4096
    v_mfma_f32_16x16x32_bf16 v[132:135], a[100:103], a[52:55], v[132:135]
    ds_read_b64_tr_b16 a[80:81], v248 offset:0
    v_mfma_f32_16x16x32_bf16 v[128:131], a[96:99], a[52:55], v[128:131]
    buffer_load_dwordx4 v240, s[44:47], s72 offen offset:0 lds
    v_mfma_f32_16x16x32_bf16 v[144:147], a[96:99], a[56:59], v[144:147]
    ds_read_b64_tr_b16 a[82:83], v248 offset:4096
    v_mfma_f32_16x16x32_bf16 v[148:151], a[100:103], a[56:59], v[148:151]
    ds_read_b64_tr_b16 a[84:85], v249 offset:0
    v_mfma_f32_16x16x32_bf16 v[152:155], a[104:107], a[56:59], v[152:155]
    ds_read_b64_tr_b16 a[86:87], v249 offset:4096
    buffer_load_dwordx4 v241, s[44:47], s72 offen offset:1024 lds
    v_mfma_f32_16x16x32_bf16 v[156:159], a[108:111], a[56:59], v[156:159]
    ds_read_b64_tr_b16 a[88:89], v250 offset:0
    v_mfma_f32_16x16x32_bf16 v[208:211], a[112:115], a[56:59], v[208:211]
    ds_read_b64_tr_b16 a[90:91], v250 offset:4096
    v_mfma_f32_16x16x32_bf16 v[212:215], a[116:119], a[56:59], v[212:215]
    ds_read_b64_tr_b16 a[92:93], v251 offset:0
    v_mfma_f32_16x16x32_bf16 v[216:219], a[120:123], a[56:59], v[216:219]
    buffer_load_dwordx4 v242, s[44:47], s72 offen offset:2048 lds
    v_mfma_f32_16x16x32_bf16 v[220:223], a[124:127], a[56:59], v[220:223]
    ds_read_b64_tr_b16 a[94:95], v251 offset:4096
    v_mfma_f32_16x16x32_bf16 v[236:239], a[124:127], a[60:63], v[236:239]
    buffer_load_dwordx4 v243, s[44:47], s72 offen offset:3072 lds
    v_mfma_f32_16x16x32_bf16 v[232:235], a[120:123], a[60:63], v[232:235]
    buffer_load_dwordx4 a[48:51], v254, s[36:39], s71 offen offset:0 sc1
    v_mfma_f32_16x16x32_bf16 v[228:231], a[116:119], a[60:63], v[228:231]
    v_mfma_f32_16x16x32_bf16 v[224:227], a[112:115], a[60:63], v[224:227]
    buffer_load_dwordx4 a[52:55], v254, s[36:39], s71 offen offset:1024 sc1
    v_mfma_f32_16x16x32_bf16 v[172:175], a[108:111], a[60:63], v[172:175]
    v_mfma_f32_16x16x32_bf16 v[168:171], a[104:107], a[60:63], v[168:171]
    buffer_load_dwordx4 a[56:59], v254, s[36:39], s71 offen offset:2048 sc1
    v_mfma_f32_16x16x32_bf16 v[164:167], a[100:103], a[60:63], v[164:167]
    v_mfma_f32_16x16x32_bf16 v[160:163], a[96:99], a[60:63], v[160:163]
    buffer_load_dwordx4 a[60:63], v254, s[36:39], s71 offen offset:3072 sc1
    s_add_u32 s71, s71, 0x40000
    s_cmp_lt_u32 s74, s81
    s_cbranch_scc1 G2_loop
    s_branch G2_tail
G2_oflag:
    v_cmp_eq_u32 vcc, 0, v255
    v_mov_b32 v253, 0x80000000
    v_mov_b32_e64 v252, s95
    v_cndmask_b32 v253, v253, 0, vcc
    buffer_store_dword v252, v253, s[36:39], s15 offen sc1
    s_branch G2_oflag_back
G2_samp:
    buffer_load_dword v70, v71, s[36:39], s83 offen sc1
    s_branch G2_samp_back
G2_swA:
    s_mov_b32 s71, s79
    s_waitcnt vmcnt(24)
    v_cmp_eq_u32 vcc, s95, v70
    s_and_b32 s3, vcc_lo, 0xffffffff
    s_cmp_eq_u32 s3, 0xffffffff
    s_cbranch_scc1 G2_swA_back
    v_min_u32 v253, 31, v255
    v_lshlrev_b32 v253, 7, v253
G2_pollo:
    buffer_load_dword v252, v253, s[36:39], s83 offen offset:0 sc1
    s_waitcnt vmcnt(0)
    v_cmp_eq_u32 vcc, s95, v252
    s_and_b32 s3, vcc_lo, 0xffffffff
    s_cmp_eq_u32 s3, 0xffffffff
    s_cbranch_scc1 G2_pollo_ok
    s_sleep 1
    s_sub_u32 s12, s12, 1
    s_cmp_gt_i32 s12, 0
    s_cbranch_scc1 G2_pollo
G2_pollo_ok:
    s_branch G2_swA_back
G2_tail:
    s_waitcnt vmcnt(24) lgkmcnt(0)
    s_barrier
    v_mfma_f32_16x16x32_bf16 v[112:115], a[64:67], a[0:3], v[112:115]
    ds_read_b64_tr_b16 a[96:97], v244 offset:8192
    ds_read_b64_tr_b16 a[98:99], v244 offset:12288
    v_mfma_f32_16x16x32_bf16 v[116:119], a[68:71], a[0:3], v[116:119]
    ds_read_b64_tr_b16 a[100:101], v245 offset:8192
    s_lshl_b32 s78, s61, 18
    v_mfma_f32_16x16x32_bf16 v[120:123], a[72:75], a[0:3], v[120:123]
    s_lshl_b32 s3, s70, 17
    s_add_u32 s78, s78, s3
    v_mfma_f32_16x16x32_bf16 v[124:127], a[76:79], a[0:3], v[124:127]
    s_lshl_b32 s3, s62, 8
    ds_read_b64_tr_b16 a[102:103], v245 offset:12288
    v_mfma_f32_16x16x32_bf16 v[176:179], a[80:83], a[0:3], v[176:179]
    ds_read_b64_tr_b16 a[104:105], v246 offset:8192
    ds_read_b64_tr_b16 a[106:107], v246 offset:12288
    v_mfma_f32_16x16x32_bf16 v[180:183], a[84:87], a[0:3], v[180:183]
    s_add_u32 s78, s78, s3
    s_lshl_b32 s3, s69, 7
    v_mfma_f32_16x16x32_bf16 v[184:187], a[88:91], a[0:3], v[184:187]
    s_add_u32 s78, s78, s3
    v_lshrrev_b32 v64, 3, v255
    v_mfma_f32_16x16x32_bf16 v[188:191], a[92:95], a[0:3], v[188:191]
    ds_read_b64_tr_b16 a[108:109], v247 offset:8192
    ds_read_b64_tr_b16 a[110:111], v247 offset:12288
    v_mfma_f32_16x16x32_bf16 v[204:207], a[92:95], a[4:7], v[204:207]
    ds_read_b64_tr_b16 a[112:113], v248 offset:8192
    v_and_b32_e64 v65, 7, v255
    v_mfma_f32_16x16x32_bf16 v[200:203], a[88:91], a[4:7], v[200:203]
    v_xor_b32 v65, v65, v67
    v_lshlrev_b32 v65, 4, v65
    v_mfma_f32_16x16x32_bf16 v[196:199], a[84:87], a[4:7], v[196:199]
    v_lshl_add_u32 v76, v64, 11, v65
    ds_read_b64_tr_b16 a[114:115], v248 offset:12288
    v_mfma_f32_16x16x32_bf16 v[192:195], a[80:83], a[4:7], v[192:195]
    ds_read_b64_tr_b16 a[116:117], v249 offset:8192
    ds_read_b64_tr_b16 a[118:119], v249 offset:12288
    v_mfma_f32_16x16x32_bf16 v[140:143], a[76:79], a[4:7], v[140:143]
    v_xor_b32_e64 v77, 64, v76
    v_mfma_f32_16x16x32_bf16 v[136:139], a[72:75], a[4:7], v[136:139]
    v_add_u32 v78, 30720, v76
    v_add_u32 v77, 15360, v77
    v_mfma_f32_16x16x32_bf16 v[132:135], a[68:71], a[4:7], v[132:135]
    v_add_u32 v79, 30720, v77
    ds_read_b64_tr_b16 a[120:121], v250 offset:8192
    v_mfma_f32_16x16x32_bf16 v[128:131], a[64:67], a[4:7], v[128:131]
    ds_read_b64_tr_b16 a[122:123], v250 offset:12288
    ds_read_b64_tr_b16 a[124:125], v251 offset:8192
    v_mfma_f32_16x16x32_bf16 v[144:147], a[64:67], a[8:11], v[144:147]
    s_lshl_b32 s67, s4, 13
    s_add_u32 s67, s67, 0x20000
    v_mfma_f32_16x16x32_bf16 v[148:151], a[68:71], a[8:11], v[148:151]
    s_cmp_eq_u32 s60, 1
    s_cselect_b32 s66, 0x40000000, s78
    v_mfma_f32_16x16x32_bf16 v[152:155], a[72:75], a[8:11], v[152:155]
    ds_read_b64_tr_b16 a[126:127], v251 offset:12288
    s_add_u32 m0, s67, 0
    v_mfma_f32_16x16x32_bf16 v[156:159], a[76:79], a[8:11], v[156:159]
    s_add_u32 s3, s66, 0
    buffer_load_dwordx4 v76, s[40:43], s3 offen offset:0 lds
    v_mfma_f32_16x16x32_bf16 v[208:211], a[80:83], a[8:11], v[208:211]
    buffer_load_dwordx4 v77, s[40:43], s3 offen offset:1024 lds
    buffer_load_dwordx4 v78, s[40:43], s3 offen offset:2048 lds
    v_mfma_f32_16x16x32_bf16 v[212:215], a[84:87], a[8:11], v[212:215]
    buffer_load_dwordx4 v79, s[40:43], s3 offen offset:3072 lds
    s_add_u32 m0, s67, 4096
    v_mfma_f32_16x16x32_bf16 v[216:219], a[88:91], a[8:11], v[216:219]
    s_add_u32 s3, s66, 65536
    buffer_load_dwordx4 v76, s[40:43], s3 offen offset:0 lds
    v_mfma_f32_16x16x32_bf16 v[220:223], a[92:95], a[8:11], v[220:223]
    buffer_load_dwordx4 v77, s[40:43], s3 offen offset:1024 lds
    buffer_load_dwordx4 v78, s[40:43], s3 offen offset:2048 lds
    v_mfma_f32_16x16x32_bf16 v[236:239], a[92:95], a[12:15], v[236:239]
    buffer_load_dwordx4 v79, s[40:43], s3 offen offset:3072 lds
    v_mfma_f32_16x16x32_bf16 v[232:235], a[88:91], a[12:15], v[232:235]
    v_mfma_f32_16x16x32_bf16 v[228:231], a[84:87], a[12:15], v[228:231]
    v_mfma_f32_16x16x32_bf16 v[224:227], a[80:83], a[12:15], v[224:227]
    v_mfma_f32_16x16x32_bf16 v[172:175], a[76:79], a[12:15], v[172:175]
    v_mfma_f32_16x16x32_bf16 v[168:171], a[72:75], a[12:15], v[168:171]
    v_mfma_f32_16x16x32_bf16 v[164:167], a[68:71], a[12:15], v[164:167]
    v_mfma_f32_16x16x32_bf16 v[160:163], a[64:67], a[12:15], v[160:163]
    s_cmp_eq_u32 s60, 1
    s_cbranch_scc1 G2_fin
    s_waitcnt vmcnt(24) lgkmcnt(0)
    s_barrier
    v_mfma_f32_16x16x32_bf16 v[112:115], a[96:99], a[16:19], v[112:115]
    ds_read_b64_tr_b16 a[64:65], v244 offset:16384
    ds_read_b64_tr_b16 a[66:67], v244 offset:20480
    v_mfma_f32_16x16x32_bf16 v[116:119], a[100:103], a[16:19], v[116:119]
    ds_read_b64_tr_b16 a[68:69], v245 offset:16384
    v_mfma_f32_16x16x32_bf16 v[120:123], a[104:107], a[16:19], v[120:123]
    s_lshl_b32 s77, s61, 10
    v_mfma_f32_16x16x32_bf16 v[124:127], a[108:111], a[16:19], v[124:127]
    s_lshl_b32 s3, s70, 9
    v_mfma_f32_16x16x32_bf16 v[176:179], a[112:115], a[16:19], v[176:179]
    s_add_u32 s77, s77, s3
    v_mfma_f32_16x16x32_bf16 v[180:183], a[116:119], a[16:19], v[180:183]
    s_add_u32 s77, s77, 0x2800004
    ds_read_b64_tr_b16 a[70:71], v245 offset:20480
    v_mfma_f32_16x16x32_bf16 v[184:187], a[120:123], a[16:19], v[184:187]
    ds_read_b64_tr_b16 a[72:73], v246 offset:16384
    v_mfma_f32_16x16x32_bf16 v[188:191], a[124:127], a[16:19], v[188:191]
    ds_read_b64_tr_b16 a[74:75], v246 offset:20480
    v_mfma_f32_16x16x32_bf16 v[204:207], a[124:127], a[20:23], v[204:207]
    v_lshlrev_b32_e64 v64, 3, v68
    v_mfma_f32_16x16x32_bf16 v[200:203], a[120:123], a[20:23], v[200:203]
    buffer_load_dword v72, v64, s[36:39], s77 offen offset:0 sc1
    v_mfma_f32_16x16x32_bf16 v[196:199], a[116:119], a[20:23], v[196:199]
    buffer_load_dword v73, v64, s[36:39], s77 offen offset:128 sc1
    buffer_load_dword v74, v64, s[36:39], s77 offen offset:256 sc1
    v_mfma_f32_16x16x32_bf16 v[192:195], a[112:115], a[20:23], v[192:195]
    ds_read_b64_tr_b16 a[76:77], v247 offset:16384
    v_mfma_f32_16x16x32_bf16 v[140:143], a[108:111], a[20:23], v[140:143]
    ds_read_b64_tr_b16 a[78:79], v247 offset:20480
    v_mfma_f32_16x16x32_bf16 v[136:139], a[104:107], a[20:23], v[136:139]
    ds_read_b64_tr_b16 a[80:81], v248 offset:16384
    v_mfma_f32_16x16x32_bf16 v[132:135], a[100:103], a[20:23], v[132:135]
    buffer_load_dword v75, v64, s[36:39], s77 offen offset:384 sc1
    v_mfma_f32_16x16x32_bf16 v[128:131], a[96:99], a[20:23], v[128:131]
    s_lshl_b32 s64, s63, 15
    s_lshl_b32 s3, s4, 13
    v_mfma_f32_16x16x32_bf16 v[144:147], a[96:99], a[24:27], v[144:147]
    s_add_u32 s64, s64, s3
    v_mfma_f32_16x16x32_bf16 v[148:151], a[100:103], a[24:27], v[148:151]
    ds_read_b64_tr_b16 a[82:83], v248 offset:20480
    v_mfma_f32_16x16x32_bf16 v[152:155], a[104:107], a[24:27], v[152:155]
    ds_read_b64_tr_b16 a[84:85], v249 offset:16384
    v_mfma_f32_16x16x32_bf16 v[156:159], a[108:111], a[24:27], v[156:159]
    ds_read_b64_tr_b16 a[86:87], v249 offset:20480
    v_mfma_f32_16x16x32_bf16 v[208:211], a[112:115], a[24:27], v[208:211]
    s_add_u32 s64, s64, 0x2000000
    s_add_u32 s65, s64, 4096
    v_mfma_f32_16x16x32_bf16 v[212:215], a[116:119], a[24:27], v[212:215]
    ds_read_b64_tr_b16 a[88:89], v250 offset:16384
    v_mfma_f32_16x16x32_bf16 v[216:219], a[120:123], a[24:27], v[216:219]
    ds_read_b64_tr_b16 a[90:91], v250 offset:20480
    v_mfma_f32_16x16x32_bf16 v[220:223], a[124:127], a[24:27], v[220:223]
    ds_read_b64_tr_b16 a[92:93], v251 offset:16384
    v_mfma_f32_16x16x32_bf16 v[236:239], a[124:127], a[28:31], v[236:239]
    ds_read_b64_tr_b16 a[94:95], v251 offset:20480
    v_mfma_f32_16x16x32_bf16 v[232:235], a[120:123], a[28:31], v[232:235]
    v_mfma_f32_16x16x32_bf16 v[228:231], a[116:119], a[28:31], v[228:231]
    v_mfma_f32_16x16x32_bf16 v[224:227], a[112:115], a[28:31], v[224:227]
    v_mfma_f32_16x16x32_bf16 v[172:175], a[108:111], a[28:31], v[172:175]
    v_mfma_f32_16x16x32_bf16 v[168:171], a[104:107], a[28:31], v[168:171]
    v_mfma_f32_16x16x32_bf16 v[164:167], a[100:103], a[28:31], v[164:167]
    v_mfma_f32_16x16x32_bf16 v[160:163], a[96:99], a[28:31], v[160:163]
    s_waitcnt vmcnt(20) lgkmcnt(0)
    s_barrier
    v_mfma_f32_16x16x32_bf16 v[112:115], a[64:67], a[32:35], v[112:115]
    ds_read_b64_tr_b16 a[96:97], v244 offset:24576
    ds_read_b64_tr_b16 a[98:99], v244 offset:28672
    v_mfma_f32_16x16x32_bf16 v[116:119], a[68:71], a[32:35], v[116:119]
    ds_read_b64_tr_b16 a[100:101], v245 offset:24576
    s_lshl_b32 s3, s4, 14
    v_mfma_f32_16x16x32_bf16 v[120:123], a[72:75], a[32:35], v[120:123]
    v_add_u32_e64 v64, s3, v254
    v_mfma_f32_16x16x32_bf16 v[124:127], a[76:79], a[32:35], v[124:127]
    s_xor_b32 s3, s4, 2
    s_lshl_b32 s3, s3, 14
    v_mfma_f32_16x16x32_bf16 v[176:179], a[80:83], a[32:35], v[176:179]
    ds_read_b64_tr_b16 a[102:103], v245 offset:28672
    v_mfma_f32_16x16x32_bf16 v[180:183], a[84:87], a[32:35], v[180:183]
    ds_read_b64_tr_b16 a[104:105], v246 offset:24576
    ds_read_b64_tr_b16 a[106:107], v246 offset:28672
    v_mfma_f32_16x16x32_bf16 v[184:187], a[88:91], a[32:35], v[184:187]
    v_add_u32_e64 v65, s3, v254
    s_mov_b32 s75, 0xffff0000
    v_mfma_f32_16x16x32_bf16 v[188:191], a[92:95], a[32:35], v[188:191]
    v_and_b32_e64 v66, 1, v67
    v_mfma_f32_16x16x32_bf16 v[204:207], a[92:95], a[36:39], v[204:207]
    v_lshrrev_b32_e64 v96, 1, v67
    ds_read_b64_tr_b16 a[108:109], v247 offset:24576
    v_mfma_f32_16x16x32_bf16 v[200:203], a[88:91], a[36:39], v[200:203]
    ds_read_b64_tr_b16 a[110:111], v247 offset:28672
    v_mfma_f32_16x16x32_bf16 v[196:199], a[84:87], a[36:39], v[196:199]
    ds_read_b64_tr_b16 a[112:113], v248 offset:24576
    v_lshl_or_b32 v66, v66, 1, v96
    v_mfma_f32_16x16x32_bf16 v[192:195], a[80:83], a[36:39], v[192:195]
    v_lshrrev_b32 v96, 1, v68
    v_xor_b32 v66, v66, v96
    v_mfma_f32_16x16x32_bf16 v[140:143], a[76:79], a[36:39], v[140:143]
    v_lshlrev_b32_e64 v66, 4, v66
    v_mfma_f32_16x16x32_bf16 v[136:139], a[72:75], a[36:39], v[136:139]
    ds_read_b64_tr_b16 a[114:115], v248 offset:28672
    ds_read_b64_tr_b16 a[116:117], v249 offset:24576
    v_mfma_f32_16x16x32_bf16 v[132:135], a[68:71], a[36:39], v[132:135]
    ds_read_b64_tr_b16 a[118:119], v249 offset:28672
    v_mfma_f32_16x16x32_bf16 v[128:131], a[64:67], a[36:39], v[128:131]
    v_lshl_add_u32 v66, v68, 7, v66
    v_add_u32_e64 v96, s67, v66
    v_mfma_f32_16x16x32_bf16 v[144:147], a[64:67], a[40:43], v[144:147]
    v_xor_b32 v97, 64, v96
    v_add_u32 v98, s67, v254
    v_mfma_f32_16x16x32_bf16 v[148:151], a[68:71], a[40:43], v[148:151]
    ds_read_b64_tr_b16 a[120:121], v250 offset:24576
    v_mfma_f32_16x16x32_bf16 v[152:155], a[72:75], a[40:43], v[152:155]
    ds_read_b64_tr_b16 a[122:123], v250 offset:28672
    ds_read_b64_tr_b16 a[124:125], v251 offset:24576
    v_mfma_f32_16x16x32_bf16 v[156:159], a[76:79], a[40:43], v[156:159]
    ds_read_b64_tr_b16 a[126:127], v251 offset:28672
    v_mfma_f32_16x16x32_bf16 v[208:211], a[80:83], a[40:43], v[208:211]
    v_xor_b32 v244, 0x10000, v244
    v_xor_b32 v245, 0x10000, v245
    v_mfma_f32_16x16x32_bf16 v[212:215], a[84:87], a[40:43], v[212:215]
    v_xor_b32 v246, 0x10000, v246
    v_xor_b32 v247, 0x10000, v247
    v_mfma_f32_16x16x32_bf16 v[216:219], a[88:91], a[40:43], v[216:219]
    v_xor_b32 v248, 0x10000, v248
    v_mfma_f32_16x16x32_bf16 v[220:223], a[92:95], a[40:43], v[220:223]
    v_xor_b32 v249, 0x10000, v249
    v_xor_b32 v250, 0x10000, v250
    v_mfma_f32_16x16x32_bf16 v[236:239], a[92:95], a[44:47], v[236:239]
    v_xor_b32 v251, 0x10000, v251
    v_mfma_f32_16x16x32_bf16 v[232:235], a[88:91], a[44:47], v[232:235]
    v_mfma_f32_16x16x32_bf16 v[228:231], a[84:87], a[44:47], v[228:231]
    v_mfma_f32_16x16x32_bf16 v[224:227], a[80:83], a[44:47], v[224:227]
    v_mfma_f32_16x16x32_bf16 v[172:175], a[76:79], a[44:47], v[172:175]
    v_mfma_f32_16x16x32_bf16 v[168:171], a[72:75], a[44:47], v[168:171]
    v_mfma_f32_16x16x32_bf16 v[164:167], a[68:71], a[44:47], v[164:167]
    v_mfma_f32_16x16x32_bf16 v[160:163], a[64:67], a[44:47], v[160:163]
    s_waitcnt vmcnt(4) lgkmcnt(0)
    s_barrier
    v_mfma_f32_16x16x32_bf16 v[176:179], a[112:115], a[48:51], v[176:179]
    ds_read_b128 v[0:3], v96 offset:0
    v_mfma_f32_16x16x32_bf16 v[180:183], a[116:119], a[48:51], v[180:183]
    v_mfma_f32_16x16x32_bf16 v[184:187], a[120:123], a[48:51], v[184:187]
    ds_read_b128 v[4:7], v97 offset:0
    v_mfma_f32_16x16x32_bf16 v[188:191], a[124:127], a[48:51], v[188:191]
    v_mfma_f32_16x16x32_bf16 v[192:195], a[112:115], a[52:55], v[192:195]
    ds_read_b128 v[8:11], v96 offset:2048
    v_mfma_f32_16x16x32_bf16 v[196:199], a[116:119], a[52:55], v[196:199]
    v_mfma_f32_16x16x32_bf16 v[200:203], a[120:123], a[52:55], v[200:203]
    ds_read_b128 v[12:15], v97 offset:2048
    v_mfma_f32_16x16x32_bf16 v[204:207], a[124:127], a[52:55], v[204:207]
    v_mfma_f32_16x16x32_bf16 v[208:211], a[112:115], a[56:59], v[208:211]
    ds_read_b128 v[16:19], v96 offset:4096
    v_mfma_f32_16x16x32_bf16 v[212:215], a[116:119], a[56:59], v[212:215]
    v_mfma_f32_16x16x32_bf16 v[216:219], a[120:123], a[56:59], v[216:219]
    ds_read_b128 v[20:23], v97 offset:4096
    v_mfma_f32_16x16x32_bf16 v[220:223], a[124:127], a[56:59], v[220:223]
    v_mfma_f32_16x16x32_bf16 v[224:227], a[112:115], a[60:63], v[224:227]
    ds_read_b128 v[24:27], v96 offset:6144
    v_mfma_f32_16x16x32_bf16 v[228:231], a[116:119], a[60:63], v[228:231]
    v_mfma_f32_16x16x32_bf16 v[232:235], a[120:123], a[60:63], v[232:235]
    ds_read_b128 v[28:31], v97 offset:6144
    v_mfma_f32_16x16x32_bf16 v[236:239], a[124:127], a[60:63], v[236:239]
    v_mfma_f32_16x16x32_bf16 v[112:115], a[96:99], a[48:51], v[112:115]
    ds_write_b128 v64, v[176:179] offset:0
    v_mfma_f32_16x16x32_bf16 v[116:119], a[100:103], a[48:51], v[116:119]
    ds_write_b128 v64, v[180:183] offset:1024
    v_mfma_f32_16x16x32_bf16 v[120:123], a[104:107], a[48:51], v[120:123]
    ds_write_b128 v64, v[184:187] offset:2048
    v_mfma_f32_16x16x32_bf16 v[124:127], a[108:111], a[48:51], v[124:127]
    ds_write_b128 v64, v[188:191] offset:3072
    v_mfma_f32_16x16x32_bf16 v[128:131], a[96:99], a[52:55], v[128:131]
    ds_write_b128 v64, v[192:195] offset:4096
    v_mfma_f32_16x16x32_bf16 v[132:135], a[100:103], a[52:55], v[132:135]
    ds_write_b128 v64, v[196:199] offset:5120
    v_mfma_f32_16x16x32_bf16 v[136:139], a[104:107], a[52:55], v[136:139]
    ds_write_b128 v64, v[200:203] offset:6144
    v_mfma_f32_16x16x32_bf16 v[140:143], a[108:111], a[52:55], v[140:143]
    ds_write_b128 v64, v[204:207] offset:7168
    v_mfma_f32_16x16x32_bf16 v[144:147], a[96:99], a[56:59], v[144:147]
    ds_write_b128 v64, v[208:211] offset:8192
    v_mfma_f32_16x16x32_bf16 v[148:151], a[100:103], a[56:59], v[148:151]
    ds_write_b128 v64, v[212:215] offset:9216
    v_mfma_f32_16x16x32_bf16 v[152:155], a[104:107], a[56:59], v[152:155]
    ds_write_b128 v64, v[216:219] offset:10240
    v_mfma_f32_16x16x32_bf16 v[156:159], a[108:111], a[56:59], v[156:159]
    ds_write_b128 v64, v[220:223] offset:11264
    v_mfma_f32_16x16x32_bf16 v[160:163], a[96:99], a[60:63], v[160:163]
    v_mfma_f32_16x16x32_bf16 v[164:167], a[100:103], a[60:63], v[164:167]
    v_mfma_f32_16x16x32_bf16 v[168:171], a[104:107], a[60:63], v[168:171]
    v_mfma_f32_16x16x32_bf16 v[172:175], a[108:111], a[60:63], v[172:175]
    ds_write_b128 v64, v[224:227] offset:12288
    ds_write_b128 v64, v[228:231] offset:13312
    ds_write_b128 v64, v[232:235] offset:14336
    ds_write_b128 v64, v[236:239] offset:15360
    s_waitcnt lgkmcnt(0)
    s_barrier
    ds_read_b128 v[176:179], v65 offset:0
    ds_read_b128 v[180:183], v65 offset:1024
    ds_read_b128 v[184:187], v65 offset:2048
    ds_read_b128 v[188:191], v65 offset:3072
    ds_read_b128 v[192:195], v65 offset:4096
    ds_read_b128 v[196:199], v65 offset:5120
    ds_read_b128 v[200:203], v65 offset:6144
    ds_read_b128 v[204:207], v65 offset:7168
    ds_read_b128 v[208:211], v65 offset:8192
    ds_read_b128 v[212:215], v65 offset:9216
    ds_read_b128 v[216:219], v65 offset:10240
    ds_read_b128 v[220:223], v65 offset:11264
    ds_read_b128 v[224:227], v65 offset:12288
    ds_read_b128 v[228:231], v65 offset:13312
    ds_read_b128 v[232:235], v65 offset:14336
    ds_read_b128 v[236:239], v65 offset:15360
    v_permlane16_swap_b32 v0, v2
    v_permlane16_swap_b32 v1, v3
    v_permlane16_swap_b32 v4, v6
    v_permlane16_swap_b32 v5, v7
    v_permlane16_swap_b32 v8, v10
    v_permlane16_swap_b32 v9, v11
    v_permlane16_swap_b32 v12, v14
    v_permlane16_swap_b32 v13, v15
    v_permlane16_swap_b32 v16, v18
    v_permlane16_swap_b32 v17, v19
    v_permlane16_swap_b32 v20, v22
    v_permlane16_swap_b32 v21, v23
    v_permlane16_swap_b32 v24, v26
    v_permlane16_swap_b32 v25, v27
    v_permlane16_swap_b32 v28, v30
    v_permlane16_swap_b32 v29, v31
    s_waitcnt vmcnt(0)
    v_lshlrev_b32 v32, 16, v0
    v_and_b32 v33, s75, v0
    v_lshlrev_b32 v34, 16, v1
    v_and_b32 v35, s75, v1
    v_lshlrev_b32 v36, 16, v2
    v_and_b32 v37, s75, v2
    v_lshlrev_b32 v38, 16, v3
    v_and_b32 v39, s75, v3
    s_waitcnt lgkmcnt(14)
    v_pk_add_f32 v[112:113], v[112:113], v[176:177]
    v_pk_add_f32 v[114:115], v[114:115], v[178:179]
    v_pk_add_f32 v[116:117], v[116:117], v[180:181]
    v_pk_add_f32 v[118:119], v[118:119], v[182:183]
    v_pk_fma_f32 v[112:113], v[112:113], v[72:73], v[32:33] op_sel_hi:[1,0,1]
    v_pk_fma_f32 v[114:115], v[114:115], v[72:73], v[34:35] op_sel_hi:[1,0,1]
    v_pk_fma_f32 v[116:117], v[116:117], v[72:73], v[36:37] op_sel_hi:[1,0,1]
    v_pk_fma_f32 v[118:119], v[118:119], v[72:73], v[38:39] op_sel_hi:[1,0,1]
    v_cvt_pk_bf16_f32 v112, v112, v113
    v_cvt_pk_bf16_f32 v113, v114, v115
    v_cvt_pk_bf16_f32 v114, v116, v117
    v_cvt_pk_bf16_f32 v115, v118, v119
    buffer_store_dwordx4 v[112:115], v254, s[36:39], s64 offen offset:0 sc1
    v_lshlrev_b32 v40, 16, v4
    v_and_b32 v41, s75, v4
    v_lshlrev_b32 v42, 16, v5
    v_and_b32 v43, s75, v5
    v_lshlrev_b32 v44, 16, v6
    v_and_b32 v45, s75, v6
    v_lshlrev_b32 v46, 16, v7
    v_and_b32 v47, s75, v7
    s_waitcnt lgkmcnt(12)
    s_nop 0
    v_pk_add_f32 v[120:121], v[120:121], v[184:185]
    v_pk_add_f32 v[122:123], v[122:123], v[186:187]
    v_pk_add_f32 v[124:125], v[124:125], v[188:189]
    v_pk_add_f32 v[126:127], v[126:127], v[190:191]
    v_pk_fma_f32 v[120:121], v[120:121], v[72:73], v[40:41] op_sel_hi:[1,0,1]
    v_pk_fma_f32 v[122:123], v[122:123], v[72:73], v[42:43] op_sel_hi:[1,0,1]
    v_pk_fma_f32 v[124:125], v[124:125], v[72:73], v[44:45] op_sel_hi:[1,0,1]
    v_pk_fma_f32 v[126:127], v[126:127], v[72:73], v[46:47] op_sel_hi:[1,0,1]
    v_cvt_pk_bf16_f32 v120, v120, v121
    v_cvt_pk_bf16_f32 v121, v122, v123
    v_cvt_pk_bf16_f32 v122, v124, v125
    v_cvt_pk_bf16_f32 v123, v126, v127
    buffer_store_dwordx4 v[120:123], v254, s[36:39], s64 offen offset:1024 sc1
    v_lshlrev_b32 v32, 16, v8
    v_and_b32 v33, s75, v8
    v_lshlrev_b32 v34, 16, v9
    v_and_b32 v35, s75, v9
    v_lshlrev_b32 v36, 16, v10
    v_and_b32 v37, s75, v10
    v_lshlrev_b32 v38, 16, v11
    v_and_b32 v39, s75, v11
    s_waitcnt lgkmcnt(10)
    s_nop 0
    v_pk_add_f32 v[128:129], v[128:129], v[192:193]
    v_pk_add_f32 v[130:131], v[130:131], v[194:195]
    v_pk_add_f32 v[132:133], v[132:133], v[196:197]
    v_pk_add_f32 v[134:135], v[134:135], v[198:199]
    v_pk_fma_f32 v[128:129], v[128:129], v[72:73], v[32:33] op_sel:[0,1,0] op_sel_hi:[1,1,1]
    v_pk_fma_f32 v[130:131], v[130:131], v[72:73], v[34:35] op_sel:[0,1,0] op_sel_hi:[1,1,1]
    v_pk_fma_f32 v[132:133], v[132:133], v[72:73], v[36:37] op_sel:[0,1,0] op_sel_hi:[1,1,1]
    v_pk_fma_f32 v[134:135], v[134:135], v[72:73], v[38:39] op_sel:[0,1,0] op_sel_hi:[1,1,1]
    v_cvt_pk_bf16_f32 v128, v128, v129
    v_cvt_pk_bf16_f32 v129, v130, v131
    v_cvt_pk_bf16_f32 v130, v132, v133
    v_cvt_pk_bf16_f32 v131, v134, v135
    buffer_store_dwordx4 v[128:131], v254, s[36:39], s64 offen offset:2048 sc1
    v_lshlrev_b32 v40, 16, v12
    v_and_b32 v41, s75, v12
    v_lshlrev_b32 v42, 16, v13
    v_and_b32 v43, s75, v13
    v_lshlrev_b32 v44, 16, v14
    v_and_b32 v45, s75, v14
    v_lshlrev_b32 v46, 16, v15
    v_and_b32 v47, s75, v15
    s_waitcnt lgkmcnt(8)
    s_nop 0
    v_pk_add_f32 v[136:137], v[136:137], v[200:201]
    v_pk_add_f32 v[138:139], v[138:139], v[202:203]
    v_pk_add_f32 v[140:141], v[140:141], v[204:205]
    v_pk_add_f32 v[142:143], v[142:143], v[206:207]
    v_pk_fma_f32 v[136:137], v[136:137], v[72:73], v[40:41] op_sel:[0,1,0] op_sel_hi:[1,1,1]
    v_pk_fma_f32 v[138:139], v[138:139], v[72:73], v[42:43] op_sel:[0,1,0] op_sel_hi:[1,1,1]
    v_pk_fma_f32 v[140:141], v[140:141], v[72:73], v[44:45] op_sel:[0,1,0] op_sel_hi:[1,1,1]
    v_pk_fma_f32 v[142:143], v[142:143], v[72:73], v[46:47] op_sel:[0,1,0] op_sel_hi:[1,1,1]
    v_cvt_pk_bf16_f32 v136, v136, v137
    v_cvt_pk_bf16_f32 v137, v138, v139
    v_cvt_pk_bf16_f32 v138, v140, v141
    v_cvt_pk_bf16_f32 v139, v142, v143
    buffer_store_dwordx4 v[136:139], v254, s[36:39], s64 offen offset:3072 sc1
    v_lshlrev_b32 v32, 16, v16
    v_and_b32 v33, s75, v16
    v_lshlrev_b32 v34, 16, v17
    v_and_b32 v35, s75, v17
    v_lshlrev_b32 v36, 16, v18
    v_and_b32 v37, s75, v18
    v_lshlrev_b32 v38, 16, v19
    v_and_b32 v39, s75, v19
    s_waitcnt lgkmcnt(6)
    s_nop 0
    v_pk_add_f32 v[144:145], v[144:145], v[208:209]
    v_pk_add_f32 v[146:147], v[146:147], v[210:211]
    v_pk_add_f32 v[148:149], v[148:149], v[212:213]
    v_pk_add_f32 v[150:151], v[150:151], v[214:215]
    v_pk_fma_f32 v[144:145], v[144:145], v[74:75], v[32:33] op_sel_hi:[1,0,1]
    v_pk_fma_f32 v[146:147], v[146:147], v[74:75], v[34:35] op_sel_hi:[1,0,1]
    v_pk_fma_f32 v[148:149], v[148:149], v[74:75], v[36:37] op_sel_hi:[1,0,1]
    v_pk_fma_f32 v[150:151], v[150:151], v[74:75], v[38:39] op_sel_hi:[1,0,1]
    v_cvt_pk_bf16_f32 v144, v144, v145
    v_cvt_pk_bf16_f32 v145, v146, v147
    v_cvt_pk_bf16_f32 v146, v148, v149
    v_cvt_pk_bf16_f32 v147, v150, v151
    buffer_store_dwordx4 v[144:147], v254, s[36:39], s65 offen offset:0 sc1
    v_lshlrev_b32 v40, 16, v20
    v_and_b32 v41, s75, v20
    v_lshlrev_b32 v42, 16, v21
    v_and_b32 v43, s75, v21
    v_lshlrev_b32 v44, 16, v22
    v_and_b32 v45, s75, v22
    v_lshlrev_b32 v46, 16, v23
    v_and_b32 v47, s75, v23
    s_waitcnt lgkmcnt(4)
    s_nop 0
    v_pk_add_f32 v[152:153], v[152:153], v[216:217]
    v_pk_add_f32 v[154:155], v[154:155], v[218:219]
    v_pk_add_f32 v[156:157], v[156:157], v[220:221]
    v_pk_add_f32 v[158:159], v[158:159], v[222:223]
    v_pk_fma_f32 v[152:153], v[152:153], v[74:75], v[40:41] op_sel_hi:[1,0,1]
    v_pk_fma_f32 v[154:155], v[154:155], v[74:75], v[42:43] op_sel_hi:[1,0,1]
    v_pk_fma_f32 v[156:157], v[156:157], v[74:75], v[44:45] op_sel_hi:[1,0,1]
    v_pk_fma_f32 v[158:159], v[158:159], v[74:75], v[46:47] op_sel_hi:[1,0,1]
    v_cvt_pk_bf16_f32 v152, v152, v153
    v_cvt_pk_bf16_f32 v153, v154, v155
    v_cvt_pk_bf16_f32 v154, v156, v157
    v_cvt_pk_bf16_f32 v155, v158, v159
    buffer_store_dwordx4 v[152:155], v254, s[36:39], s65 offen offset:1024 sc1
    v_lshlrev_b32 v32, 16, v24
    v_and_b32 v33, s75, v24
    v_lshlrev_b32 v34, 16, v25
    v_and_b32 v35, s75, v25
    v_lshlrev_b32 v36, 16, v26
    v_and_b32 v37, s75, v26
    v_lshlrev_b32 v38, 16, v27
    v_and_b32 v39, s75, v27
    s_waitcnt lgkmcnt(2)
    s_nop 0
    v_pk_add_f32 v[160:161], v[160:161], v[224:225]
    v_pk_add_f32 v[162:163], v[162:163], v[226:227]
    v_pk_add_f32 v[164:165], v[164:165], v[228:229]
    v_pk_add_f32 v[166:167], v[166:167], v[230:231]
    v_pk_fma_f32 v[160:161], v[160:161], v[74:75], v[32:33] op_sel:[0,1,0] op_sel_hi:[1,1,1]
    v_pk_fma_f32 v[162:163], v[162:163], v[74:75], v[34:35] op_sel:[0,1,0] op_sel_hi:[1,1,1]
    v_pk_fma_f32 v[164:165], v[164:165], v[74:75], v[36:37] op_sel:[0,1,0] op_sel_hi:[1,1,1]
    v_pk_fma_f32 v[166:167], v[166:167], v[74:75], v[38:39] op_sel:[0,1,0] op_sel_hi:[1,1,1]
    v_cvt_pk_bf16_f32 v160, v160, v161
    v_cvt_pk_bf16_f32 v161, v162, v163
    v_cvt_pk_bf16_f32 v162, v164, v165
    v_cvt_pk_bf16_f32 v163, v166, v167
    buffer_store_dwordx4 v[160:163], v254, s[36:39], s65 offen offset:2048 sc1
    v_lshlrev_b32 v40, 16, v28
    v_and_b32 v41, s75, v28
    v_lshlrev_b32 v42, 16, v29
    v_and_b32 v43, s75, v29
    v_lshlrev_b32 v44, 16, v30
    v_and_b32 v45, s75, v30
    v_lshlrev_b32 v46, 16, v31
    v_and_b32 v47, s75, v31
    s_waitcnt lgkmcnt(0)
    s_nop 0
    v_pk_add_f32 v[168:169], v[168:169], v[232:233]
    v_pk_add_f32 v[170:171], v[170:171], v[234:235]
    v_pk_add_f32 v[172:173], v[172:173], v[236:237]
    v_pk_add_f32 v[174:175], v[174:175], v[238:239]
    v_pk_fma_f32 v[168:169], v[168:169], v[74:75], v[40:41] op_sel:[0,1,0] op_sel_hi:[1,1,1]
    v_pk_fma_f32 v[170:171], v[170:171], v[74:75], v[42:43] op_sel:[0,1,0] op_sel_hi:[1,1,1]
    v_pk_fma_f32 v[172:173], v[172:173], v[74:75], v[44:45] op_sel:[0,1,0] op_sel_hi:[1,1,1]
    v_pk_fma_f32 v[174:175], v[174:175], v[74:75], v[46:47] op_sel:[0,1,0] op_sel_hi:[1,1,1]
    v_cvt_pk_bf16_f32 v168, v168, v169
    v_cvt_pk_bf16_f32 v169, v170, v171
    v_cvt_pk_bf16_f32 v170, v172, v173
    v_cvt_pk_bf16_f32 v171, v174, v175
    buffer_store_dwordx4 v[168:171], v254, s[36:39], s65 offen offset:3072 sc1
    v_cmp_eq_u32 vcc, 0, v255
    v_mov_b32 v253, 0x80000000
    v_mov_b32 v252, s95
    v_cndmask_b32 v253, v253, 0, vcc
    s_waitcnt vmcnt(0)
    buffer_store_dword v252, v253, s[36:39], s34 offen sc1
    s_endpgm
G2_fin:
    s_mov_b32 s48, s28
    s_mov_b32 s49, s29
    s_mov_b32 s50, 0x400000
    s_mov_b32 s51, 0x00020000
    s_waitcnt vmcnt(24) lgkmcnt(0)
    s_barrier
    v_mfma_f32_16x16x32_bf16 v[112:115], a[96:99], a[16:19], v[112:115]
    ds_read_b64_tr_b16 a[64:65], v244 offset:16384
    ds_read_b64_tr_b16 a[66:67], v244 offset:20480
    v_mfma_f32_16x16x32_bf16 v[116:119], a[100:103], a[16:19], v[116:119]
    ds_read_b64_tr_b16 a[68:69], v245 offset:16384
    v_mfma_f32_16x16x32_bf16 v[120:123], a[104:107], a[16:19], v[120:123]
    s_lshl_b32 s77, s61, 10
    v_mfma_f32_16x16x32_bf16 v[124:127], a[108:111], a[16:19], v[124:127]
    s_lshl_b32 s3, s70, 9
    v_mfma_f32_16x16x32_bf16 v[176:179], a[112:115], a[16:19], v[176:179]
    s_add_u32 s77, s77, s3
    v_mfma_f32_16x16x32_bf16 v[180:183], a[116:119], a[16:19], v[180:183]
    s_add_u32 s77, s77, 0x2800004
    ds_read_b64_tr_b16 a[70:71], v245 offset:20480
    v_mfma_f32_16x16x32_bf16 v[184:187], a[120:123], a[16:19], v[184:187]
    ds_read_b64_tr_b16 a[72:73], v246 offset:16384
    v_mfma_f32_16x16x32_bf16 v[188:191], a[124:127], a[16:19], v[188:191]
    ds_read_b64_tr_b16 a[74:75], v246 offset:20480
    v_mfma_f32_16x16x32_bf16 v[204:207], a[124:127], a[20:23], v[204:207]
    v_lshlrev_b32 v64, 3, v68
    v_mfma_f32_16x16x32_bf16 v[200:203], a[120:123], a[20:23], v[200:203]
    buffer_load_dword v72, v64, s[36:39], s77 offen offset:0 sc1
    v_mfma_f32_16x16x32_bf16 v[196:199], a[116:119], a[20:23], v[196:199]
    buffer_load_dword v73, v64, s[36:39], s77 offen offset:128 sc1
    buffer_load_dword v74, v64, s[36:39], s77 offen offset:256 sc1
    v_mfma_f32_16x16x32_bf16 v[192:195], a[112:115], a[20:23], v[192:195]
    ds_read_b64_tr_b16 a[76:77], v247 offset:16384
    v_mfma_f32_16x16x32_bf16 v[140:143], a[108:111], a[20:23], v[140:143]
    ds_read_b64_tr_b16 a[78:79], v247 offset:20480
    v_mfma_f32_16x16x32_bf16 v[136:139], a[104:107], a[20:23], v[136:139]
    ds_read_b64_tr_b16 a[80:81], v248 offset:16384
    v_mfma_f32_16x16x32_bf16 v[132:135], a[100:103], a[20:23], v[132:135]
    buffer_load_dword v75, v64, s[36:39], s77 offen offset:384 sc1
    v_mfma_f32_16x16x32_bf16 v[128:131], a[96:99], a[20:23], v[128:131]
    s_lshl_b32 s64, s63, 15
    s_lshl_b32 s3, s4, 13
    v_mfma_f32_16x16x32_bf16 v[144:147], a[96:99], a[24:27], v[144:147]
    s_add_u32 s64, s64, s3
    v_mfma_f32_16x16x32_bf16 v[148:151], a[100:103], a[24:27], v[148:151]
    ds_read_b64_tr_b16 a[82:83], v248 offset:20480
    v_mfma_f32_16x16x32_bf16 v[152:155], a[104:107], a[24:27], v[152:155]
    ds_read_b64_tr_b16 a[84:85], v249 offset:16384
    v_mfma_f32_16x16x32_bf16 v[156:159], a[108:111], a[24:27], v[156:159]
    ds_read_b64_tr_b16 a[86:87], v249 offset:20480
    v_mfma_f32_16x16x32_bf16 v[208:211], a[112:115], a[24:27], v[208:211]
    s_add_u32 s64, s64, 0x2000000
    s_add_u32 s65, s64, 4096
    v_mfma_f32_16x16x32_bf16 v[212:215], a[116:119], a[24:27], v[212:215]
    ds_read_b64_tr_b16 a[88:89], v250 offset:16384
    v_mfma_f32_16x16x32_bf16 v[216:219], a[120:123], a[24:27], v[216:219]
    ds_read_b64_tr_b16 a[90:91], v250 offset:20480
    v_mfma_f32_16x16x32_bf16 v[220:223], a[124:127], a[24:27], v[220:223]
    ds_read_b64_tr_b16 a[92:93], v251 offset:16384
    v_mfma_f32_16x16x32_bf16 v[236:239], a[124:127], a[28:31], v[236:239]
    ds_read_b64_tr_b16 a[94:95], v251 offset:20480
    v_mfma_f32_16x16x32_bf16 v[232:235], a[120:123], a[28:31], v[232:235]
    v_mfma_f32_16x16x32_bf16 v[228:231], a[116:119], a[28:31], v[228:231]
    v_mfma_f32_16x16x32_bf16 v[224:227], a[112:115], a[28:31], v[224:227]
    v_mfma_f32_16x16x32_bf16 v[172:175], a[108:111], a[28:31], v[172:175]
    v_mfma_f32_16x16x32_bf16 v[168:171], a[104:107], a[28:31], v[168:171]
    v_mfma_f32_16x16x32_bf16 v[164:167], a[100:103], a[28:31], v[164:167]
    v_mfma_f32_16x16x32_bf16 v[160:163], a[96:99], a[28:31], v[160:163]
    s_waitcnt vmcnt(20) lgkmcnt(0)
    s_barrier
    v_mfma_f32_16x16x32_bf16 v[112:115], a[64:67], a[32:35], v[112:115]
    buffer_load_dword v70, off, s[36:39], s34 sc1
    ds_read_b64_tr_b16 a[96:97], v244 offset:24576
    v_mfma_f32_16x16x32_bf16 v[116:119], a[68:71], a[32:35], v[116:119]
    ds_read_b64_tr_b16 a[98:99], v244 offset:28672
    ds_read_b64_tr_b16 a[100:101], v245 offset:24576
    v_mfma_f32_16x16x32_bf16 v[120:123], a[72:75], a[32:35], v[120:123]
    s_lshl_b32 s3, s4, 14
    v_mfma_f32_16x16x32_bf16 v[124:127], a[76:79], a[32:35], v[124:127]
    v_add_u32 v64, s3, v254
    s_xor_b32 s3, s4, 2
    v_mfma_f32_16x16x32_bf16 v[176:179], a[80:83], a[32:35], v[176:179]
    s_lshl_b32 s3, s3, 14
    ds_read_b64_tr_b16 a[102:103], v245 offset:28672
    v_mfma_f32_16x16x32_bf16 v[180:183], a[84:87], a[32:35], v[180:183]
    ds_read_b64_tr_b16 a[104:105], v246 offset:24576
    v_mfma_f32_16x16x32_bf16 v[184:187], a[88:91], a[32:35], v[184:187]
    ds_read_b64_tr_b16 a[106:107], v246 offset:28672
    v_add_u32 v65, s3, v254
    v_mfma_f32_16x16x32_bf16 v[188:191], a[92:95], a[32:35], v[188:191]
    s_mov_b32 s75, 0xffff0000
    v_and_b32_e64 v66, 1, v67
    v_mfma_f32_16x16x32_bf16 v[204:207], a[92:95], a[36:39], v[204:207]
    v_lshrrev_b32_e64 v96, 1, v67
    v_mfma_f32_16x16x32_bf16 v[200:203], a[88:91], a[36:39], v[200:203]
    ds_read_b64_tr_b16 a[108:109], v247 offset:24576
    ds_read_b64_tr_b16 a[110:111], v247 offset:28672
    v_mfma_f32_16x16x32_bf16 v[196:199], a[84:87], a[36:39], v[196:199]
    ds_read_b64_tr_b16 a[112:113], v248 offset:24576
    v_lshl_or_b32 v66, v66, 1, v96
    v_mfma_f32_16x16x32_bf16 v[192:195], a[80:83], a[36:39], v[192:195]
    v_lshrrev_b32_e64 v96, 1, v68
    v_mfma_f32_16x16x32_bf16 v[140:143], a[76:79], a[36:39], v[140:143]
    v_xor_b32 v66, v66, v96
    v_lshlrev_b32 v66, 4, v66
    v_mfma_f32_16x16x32_bf16 v[136:139], a[72:75], a[36:39], v[136:139]
    ds_read_b64_tr_b16 a[114:115], v248 offset:28672
    v_mfma_f32_16x16x32_bf16 v[132:135], a[68:71], a[36:39], v[132:135]
    ds_read_b64_tr_b16 a[116:117], v249 offset:24576
    ds_read_b64_tr_b16 a[118:119], v249 offset:28672
    v_mfma_f32_16x16x32_bf16 v[128:131], a[64:67], a[36:39], v[128:131]
    v_lshl_add_u32 v66, v68, 7, v66
    v_add_u32_e64 v96, s67, v66
    v_mfma_f32_16x16x32_bf16 v[144:147], a[64:67], a[40:43], v[144:147]
    v_xor_b32_e64 v97, 64, v96
    v_mfma_f32_16x16x32_bf16 v[148:151], a[68:71], a[40:43], v[148:151]
    v_add_u32_e64 v98, s67, v254
    ds_read_b64_tr_b16 a[120:121], v250 offset:24576
    v_mfma_f32_16x16x32_bf16 v[152:155], a[72:75], a[40:43], v[152:155]
    ds_read_b64_tr_b16 a[122:123], v250 offset:28672
    ds_read_b64_tr_b16 a[124:125], v251 offset:24576
    v_mfma_f32_16x16x32_bf16 v[156:159], a[76:79], a[40:43], v[156:159]
    ds_read_b64_tr_b16 a[126:127], v251 offset:28672
    v_mfma_f32_16x16x32_bf16 v[208:211], a[80:83], a[40:43], v[208:211]
    v_xor_b32 v244, 0x10000, v244
    v_xor_b32 v245, 0x10000, v245
    v_mfma_f32_16x16x32_bf16 v[212:215], a[84:87], a[40:43], v[212:215]
    v_xor_b32 v246, 0x10000, v246
    v_xor_b32 v247, 0x10000, v247
    v_mfma_f32_16x16x32_bf16 v[216:219], a[88:91], a[40:43], v[216:219]
    v_xor_b32 v248, 0x10000, v248
    v_mfma_f32_16x16x32_bf16 v[220:223], a[92:95], a[40:43], v[220:223]
    v_xor_b32 v249, 0x10000, v249
    v_xor_b32 v250, 0x10000, v250
    v_mfma_f32_16x16x32_bf16 v[236:239], a[92:95], a[44:47], v[236:239]
    v_xor_b32 v251, 0x10000, v251
    v_mfma_f32_16x16x32_bf16 v[232:235], a[88:91], a[44:47], v[232:235]
    v_mfma_f32_16x16x32_bf16 v[228:231], a[84:87], a[44:47], v[228:231]
    v_mfma_f32_16x16x32_bf16 v[224:227], a[80:83], a[44:47], v[224:227]
    v_mfma_f32_16x16x32_bf16 v[172:175], a[76:79], a[44:47], v[172:175]
    v_mfma_f32_16x16x32_bf16 v[168:171], a[72:75], a[44:47], v[168:171]
    v_mfma_f32_16x16x32_bf16 v[164:167], a[68:71], a[44:47], v[164:167]
    v_mfma_f32_16x16x32_bf16 v[160:163], a[64:67], a[44:47], v[160:163]
    s_waitcnt vmcnt(0) lgkmcnt(0)
    s_barrier
    v_mfma_f32_16x16x32_bf16 v[176:179], a[112:115], a[48:51], v[176:179]
    v_cmp_eq_u32 vcc, s95, v70
    v_mfma_f32_16x16x32_bf16 v[180:183], a[116:119], a[48:51], v[180:183]
    s_and_b32 s3, vcc_lo, 1
    v_mfma_f32_16x16x32_bf16 v[184:187], a[120:123], a[48:51], v[184:187]
    s_cmp_eq_u32 s3, 1
    v_mfma_f32_16x16x32_bf16 v[188:191], a[124:127], a[48:51], v[188:191]
    s_cselect_b32 s81, 1, 0
    v_mfma_f32_16x16x32_bf16 v[192:195], a[112:115], a[52:55], v[192:195]
    s_cselect_b32 s71, s64, 0x80000000
    v_mfma_f32_16x16x32_bf16 v[196:199], a[116:119], a[52:55], v[196:199]
    s_cselect_b32 s72, s65, 0x80000000
    v_mfma_f32_16x16x32_bf16 v[200:203], a[120:123], a[52:55], v[200:203]
    buffer_load_dwordx4 v[0:3], v254, s[36:39], s71 offen offset:0 sc1
    v_mfma_f32_16x16x32_bf16 v[204:207], a[124:127], a[52:55], v[204:207]
    v_mfma_f32_16x16x32_bf16 v[208:211], a[112:115], a[56:59], v[208:211]
    buffer_load_dwordx4 v[4:7], v254, s[36:39], s71 offen offset:1024 sc1
    v_mfma_f32_16x16x32_bf16 v[212:215], a[116:119], a[56:59], v[212:215]
    buffer_load_dwordx4 v[8:11], v254, s[36:39], s71 offen offset:2048 sc1
    v_mfma_f32_16x16x32_bf16 v[216:219], a[120:123], a[56:59], v[216:219]
    buffer_load_dwordx4 v[12:15], v254, s[36:39], s71 offen offset:3072 sc1
    v_mfma_f32_16x16x32_bf16 v[220:223], a[124:127], a[56:59], v[220:223]
    buffer_load_dwordx4 v[16:19], v254, s[36:39], s72 offen offset:0 sc1
    v_mfma_f32_16x16x32_bf16 v[224:227], a[112:115], a[60:63], v[224:227]
    buffer_load_dwordx4 v[20:23], v254, s[36:39], s72 offen offset:1024 sc1
    v_mfma_f32_16x16x32_bf16 v[228:231], a[116:119], a[60:63], v[228:231]
    buffer_load_dwordx4 v[24:27], v254, s[36:39], s72 offen offset:2048 sc1
    v_mfma_f32_16x16x32_bf16 v[232:235], a[120:123], a[60:63], v[232:235]
    buffer_load_dwordx4 v[28:31], v254, s[36:39], s72 offen offset:3072 sc1
    v_mfma_f32_16x16x32_bf16 v[236:239], a[124:127], a[60:63], v[236:239]
    v_mfma_f32_16x16x32_bf16 v[112:115], a[96:99], a[48:51], v[112:115]
    ds_write_b128 v64, v[176:179] offset:0
    v_mfma_f32_16x16x32_bf16 v[116:119], a[100:103], a[48:51], v[116:119]
    ds_write_b128 v64, v[180:183] offset:1024
    v_mfma_f32_16x16x32_bf16 v[120:123], a[104:107], a[48:51], v[120:123]
    ds_write_b128 v64, v[184:187] offset:2048
    v_mfma_f32_16x16x32_bf16 v[124:127], a[108:111], a[48:51], v[124:127]
    ds_write_b128 v64, v[188:191] offset:3072
    v_mfma_f32_16x16x32_bf16 v[128:131], a[96:99], a[52:55], v[128:131]
    ds_write_b128 v64, v[192:195] offset:4096
    v_mfma_f32_16x16x32_bf16 v[132:135], a[100:103], a[52:55], v[132:135]
    ds_write_b128 v64, v[196:199] offset:5120
    v_mfma_f32_16x16x32_bf16 v[136:139], a[104:107], a[52:55], v[136:139]
    ds_write_b128 v64, v[200:203] offset:6144
    v_mfma_f32_16x16x32_bf16 v[140:143], a[108:111], a[52:55], v[140:143]
    ds_write_b128 v64, v[204:207] offset:7168
    v_mfma_f32_16x16x32_bf16 v[144:147], a[96:99], a[56:59], v[144:147]
    ds_write_b128 v64, v[208:211] offset:8192
    v_mfma_f32_16x16x32_bf16 v[148:151], a[100:103], a[56:59], v[148:151]
    ds_write_b128 v64, v[212:215] offset:9216
    v_mfma_f32_16x16x32_bf16 v[152:155], a[104:107], a[56:59], v[152:155]
    ds_write_b128 v64, v[216:219] offset:10240
    v_mfma_f32_16x16x32_bf16 v[156:159], a[108:111], a[56:59], v[156:159]
    ds_write_b128 v64, v[220:223] offset:11264
    v_mfma_f32_16x16x32_bf16 v[160:163], a[96:99], a[60:63], v[160:163]
    v_mfma_f32_16x16x32_bf16 v[164:167], a[100:103], a[60:63], v[164:167]
    v_mfma_f32_16x16x32_bf16 v[168:171], a[104:107], a[60:63], v[168:171]
    v_mfma_f32_16x16x32_bf16 v[172:175], a[108:111], a[60:63], v[172:175]
    ds_write_b128 v64, v[224:227] offset:12288
    ds_write_b128 v64, v[228:231] offset:13312
    ds_write_b128 v64, v[232:235] offset:14336
    ds_write_b128 v64, v[236:239] offset:15360
    s_cmp_eq_u32 s81, 1
    s_cbranch_scc1 G2_x
G2_nop:
    buffer_load_dword v70, off, s[36:39], s34 sc1
G2_x:
    s_waitcnt lgkmcnt(0)
    s_barrier
    ds_read_b128 v[176:179], v65 offset:0
    ds_read_b128 v[180:183], v65 offset:1024
    ds_read_b128 v[184:187], v65 offset:2048
    ds_read_b128 v[188:191], v65 offset:3072
    ds_read_b128 v[192:195], v65 offset:4096
    ds_read_b128 v[196:199], v65 offset:5120
    ds_read_b128 v[200:203], v65 offset:6144
    ds_read_b128 v[204:207], v65 offset:7168
    ds_read_b128 v[208:211], v65 offset:8192
    ds_read_b128 v[212:215], v65 offset:9216
    ds_read_b128 v[216:219], v65 offset:10240
    ds_read_b128 v[220:223], v65 offset:11264
    ds_read_b128 v[224:227], v65 offset:12288
    ds_read_b128 v[228:231], v65 offset:13312
    ds_read_b128 v[232:235], v65 offset:14336
    ds_read_b128 v[236:239], v65 offset:15360
    s_waitcnt lgkmcnt(14)
    v_pk_add_f32 v[112:113], v[112:113], v[176:177]
    v_pk_add_f32 v[114:115], v[114:115], v[178:179]
    v_pk_add_f32 v[116:117], v[116:117], v[180:181]
    v_pk_add_f32 v[118:119], v[118:119], v[182:183]
    s_waitcnt lgkmcnt(12)
    v_pk_add_f32 v[120:121], v[120:121], v[184:185]
    v_pk_add_f32 v[122:123], v[122:123], v[186:187]
    v_pk_add_f32 v[124:125], v[124:125], v[188:189]
    v_pk_add_f32 v[126:127], v[126:127], v[190:191]
    s_waitcnt lgkmcnt(10)
    v_pk_add_f32 v[128:129], v[128:129], v[192:193]
    v_pk_add_f32 v[130:131], v[130:131], v[194:195]
    v_pk_add_f32 v[132:133], v[132:133], v[196:197]
    v_pk_add_f32 v[134:135], v[134:135], v[198:199]
    s_waitcnt lgkmcnt(8)
    v_pk_add_f32 v[136:137], v[136:137], v[200:201]
    v_pk_add_f32 v[138:139], v[138:139], v[202:203]
    v_pk_add_f32 v[140:141], v[140:141], v[204:205]
    v_pk_add_f32 v[142:143], v[142:143], v[206:207]
    s_waitcnt lgkmcnt(6)
    v_pk_add_f32 v[144:145], v[144:145], v[208:209]
    v_pk_add_f32 v[146:147], v[146:147], v[210:211]
    v_pk_add_f32 v[148:149], v[148:149], v[212:213]
    v_pk_add_f32 v[150:151], v[150:151], v[214:215]
    s_waitcnt lgkmcnt(4)
    v_pk_add_f32 v[152:153], v[152:153], v[216:217]
    v_pk_add_f32 v[154:155], v[154:155], v[218:219]
    v_pk_add_f32 v[156:157], v[156:157], v[220:221]
    v_pk_add_f32 v[158:159], v[158:159], v[222:223]
    s_waitcnt lgkmcnt(2)
    v_pk_add_f32 v[160:161], v[160:161], v[224:225]
    v_pk_add_f32 v[162:163], v[162:163], v[226:227]
    v_pk_add_f32 v[164:165], v[164:165], v[228:229]
    v_pk_add_f32 v[166:167], v[166:167], v[230:231]
    s_waitcnt lgkmcnt(0)
    v_pk_add_f32 v[168:169], v[168:169], v[232:233]
    v_pk_add_f32 v[170:171], v[170:171], v[234:235]
    v_pk_add_f32 v[172:173], v[172:173], v[236:237]
    v_pk_add_f32 v[174:175], v[174:175], v[238:239]
    s_cmp_eq_u32 s81, 1
    s_cbranch_scc1 G2_havep
    s_waitcnt vmcnt(0)
    v_cmp_eq_u32 vcc, s95, v70
    s_and_b32 s3, vcc_lo, 0x1
    s_cmp_eq_u32 s3, 0x1
    s_cbranch_scc1 G2_pollp_ok
    v_min_u32 v253, 0, v255
    v_lshlrev_b32_e64 v253, 7, v253
G2_pollp:
    buffer_load_dword v252, v253, s[36:39], s34 offen offset:0 sc1
    s_waitcnt vmcnt(0)
    v_cmp_eq_u32 vcc, s95, v252
    s_and_b32 s3, vcc_lo, 0x1
    s_cmp_eq_u32 s3, 0x1
    s_cbranch_scc1 G2_pollp_ok
    s_sleep 1
    s_sub_u32 s12, s12, 1
    s_cmp_gt_i32 s12, 0
    s_cbranch_scc1 G2_pollp
G2_pollp_ok:
    s_nop 0
    buffer_load_dwordx4 v[0:3], v254, s[36:39], s64 offen offset:0 sc1
    buffer_load_dwordx4 v[4:7], v254, s[36:39], s64 offen offset:1024 sc1
    buffer_load_dwordx4 v[8:11], v254, s[36:39], s64 offen offset:2048 sc1
    buffer_load_dwordx4 v[12:15], v254, s[36:39], s64 offen offset:3072 sc1
    buffer_load_dwordx4 v[16:19], v254, s[36:39], s65 offen offset:0 sc1
    buffer_load_dwordx4 v[20:23], v254, s[36:39], s65 offen offset:1024 sc1
    buffer_load_dwordx4 v[24:27], v254, s[36:39], s65 offen offset:2048 sc1
    buffer_load_dwordx4 v[28:31], v254, s[36:39], s65 offen offset:3072 sc1
G2_havep:
    s_add_u32 s66, s78, 0x10000
    s_waitcnt vmcnt(7)
    v_lshlrev_b32 v32, 16, v0
    v_and_b32 v33, s75, v0
    v_lshlrev_b32 v34, 16, v1
    v_and_b32 v35, s75, v1
    v_lshlrev_b32 v36, 16, v2
    v_and_b32 v37, s75, v2
    v_lshlrev_b32 v38, 16, v3
    v_and_b32_e64 v39, s75, v3
    v_pk_fma_f32 v[112:113], v[112:113], v[72:73], v[32:33] op_sel_hi:[1,0,1]
    v_pk_fma_f32 v[114:115], v[114:115], v[72:73], v[34:35] op_sel_hi:[1,0,1]
    v_pk_fma_f32 v[116:117], v[116:117], v[72:73], v[36:37] op_sel_hi:[1,0,1]
    v_pk_fma_f32 v[118:119], v[118:119], v[72:73], v[38:39] op_sel_hi:[1,0,1]
    v_cvt_pk_bf16_f32 v112, v112, v113
    v_cvt_pk_bf16_f32 v113, v114, v115
    v_cvt_pk_bf16_f32 v114, v116, v117
    v_cvt_pk_bf16_f32 v115, v118, v119
    s_nop 1
    v_permlane16_swap_b32 v112, v114
    v_permlane16_swap_b32 v113, v115
    ds_write_b128 v96, v[112:115] offset:0
    s_waitcnt vmcnt(6)
    v_lshlrev_b32 v40, 16, v4
    v_and_b32 v41, s75, v4
    v_lshlrev_b32 v42, 16, v5
    v_and_b32 v43, s75, v5
    v_lshlrev_b32 v44, 16, v6
    v_and_b32 v45, s75, v6
    v_lshlrev_b32 v46, 16, v7
    v_and_b32 v47, s75, v7
    v_pk_fma_f32 v[120:121], v[120:121], v[72:73], v[40:41] op_sel_hi:[1,0,1]
    v_pk_fma_f32 v[122:123], v[122:123], v[72:73], v[42:43] op_sel_hi:[1,0,1]
    v_pk_fma_f32 v[124:125], v[124:125], v[72:73], v[44:45] op_sel_hi:[1,0,1]
    v_pk_fma_f32 v[126:127], v[126:127], v[72:73], v[46:47] op_sel_hi:[1,0,1]
    v_cvt_pk_bf16_f32 v120, v120, v121
    v_cvt_pk_bf16_f32 v121, v122, v123
    v_cvt_pk_bf16_f32 v122, v124, v125
    v_cvt_pk_bf16_f32 v123, v126, v127
    s_nop 1
    v_permlane16_swap_b32 v120, v122
    v_permlane16_swap_b32 v121, v123
    ds_write_b128 v97, v[120:123] offset:0
    ds_read_b128 v[176:179], v98 offset:0
    ds_read_b128 v[184:187], v98 offset:1024
    s_waitcnt vmcnt(5)
    v_lshlrev_b32 v32, 16, v8
    v_and_b32 v33, s75, v8
    v_lshlrev_b32 v34, 16, v9
    v_and_b32 v35, s75, v9
    v_lshlrev_b32 v36, 16, v10
    v_and_b32 v37, s75, v10
    v_lshlrev_b32 v38, 16, v11
    v_and_b32 v39, s75, v11
    v_pk_fma_f32 v[128:129], v[128:129], v[72:73], v[32:33] op_sel:[0,1,0] op_sel_hi:[1,1,1]
    v_pk_fma_f32 v[130:131], v[130:131], v[72:73], v[34:35] op_sel:[0,1,0] op_sel_hi:[1,1,1]
    v_pk_fma_f32 v[132:133], v[132:133], v[72:73], v[36:37] op_sel:[0,1,0] op_sel_hi:[1,1,1]
    v_pk_fma_f32 v[134:135], v[134:135], v[72:73], v[38:39] op_sel:[0,1,0] op_sel_hi:[1,1,1]
    v_cvt_pk_bf16_f32 v128, v128, v129
    v_cvt_pk_bf16_f32 v129, v130, v131
    v_cvt_pk_bf16_f32 v130, v132, v133
    v_cvt_pk_bf16_f32 v131, v134, v135
    s_waitcnt lgkmcnt(0)
    buffer_store_dwordx4 v[176:179], v76, s[48:51], s78 offen offset:0 sc1
    buffer_store_dwordx4 v[184:187], v77, s[48:51], s78 offen offset:1024 sc1
    v_permlane16_swap_b32 v128, v130
    v_permlane16_swap_b32 v129, v131
    ds_write_b128 v96, v[128:131] offset:2048
    s_waitcnt vmcnt(6)
    v_lshlrev_b32 v40, 16, v12
    v_and_b32 v41, s75, v12
    v_lshlrev_b32 v42, 16, v13
    v_and_b32 v43, s75, v13
    v_lshlrev_b32 v44, 16, v14
    v_and_b32 v45, s75, v14
    v_lshlrev_b32 v46, 16, v15
    v_and_b32 v47, s75, v15
    v_pk_fma_f32 v[136:137], v[136:137], v[72:73], v[40:41] op_sel:[0,1,0] op_sel_hi:[1,1,1]
    v_pk_fma_f32 v[138:139], v[138:139], v[72:73], v[42:43] op_sel:[0,1,0] op_sel_hi:[1,1,1]
    v_pk_fma_f32 v[140:141], v[140:141], v[72:73], v[44:45] op_sel:[0,1,0] op_sel_hi:[1,1,1]
    v_pk_fma_f32 v[142:143], v[142:143], v[72:73], v[46:47] op_sel:[0,1,0] op_sel_hi:[1,1,1]
    v_cvt_pk_bf16_f32 v136, v136, v137
    v_cvt_pk_bf16_f32 v137, v138, v139
    v_cvt_pk_bf16_f32 v138, v140, v141
    v_cvt_pk_bf16_f32 v139, v142, v143
    s_nop 1
    v_permlane16_swap_b32 v136, v138
    v_permlane16_swap_b32 v137, v139
    ds_write_b128 v97, v[136:139] offset:2048
    ds_read_b128 v[192:195], v98 offset:2048
    ds_read_b128 v[200:203], v98 offset:3072
    s_waitcnt vmcnt(5)
    v_lshlrev_b32 v32, 16, v16
    v_and_b32 v33, s75, v16
    v_lshlrev_b32 v34, 16, v17
    v_and_b32 v35, s75, v17
    v_lshlrev_b32 v36, 16, v18
    v_and_b32 v37, s75, v18
    v_lshlrev_b32 v38, 16, v19
    v_and_b32 v39, s75, v19
    v_pk_fma_f32 v[144:145], v[144:145], v[74:75], v[32:33] op_sel_hi:[1,0,1]
    v_pk_fma_f32 v[146:147], v[146:147], v[74:75], v[34:35] op_sel_hi:[1,0,1]
    v_pk_fma_f32 v[148:149], v[148:149], v[74:75], v[36:37] op_sel_hi:[1,0,1]
    v_pk_fma_f32 v[150:151], v[150:151], v[74:75], v[38:39] op_sel_hi:[1,0,1]
    v_cvt_pk_bf16_f32 v144, v144, v145
    v_cvt_pk_bf16_f32 v145, v146, v147
    v_cvt_pk_bf16_f32 v146, v148, v149
    v_cvt_pk_bf16_f32 v147, v150, v151
    s_waitcnt lgkmcnt(0)
    buffer_store_dwordx4 v[192:195], v78, s[48:51], s78 offen offset:2048 sc1
    buffer_store_dwordx4 v[200:203], v79, s[48:51], s78 offen offset:3072 sc1
    v_permlane16_swap_b32 v144, v146
    v_permlane16_swap_b32 v145, v147
    ds_write_b128 v96, v[144:147] offset:4096
    s_waitcnt vmcnt(6)
    v_lshlrev_b32 v40, 16, v20
    v_and_b32 v41, s75, v20
    v_lshlrev_b32 v42, 16, v21
    v_and_b32 v43, s75, v21
    v_lshlrev_b32 v44, 16, v22
    v_and_b32 v45, s75, v22
    v_lshlrev_b32 v46, 16, v23
    v_and_b32 v47, s75, v23
    v_pk_fma_f32 v[152:153], v[152:153], v[74:75], v[40:41] op_sel_hi:[1,0,1]
    v_pk_fma_f32 v[154:155], v[154:155], v[74:75], v[42:43] op_sel_hi:[1,0,1]
    v_pk_fma_f32 v[156:157], v[156:157], v[74:75], v[44:45] op_sel_hi:[1,0,1]
    v_pk_fma_f32 v[158:159], v[158:159], v[74:75], v[46:47] op_sel_hi:[1,0,1]
    v_cvt_pk_bf16_f32 v152, v152, v153
    v_cvt_pk_bf16_f32 v153, v154, v155
    v_cvt_pk_bf16_f32 v154, v156, v157
    v_cvt_pk_bf16_f32 v155, v158, v159
    s_nop 1
    v_permlane16_swap_b32 v152, v154
    v_permlane16_swap_b32 v153, v155
    ds_write_b128 v97, v[152:155] offset:4096
    ds_read_b128 v[208:211], v98 offset:4096
    ds_read_b128 v[216:219], v98 offset:5120
    s_waitcnt vmcnt(5)
    v_lshlrev_b32 v32, 16, v24
    v_and_b32 v33, s75, v24
    v_lshlrev_b32 v34, 16, v25
    v_and_b32 v35, s75, v25
    v_lshlrev_b32 v36, 16, v26
    v_and_b32 v37, s75, v26
    v_lshlrev_b32 v38, 16, v27
    v_and_b32 v39, s75, v27
    v_pk_fma_f32 v[160:161], v[160:161], v[74:75], v[32:33] op_sel:[0,1,0] op_sel_hi:[1,1,1]
    v_pk_fma_f32 v[162:163], v[162:163], v[74:75], v[34:35] op_sel:[0,1,0] op_sel_hi:[1,1,1]
    v_pk_fma_f32 v[164:165], v[164:165], v[74:75], v[36:37] op_sel:[0,1,0] op_sel_hi:[1,1,1]
    v_pk_fma_f32 v[166:167], v[166:167], v[74:75], v[38:39] op_sel:[0,1,0] op_sel_hi:[1,1,1]
    v_cvt_pk_bf16_f32 v160, v160, v161
    v_cvt_pk_bf16_f32 v161, v162, v163
    v_cvt_pk_bf16_f32 v162, v164, v165
    v_cvt_pk_bf16_f32 v163, v166, v167
    s_waitcnt lgkmcnt(0)
    buffer_store_dwordx4 v[208:211], v76, s[48:51], s66 offen offset:0 sc1
    buffer_store_dwordx4 v[216:219], v77, s[48:51], s66 offen offset:1024 sc1
    v_permlane16_swap_b32 v160, v162
    v_permlane16_swap_b32 v161, v163
    ds_write_b128 v96, v[160:163] offset:6144
    s_waitcnt vmcnt(6)
    v_lshlrev_b32 v40, 16, v28
    v_and_b32 v41, s75, v28
    v_lshlrev_b32 v42, 16, v29
    v_and_b32 v43, s75, v29
    v_lshlrev_b32 v44, 16, v30
    v_and_b32 v45, s75, v30
    v_lshlrev_b32 v46, 16, v31
    v_and_b32 v47, s75, v31
    v_pk_fma_f32 v[168:169], v[168:169], v[74:75], v[40:41] op_sel:[0,1,0] op_sel_hi:[1,1,1]
    v_pk_fma_f32 v[170:171], v[170:171], v[74:75], v[42:43] op_sel:[0,1,0] op_sel_hi:[1,1,1]
    v_pk_fma_f32 v[172:173], v[172:173], v[74:75], v[44:45] op_sel:[0,1,0] op_sel_hi:[1,1,1]
    v_pk_fma_f32 v[174:175], v[174:175], v[74:75], v[46:47] op_sel:[0,1,0] op_sel_hi:[1,1,1]
    v_cvt_pk_bf16_f32 v168, v168, v169
    v_cvt_pk_bf16_f32 v169, v170, v171
    v_cvt_pk_bf16_f32 v170, v172, v173
    v_cvt_pk_bf16_f32 v171, v174, v175
    s_nop 1
    v_permlane16_swap_b32 v168, v170
    v_permlane16_swap_b32 v169, v171
    ds_write_b128 v97, v[168:171] offset:6144
    ds_read_b128 v[224:227], v98 offset:6144
    ds_read_b128 v[232:235], v98 offset:7168
    s_waitcnt lgkmcnt(0)
    buffer_store_dwordx4 v[224:227], v78, s[48:51], s66 offen offset:2048 sc1
    buffer_store_dwordx4 v[232:235], v79, s[48:51], s66 offen offset:3072 sc1
K_end:
    s_endpgm
K_code_end:
.section .rodata,"a"
.p2align 6
.amdhsa_kernel parallel_sum__softmax_full_mha__dense_activation_relu__prompt_kernel
  .amdhsa_next_free_vgpr 480
  .amdhsa_next_free_sgpr 102
  .amdhsa_accum_offset 256
  .amdhsa_group_segment_fixed_size 0
  .amdhsa_kernarg_size 72
  .amdhsa_user_sgpr_count 2
  .amdhsa_user_sgpr_kernarg_segment_ptr 1
  .amdhsa_system_sgpr_workgroup_id_x 1
.end_amdhsa_kernel
```
